```python
import torch

def _softmax(x, axis=-1):
    return torch.softmax(x, dim=axis)
def _gelu(x):
    return torch.nn.functional.gelu(x, approximate="tanh")
def _silu(x):
    return torch.nn.functional.silu(x)
def _sigmoid(x):
    return torch.sigmoid(x)
def _layernorm(x, axis=-1, eps=1e-5):
    m = x.mean(dim=axis, keepdim=True)
    v = x.var(dim=axis, keepdim=True, unbiased=False)
    return (x - m) / torch.sqrt(v + eps)
def _scatter_add(tgt, idx, src, axis=0):
    return tgt.clone().index_add_(axis, idx, src)
def _segment_sum(src, seg, n):
    out = torch.zeros((n,) + src.shape[1:], dtype=src.dtype)
    return out.index_add_(0, seg, src)
def _pad(x, pw):
    flat = tuple(v for pair in reversed(pw) for v in pair)
    return torch.nn.functional.pad(x, flat)

kernel_name = 'gated_mix__mha_block__mixer_s_mlp__prompt'

def setup_inputs():

    _w = (lambda a: (lambda t: t.to(torch.bfloat16) if t.is_floating_point() else t)(torch.as_tensor(a)))
    def _A_setup():
        B, S, D, H = 1, 2048, 512, 32
        return {
            "x": _w((lambda *s: torch.randn(*s, dtype=torch.bfloat16) * 0.05)(B, S, D)),
            "wqkv": _w((lambda *s: torch.randn(*s, dtype=torch.bfloat16) * 1.6)(D, 3 * D)),
            "wo": _w((lambda *s: torch.randn(*s, dtype=torch.bfloat16) * 0.1)(D, D)),
        }
    _A_in = _A_setup()

    def _B_setup():
        B, S, D, F = 1, 2048, 512, 1792
        return {
            "x":  _w((lambda *s: torch.randn(*s, dtype=torch.bfloat16) * 0.05)(B, S, D)),
            "w1": _w((lambda *s: torch.randn(*s, dtype=torch.bfloat16) * 3.2)(D, D) * (D ** -0.5)),
            "w2": _w((lambda *s: torch.randn(*s, dtype=torch.bfloat16) * 3.2)(D, D) * (D ** -0.5)),
            "w3": _w((lambda *s: torch.randn(*s, dtype=torch.bfloat16) * 3.2)(D, F) * (D ** -0.5)),
            "w4": _w((lambda *s: torch.randn(*s, dtype=torch.bfloat16) * 1.6)(F, D) * (F ** -0.5)),
        }
    _B_in = _B_setup()

    return {
        "A_x": _A_in["x"],
        "A_wqkv": _A_in["wqkv"],
        "A_wo": _A_in["wo"],
        "B_x": _B_in["x"],
        "B_w1": _B_in["w1"],
        "B_w2": _B_in["w2"],
        "B_w3": _B_in["w3"],
        "B_w4": _B_in["w4"],
        "gate_w": _w((lambda *s: torch.randn(*s, dtype=torch.bfloat16) * 0.05)(512) * 16.0),
    }

def reference(A_x, A_wqkv, A_wo, B_x, B_w1, B_w2, B_w3, B_w4, gate_w):
    def _A_ref(x, wqkv, wo):
        B, S, D = x.shape
        H = 32
        Dh = D // H
        qkv = (lambda x, *d: x.permute(*d))((x @ wqkv).reshape(B, S, 3, H, Dh), 2, 0, 3, 1, 4)
        q, k, v = qkv[0], qkv[1], qkv[2]
        scores = torch.einsum("bhqd,bhkd->bhqk", q, k) * (Dh ** -0.5)
        p = _softmax(scores, axis=-1)
        o = torch.einsum("bhqk,bhkd->bhqd", p, v)
        return (lambda x, *d: x.permute(*d))(o, 0, 2, 1, 3).reshape(B, S, D) @ wo

    def _B_ref(x, w1, w2, w3, w4):
        B, S, D = x.shape
        h = _gelu(_layernorm(x, axis=-1) @ w1)
        c = D // 4
        g0 = _pad(h[:, :, 0*c:1*c], ((0, 0), (1, 0), (0, 0)))[:, :S, :]
        g1 = _pad(h[:, :, 1*c:2*c], ((0, 0), (0, 1), (0, 0)))[:, 1:, :]
        g2 = _pad(h[:, :, 2*c:3*c], ((0, 0), (2, 0), (0, 0)))[:, :S, :]
        g3 = _pad(h[:, :, 3*c:   ], ((0, 0), (0, 2), (0, 0)))[:, 2:, :]
        hs = torch.concatenate([g0, g1, g2, g3], axis=-1) @ w2
        x1 = x + hs
        h2 = _gelu(_layernorm(x1, axis=-1) @ w3) @ w4
        return x1 + h2

    x = A_x
    g = _sigmoid((x * gate_w).sum(-1, keepdims=True))
    a = _A_ref(x, A_wqkv, A_wo)
    b = _B_ref(x, B_w1, B_w2, B_w3, B_w4)
    return g * a + (1 - g) * b
```

```asm
; @launch kernel=k1_kernel grid=(256,1,1) block=(768,1,1) lds=163840
; @launch kernel=k2_kernel grid=(512,1,1) block=(512,1,1) lds=81920
.amdgcn_target "amdgcn-amd-amdhsa--gfx950"
.set CODE_KB, 61
.text
.p2align 8
code_start:
.globl k1_kernel
.p2align 8
.type k1_kernel,@function
k1_kernel:
    s_cmp_ge_u32 s2, 256
    s_cbranch_scc1 k1_end_1
    s_load_dwordx4 s[4:7], s[0:1], 0
    s_load_dwordx2 s[92:93], s[0:1], 32
    s_load_dwordx2 s[94:95], s[0:1], 48
    s_load_dwordx2 s[98:99], s[0:1], 88
    s_load_dwordx2 s[84:85], s[0:1], 40
    s_load_dwordx2 s[86:87], s[0:1], 56
    s_load_dwordx2 s[88:89], s[0:1], 16
    v_and_b32 v1, 63, v0
    v_lshrrev_b32 v2, 6, v0
    s_nop 0
    v_readfirstlane_b32 s28, v2
    s_and_b32 s35, s2, 7
    s_lshr_b32 s36, s2, 3
    s_lshr_b32 s32, s35, 1
    s_lshl_b32 s32, s32, 2
    s_and_b32 s37, s36, 3
    s_add_u32 s32, s32, s37
    s_and_b32 s33, s35, 1
    s_lshl_b32 s33, s33, 3
    s_lshr_b32 s38, s36, 2
    s_add_u32 s33, s33, s38
    s_lshl_b32 s34, s37, 1
    s_add_u32 s34, s34, s38
    s_and_b32 s34, s34, 7
    s_cmp_lt_u32 s28, 8
    s_cbranch_scc1 k1_cons_2
    s_setprio 3
    s_and_b32 s43, s28, 1
    s_lshl_b32 s44, s43, 13
    s_cmp_ge_u32 s28, 10
    s_cbranch_scc1 k1_pw_3
    v_lshrrev_b32 v2, 4, v1
    v_and_b32 v3, 7, v1
    v_xor_b32 v2, v2, v3
    v_lshrrev_b32 v3, 3, v1
    v_lshlrev_b32 v3, 10, v3
    v_lshl_add_u32 v10, v2, 4, v3
    v_lshrrev_b32 v2, 4, v1
    v_add_u32 v2, 4, v2
    v_and_b32 v3, 7, v1
    v_xor_b32 v2, v2, v3
    v_lshrrev_b32 v3, 3, v1
    v_lshlrev_b32 v3, 10, v3
    v_lshl_add_u32 v11, v2, 4, v3
    s_lshl_b32 s35, s32, 17
    s_lshl_b32 s36, s43, 16
    s_add_u32 s35, s35, s36
    s_mov_b32 s39, s34
    s_waitcnt lgkmcnt(0)
    s_mov_b32 s8, s4
    s_and_b32 s9, s5, 0xffff
    s_mov_b32 s10, 0x200000
    s_mov_b32 s11, 0x00020000
    s_lshl_b32 s40, s39, 7
    s_add_u32 s40, s40, s35
    s_add_u32 m0, s44, 0
    s_nop 0
    buffer_load_dwordx4 v10, s[8:11], s40 offen lds
    s_add_u32 m0, s44, 1024
    s_add_u32 s40, s40, 8192
    buffer_load_dwordx4 v11, s[8:11], s40 offen lds
    s_add_u32 m0, s44, 2048
    s_add_u32 s40, s40, 8192
    buffer_load_dwordx4 v10, s[8:11], s40 offen lds
    s_add_u32 m0, s44, 3072
    s_add_u32 s40, s40, 8192
    buffer_load_dwordx4 v11, s[8:11], s40 offen lds
    s_add_u32 m0, s44, 4096
    s_add_u32 s40, s40, 8192
    buffer_load_dwordx4 v10, s[8:11], s40 offen lds
    s_add_u32 m0, s44, 5120
    s_add_u32 s40, s40, 8192
    buffer_load_dwordx4 v11, s[8:11], s40 offen lds
    s_add_u32 m0, s44, 6144
    s_add_u32 s40, s40, 8192
    buffer_load_dwordx4 v10, s[8:11], s40 offen lds
    s_add_u32 m0, s44, 7168
    s_add_u32 s40, s40, 8192
    buffer_load_dwordx4 v11, s[8:11], s40 offen lds
    s_add_u32 s39, s39, 1
    s_and_b32 s39, s39, 7
    s_lshl_b32 s40, s39, 7
    s_add_u32 s40, s40, s35
    s_add_u32 m0, s44, 32768
    s_nop 0
    buffer_load_dwordx4 v10, s[8:11], s40 offen lds
    s_add_u32 m0, s44, 33792
    s_add_u32 s40, s40, 8192
    buffer_load_dwordx4 v11, s[8:11], s40 offen lds
    s_add_u32 m0, s44, 34816
    s_add_u32 s40, s40, 8192
    buffer_load_dwordx4 v10, s[8:11], s40 offen lds
    s_add_u32 m0, s44, 35840
    s_add_u32 s40, s40, 8192
    buffer_load_dwordx4 v11, s[8:11], s40 offen lds
    s_add_u32 m0, s44, 36864
    s_add_u32 s40, s40, 8192
    buffer_load_dwordx4 v10, s[8:11], s40 offen lds
    s_add_u32 m0, s44, 37888
    s_add_u32 s40, s40, 8192
    buffer_load_dwordx4 v11, s[8:11], s40 offen lds
    s_add_u32 m0, s44, 38912
    s_add_u32 s40, s40, 8192
    buffer_load_dwordx4 v10, s[8:11], s40 offen lds
    s_add_u32 m0, s44, 39936
    s_add_u32 s40, s40, 8192
    buffer_load_dwordx4 v11, s[8:11], s40 offen lds
    s_add_u32 s39, s39, 1
    s_and_b32 s39, s39, 7
    s_waitcnt vmcnt(8)
    s_barrier
    s_lshl_b32 s40, s39, 7
    s_add_u32 s40, s40, s35
    s_add_u32 m0, s44, 65536
    s_nop 0
    buffer_load_dwordx4 v10, s[8:11], s40 offen lds
    s_add_u32 m0, s44, 66560
    s_add_u32 s40, s40, 8192
    buffer_load_dwordx4 v11, s[8:11], s40 offen lds
    s_add_u32 m0, s44, 67584
    s_add_u32 s40, s40, 8192
    buffer_load_dwordx4 v10, s[8:11], s40 offen lds
    s_add_u32 m0, s44, 68608
    s_add_u32 s40, s40, 8192
    buffer_load_dwordx4 v11, s[8:11], s40 offen lds
    s_add_u32 m0, s44, 69632
    s_add_u32 s40, s40, 8192
    buffer_load_dwordx4 v10, s[8:11], s40 offen lds
    s_add_u32 m0, s44, 70656
    s_add_u32 s40, s40, 8192
    buffer_load_dwordx4 v11, s[8:11], s40 offen lds
    s_add_u32 m0, s44, 71680
    s_add_u32 s40, s40, 8192
    buffer_load_dwordx4 v10, s[8:11], s40 offen lds
    s_add_u32 m0, s44, 72704
    s_add_u32 s40, s40, 8192
    buffer_load_dwordx4 v11, s[8:11], s40 offen lds
    s_add_u32 s39, s39, 1
    s_and_b32 s39, s39, 7
    s_lshl_b32 s40, s39, 7
    s_add_u32 s40, s40, s35
    s_add_u32 m0, s44, 98304
    s_nop 0
    buffer_load_dwordx4 v10, s[8:11], s40 offen lds
    s_add_u32 m0, s44, 99328
    s_add_u32 s40, s40, 8192
    buffer_load_dwordx4 v11, s[8:11], s40 offen lds
    s_add_u32 m0, s44, 100352
    s_add_u32 s40, s40, 8192
    buffer_load_dwordx4 v10, s[8:11], s40 offen lds
    s_add_u32 m0, s44, 101376
    s_add_u32 s40, s40, 8192
    buffer_load_dwordx4 v11, s[8:11], s40 offen lds
    s_add_u32 m0, s44, 102400
    s_add_u32 s40, s40, 8192
    buffer_load_dwordx4 v10, s[8:11], s40 offen lds
    s_add_u32 m0, s44, 103424
    s_add_u32 s40, s40, 8192
    buffer_load_dwordx4 v11, s[8:11], s40 offen lds
    s_add_u32 m0, s44, 104448
    s_add_u32 s40, s40, 8192
    buffer_load_dwordx4 v10, s[8:11], s40 offen lds
    s_add_u32 m0, s44, 105472
    s_add_u32 s40, s40, 8192
    buffer_load_dwordx4 v11, s[8:11], s40 offen lds
    s_add_u32 s39, s39, 1
    s_and_b32 s39, s39, 7
    s_waitcnt vmcnt(16)
    s_barrier
    s_lshl_b32 s40, s39, 7
    s_add_u32 s40, s40, s35
    s_add_u32 m0, s44, 131072
    s_nop 0
    buffer_load_dwordx4 v10, s[8:11], s40 offen lds
    s_add_u32 m0, s44, 132096
    s_add_u32 s40, s40, 8192
    buffer_load_dwordx4 v11, s[8:11], s40 offen lds
    s_add_u32 m0, s44, 133120
    s_add_u32 s40, s40, 8192
    buffer_load_dwordx4 v10, s[8:11], s40 offen lds
    s_add_u32 m0, s44, 134144
    s_add_u32 s40, s40, 8192
    buffer_load_dwordx4 v11, s[8:11], s40 offen lds
    s_add_u32 m0, s44, 135168
    s_add_u32 s40, s40, 8192
    buffer_load_dwordx4 v10, s[8:11], s40 offen lds
    s_add_u32 m0, s44, 136192
    s_add_u32 s40, s40, 8192
    buffer_load_dwordx4 v11, s[8:11], s40 offen lds
    s_add_u32 m0, s44, 137216
    s_add_u32 s40, s40, 8192
    buffer_load_dwordx4 v10, s[8:11], s40 offen lds
    s_add_u32 m0, s44, 138240
    s_add_u32 s40, s40, 8192
    buffer_load_dwordx4 v11, s[8:11], s40 offen lds
    s_add_u32 s39, s39, 1
    s_and_b32 s39, s39, 7
    s_waitcnt vmcnt(16)
    s_barrier
    s_lshl_b32 s40, s39, 7
    s_add_u32 s40, s40, s35
    s_add_u32 m0, s44, 0
    s_nop 0
    buffer_load_dwordx4 v10, s[8:11], s40 offen lds
    s_add_u32 m0, s44, 1024
    s_add_u32 s40, s40, 8192
    buffer_load_dwordx4 v11, s[8:11], s40 offen lds
    s_add_u32 m0, s44, 2048
    s_add_u32 s40, s40, 8192
    buffer_load_dwordx4 v10, s[8:11], s40 offen lds
    s_add_u32 m0, s44, 3072
    s_add_u32 s40, s40, 8192
    buffer_load_dwordx4 v11, s[8:11], s40 offen lds
    s_add_u32 m0, s44, 4096
    s_add_u32 s40, s40, 8192
    buffer_load_dwordx4 v10, s[8:11], s40 offen lds
    s_add_u32 m0, s44, 5120
    s_add_u32 s40, s40, 8192
    buffer_load_dwordx4 v11, s[8:11], s40 offen lds
    s_add_u32 m0, s44, 6144
    s_add_u32 s40, s40, 8192
    buffer_load_dwordx4 v10, s[8:11], s40 offen lds
    s_add_u32 m0, s44, 7168
    s_add_u32 s40, s40, 8192
    buffer_load_dwordx4 v11, s[8:11], s40 offen lds
    s_add_u32 s39, s39, 1
    s_and_b32 s39, s39, 7
    s_waitcnt vmcnt(16)
    s_barrier
    s_lshl_b32 s40, s39, 7
    s_add_u32 s40, s40, s35
    s_add_u32 m0, s44, 32768
    s_nop 0
    buffer_load_dwordx4 v10, s[8:11], s40 offen lds
    s_add_u32 m0, s44, 33792
    s_add_u32 s40, s40, 8192
    buffer_load_dwordx4 v11, s[8:11], s40 offen lds
    s_add_u32 m0, s44, 34816
    s_add_u32 s40, s40, 8192
    buffer_load_dwordx4 v10, s[8:11], s40 offen lds
    s_add_u32 m0, s44, 35840
    s_add_u32 s40, s40, 8192
    buffer_load_dwordx4 v11, s[8:11], s40 offen lds
    s_add_u32 m0, s44, 36864
    s_add_u32 s40, s40, 8192
    buffer_load_dwordx4 v10, s[8:11], s40 offen lds
    s_add_u32 m0, s44, 37888
    s_add_u32 s40, s40, 8192
    buffer_load_dwordx4 v11, s[8:11], s40 offen lds
    s_add_u32 m0, s44, 38912
    s_add_u32 s40, s40, 8192
    buffer_load_dwordx4 v10, s[8:11], s40 offen lds
    s_add_u32 m0, s44, 39936
    s_add_u32 s40, s40, 8192
    buffer_load_dwordx4 v11, s[8:11], s40 offen lds
    s_add_u32 s39, s39, 1
    s_and_b32 s39, s39, 7
    s_waitcnt vmcnt(16)
    s_barrier
    s_lshl_b32 s40, s39, 7
    s_add_u32 s40, s40, s35
    s_add_u32 m0, s44, 65536
    s_nop 0
    buffer_load_dwordx4 v10, s[8:11], s40 offen lds
    s_add_u32 m0, s44, 66560
    s_add_u32 s40, s40, 8192
    buffer_load_dwordx4 v11, s[8:11], s40 offen lds
    s_add_u32 m0, s44, 67584
    s_add_u32 s40, s40, 8192
    buffer_load_dwordx4 v10, s[8:11], s40 offen lds
    s_add_u32 m0, s44, 68608
    s_add_u32 s40, s40, 8192
    buffer_load_dwordx4 v11, s[8:11], s40 offen lds
    s_add_u32 m0, s44, 69632
    s_add_u32 s40, s40, 8192
    buffer_load_dwordx4 v10, s[8:11], s40 offen lds
    s_add_u32 m0, s44, 70656
    s_add_u32 s40, s40, 8192
    buffer_load_dwordx4 v11, s[8:11], s40 offen lds
    s_add_u32 m0, s44, 71680
    s_add_u32 s40, s40, 8192
    buffer_load_dwordx4 v10, s[8:11], s40 offen lds
    s_add_u32 m0, s44, 72704
    s_add_u32 s40, s40, 8192
    buffer_load_dwordx4 v11, s[8:11], s40 offen lds
    s_add_u32 s39, s39, 1
    s_and_b32 s39, s39, 7
    s_mov_b32 s24, s94
    s_and_b32 s25, s95, 0xffff
    s_mov_b32 s26, 0x1c0000
    s_mov_b32 s27, 0x00020000
    s_mul_hi_u32 s36, s2, 153391690
    s_mul_i32 s37, s36, 28
    s_sub_u32 s37, s2, s37
    s_lshl_b32 s38, s36, 2
    s_add_u32 s38, s38, s28
    s_sub_u32 s38, s38, 8
    s_mul_i32 s40, s38, 229376
    s_lshl_b32 s39, s37, 7
    s_add_u32 s40, s40, s39
    s_cmp_lt_u32 s2, 56
    s_cselect_b32 s40, s40, 0x7f000000
    v_lshrrev_b32 v72, 3, v1
    v_mul_u32_u24 v72, 3584, v72
    v_and_b32 v2, 7, v1
    v_lshl_add_u32 v72, v2, 4, v72
    buffer_load_dwordx4 v[24:27], v72, s[24:27], s40 offen
    s_add_u32 s40, s40, 28672
    buffer_load_dwordx4 v[28:31], v72, s[24:27], s40 offen
    s_add_u32 s40, s40, 28672
    buffer_load_dwordx4 v[32:35], v72, s[24:27], s40 offen
    s_add_u32 s40, s40, 28672
    buffer_load_dwordx4 v[36:39], v72, s[24:27], s40 offen
    s_add_u32 s40, s40, 28672
    buffer_load_dwordx4 v[40:43], v72, s[24:27], s40 offen
    s_add_u32 s40, s40, 28672
    buffer_load_dwordx4 v[44:47], v72, s[24:27], s40 offen
    s_add_u32 s40, s40, 28672
    buffer_load_dwordx4 v[48:51], v72, s[24:27], s40 offen
    s_add_u32 s40, s40, 28672
    buffer_load_dwordx4 v[52:55], v72, s[24:27], s40 offen
    v_lshlrev_b32 v2, 4, v1
    s_lshr_b32 s39, s2, 3
    s_lshl_b32 s39, s39, 2
    s_add_u32 s39, s39, s28
    s_sub_u32 s39, s39, 8
    s_mov_b32 s20, s84
    s_and_b32 s21, s85, 0xffff
    s_mov_b32 s22, 0x80000
    s_mov_b32 s23, 0x00020000
    s_mul_i32 s40, s39, 4096
    buffer_load_dwordx4 v[64:67], v2, s[20:23], s40 offen offset:0
    buffer_load_dwordx4 v[68:71], v2, s[20:23], s40 offen offset:1024
    buffer_load_dwordx4 v[64:67], v2, s[20:23], s40 offen offset:2048
    buffer_load_dwordx4 v[68:71], v2, s[20:23], s40 offen offset:3072
    s_waitcnt vmcnt(28)
    s_barrier
    s_waitcnt vmcnt(20)
    s_barrier
    s_waitcnt vmcnt(12)
    s_barrier
    s_barrier
    s_branch k1_pside_4
k1_pw_3:
    v_lshrrev_b32 v2, 4, v1
    v_lshlrev_b32 v3, 2, v2
    v_and_b32 v4, 15, v1
    v_xor_b32 v3, v3, v4
    v_cmp_gt_u32 vcc, 12, v3
    v_mov_b32 v4, 1024
    v_mov_b32 v5, 3072
    v_cndmask_b32 v14, v4, v5, vcc
    v_mul_u32_u24 v2, v2, v14
    v_lshl_add_u32 v2, v3, 4, v2
    s_mul_i32 s35, s33, 192
    s_lshl_b32 s36, s33, 6
    s_sub_u32 s36, s36, 192
    v_mov_b32 v4, s36
    v_mov_b32 v5, s35
    v_cndmask_b32 v4, v4, v5, vcc
    v_add_u32 v2, v2, v4
    s_mov_b32 s39, s34
    s_waitcnt lgkmcnt(0)
    v_mov_b32 v4, s92
    v_mov_b32 v5, s6
    v_cndmask_b32 v12, v4, v5, vcc
    v_mov_b32 v4, s93
    v_mov_b32 v5, s7
    v_cndmask_b32 v13, v4, v5, vcc
    v_add_co_u32 v12, vcc, v12, v2
    s_nop 1
    v_addc_co_u32 v13, vcc, 0, v13, vcc
    s_lshl_b32 s40, s39, 6
    s_lshl_b32 s35, s43, 5
    s_add_u32 s40, s40, s35
    v_mad_u64_u32 v[16:17], vcc, v14, s40, v[12:13]
    s_add_u32 m0, s44, 16384
    s_add_u32 s40, s40, 4
    global_load_lds_dwordx4 v[16:17], off
    v_mad_u64_u32 v[18:19], vcc, v14, s40, v[12:13]
    s_add_u32 m0, s44, 17408
    s_add_u32 s40, s40, 4
    global_load_lds_dwordx4 v[18:19], off
    v_mad_u64_u32 v[20:21], vcc, v14, s40, v[12:13]
    s_add_u32 m0, s44, 18432
    s_add_u32 s40, s40, 4
    global_load_lds_dwordx4 v[20:21], off
    v_mad_u64_u32 v[22:23], vcc, v14, s40, v[12:13]
    s_add_u32 m0, s44, 19456
    s_add_u32 s40, s40, 4
    global_load_lds_dwordx4 v[22:23], off
    v_mad_u64_u32 v[16:17], vcc, v14, s40, v[12:13]
    s_add_u32 m0, s44, 20480
    s_add_u32 s40, s40, 4
    global_load_lds_dwordx4 v[16:17], off
    v_mad_u64_u32 v[18:19], vcc, v14, s40, v[12:13]
    s_add_u32 m0, s44, 21504
    s_add_u32 s40, s40, 4
    global_load_lds_dwordx4 v[18:19], off
    v_mad_u64_u32 v[20:21], vcc, v14, s40, v[12:13]
    s_add_u32 m0, s44, 22528
    s_add_u32 s40, s40, 4
    global_load_lds_dwordx4 v[20:21], off
    v_mad_u64_u32 v[22:23], vcc, v14, s40, v[12:13]
    s_add_u32 m0, s44, 23552
    s_add_u32 s40, s40, 4
    global_load_lds_dwordx4 v[22:23], off
    s_add_u32 s39, s39, 1
    s_and_b32 s39, s39, 7
    s_lshl_b32 s40, s39, 6
    s_lshl_b32 s35, s43, 5
    s_add_u32 s40, s40, s35
    v_mad_u64_u32 v[16:17], vcc, v14, s40, v[12:13]
    s_add_u32 m0, s44, 49152
    s_add_u32 s40, s40, 4
    global_load_lds_dwordx4 v[16:17], off
    v_mad_u64_u32 v[18:19], vcc, v14, s40, v[12:13]
    s_add_u32 m0, s44, 50176
    s_add_u32 s40, s40, 4
    global_load_lds_dwordx4 v[18:19], off
    v_mad_u64_u32 v[20:21], vcc, v14, s40, v[12:13]
    s_add_u32 m0, s44, 51200
    s_add_u32 s40, s40, 4
    global_load_lds_dwordx4 v[20:21], off
    v_mad_u64_u32 v[22:23], vcc, v14, s40, v[12:13]
    s_add_u32 m0, s44, 52224
    s_add_u32 s40, s40, 4
    global_load_lds_dwordx4 v[22:23], off
    v_mad_u64_u32 v[16:17], vcc, v14, s40, v[12:13]
    s_add_u32 m0, s44, 53248
    s_add_u32 s40, s40, 4
    global_load_lds_dwordx4 v[16:17], off
    v_mad_u64_u32 v[18:19], vcc, v14, s40, v[12:13]
    s_add_u32 m0, s44, 54272
    s_add_u32 s40, s40, 4
    global_load_lds_dwordx4 v[18:19], off
    v_mad_u64_u32 v[20:21], vcc, v14, s40, v[12:13]
    s_add_u32 m0, s44, 55296
    s_add_u32 s40, s40, 4
    global_load_lds_dwordx4 v[20:21], off
    v_mad_u64_u32 v[22:23], vcc, v14, s40, v[12:13]
    s_add_u32 m0, s44, 56320
    s_add_u32 s40, s40, 4
    global_load_lds_dwordx4 v[22:23], off
    s_add_u32 s39, s39, 1
    s_and_b32 s39, s39, 7
    s_waitcnt vmcnt(8)
    s_barrier
    s_lshl_b32 s40, s39, 6
    s_lshl_b32 s35, s43, 5
    s_add_u32 s40, s40, s35
    v_mad_u64_u32 v[16:17], vcc, v14, s40, v[12:13]
    s_add_u32 m0, s44, 81920
    s_add_u32 s40, s40, 4
    global_load_lds_dwordx4 v[16:17], off
    v_mad_u64_u32 v[18:19], vcc, v14, s40, v[12:13]
    s_add_u32 m0, s44, 82944
    s_add_u32 s40, s40, 4
    global_load_lds_dwordx4 v[18:19], off
    v_mad_u64_u32 v[20:21], vcc, v14, s40, v[12:13]
    s_add_u32 m0, s44, 83968
    s_add_u32 s40, s40, 4
    global_load_lds_dwordx4 v[20:21], off
    v_mad_u64_u32 v[22:23], vcc, v14, s40, v[12:13]
    s_add_u32 m0, s44, 84992
    s_add_u32 s40, s40, 4
    global_load_lds_dwordx4 v[22:23], off
    v_mad_u64_u32 v[16:17], vcc, v14, s40, v[12:13]
    s_add_u32 m0, s44, 86016
    s_add_u32 s40, s40, 4
    global_load_lds_dwordx4 v[16:17], off
    v_mad_u64_u32 v[18:19], vcc, v14, s40, v[12:13]
    s_add_u32 m0, s44, 87040
    s_add_u32 s40, s40, 4
    global_load_lds_dwordx4 v[18:19], off
    v_mad_u64_u32 v[20:21], vcc, v14, s40, v[12:13]
    s_add_u32 m0, s44, 88064
    s_add_u32 s40, s40, 4
    global_load_lds_dwordx4 v[20:21], off
    v_mad_u64_u32 v[22:23], vcc, v14, s40, v[12:13]
    s_add_u32 m0, s44, 89088
    s_add_u32 s40, s40, 4
    global_load_lds_dwordx4 v[22:23], off
    s_add_u32 s39, s39, 1
    s_and_b32 s39, s39, 7
    s_lshl_b32 s40, s39, 6
    s_lshl_b32 s35, s43, 5
    s_add_u32 s40, s40, s35
    v_mad_u64_u32 v[16:17], vcc, v14, s40, v[12:13]
    s_add_u32 m0, s44, 114688
    s_add_u32 s40, s40, 4
    global_load_lds_dwordx4 v[16:17], off
    v_mad_u64_u32 v[18:19], vcc, v14, s40, v[12:13]
    s_add_u32 m0, s44, 115712
    s_add_u32 s40, s40, 4
    global_load_lds_dwordx4 v[18:19], off
    v_mad_u64_u32 v[20:21], vcc, v14, s40, v[12:13]
    s_add_u32 m0, s44, 116736
    s_add_u32 s40, s40, 4
    global_load_lds_dwordx4 v[20:21], off
    v_mad_u64_u32 v[22:23], vcc, v14, s40, v[12:13]
    s_add_u32 m0, s44, 117760
    s_add_u32 s40, s40, 4
    global_load_lds_dwordx4 v[22:23], off
    v_mad_u64_u32 v[16:17], vcc, v14, s40, v[12:13]
    s_add_u32 m0, s44, 118784
    s_add_u32 s40, s40, 4
    global_load_lds_dwordx4 v[16:17], off
    v_mad_u64_u32 v[18:19], vcc, v14, s40, v[12:13]
    s_add_u32 m0, s44, 119808
    s_add_u32 s40, s40, 4
    global_load_lds_dwordx4 v[18:19], off
    v_mad_u64_u32 v[20:21], vcc, v14, s40, v[12:13]
    s_add_u32 m0, s44, 120832
    s_add_u32 s40, s40, 4
    global_load_lds_dwordx4 v[20:21], off
    v_mad_u64_u32 v[22:23], vcc, v14, s40, v[12:13]
    s_add_u32 m0, s44, 121856
    s_add_u32 s40, s40, 4
    global_load_lds_dwordx4 v[22:23], off
    s_add_u32 s39, s39, 1
    s_and_b32 s39, s39, 7
    s_waitcnt vmcnt(16)
    s_barrier
    s_lshl_b32 s40, s39, 6
    s_lshl_b32 s35, s43, 5
    s_add_u32 s40, s40, s35
    v_mad_u64_u32 v[16:17], vcc, v14, s40, v[12:13]
    s_add_u32 m0, s44, 147456
    s_add_u32 s40, s40, 4
    global_load_lds_dwordx4 v[16:17], off
    v_mad_u64_u32 v[18:19], vcc, v14, s40, v[12:13]
    s_add_u32 m0, s44, 148480
    s_add_u32 s40, s40, 4
    global_load_lds_dwordx4 v[18:19], off
    v_mad_u64_u32 v[20:21], vcc, v14, s40, v[12:13]
    s_add_u32 m0, s44, 149504
    s_add_u32 s40, s40, 4
    global_load_lds_dwordx4 v[20:21], off
    v_mad_u64_u32 v[22:23], vcc, v14, s40, v[12:13]
    s_add_u32 m0, s44, 150528
    s_add_u32 s40, s40, 4
    global_load_lds_dwordx4 v[22:23], off
    v_mad_u64_u32 v[16:17], vcc, v14, s40, v[12:13]
    s_add_u32 m0, s44, 151552
    s_add_u32 s40, s40, 4
    global_load_lds_dwordx4 v[16:17], off
    v_mad_u64_u32 v[18:19], vcc, v14, s40, v[12:13]
    s_add_u32 m0, s44, 152576
    s_add_u32 s40, s40, 4
    global_load_lds_dwordx4 v[18:19], off
    v_mad_u64_u32 v[20:21], vcc, v14, s40, v[12:13]
    s_add_u32 m0, s44, 153600
    s_add_u32 s40, s40, 4
    global_load_lds_dwordx4 v[20:21], off
    v_mad_u64_u32 v[22:23], vcc, v14, s40, v[12:13]
    s_add_u32 m0, s44, 154624
    s_add_u32 s40, s40, 4
    global_load_lds_dwordx4 v[22:23], off
    s_add_u32 s39, s39, 1
    s_and_b32 s39, s39, 7
    s_waitcnt vmcnt(16)
    s_barrier
    s_lshl_b32 s40, s39, 6
    s_lshl_b32 s35, s43, 5
    s_add_u32 s40, s40, s35
    v_mad_u64_u32 v[16:17], vcc, v14, s40, v[12:13]
    s_add_u32 m0, s44, 16384
    s_add_u32 s40, s40, 4
    global_load_lds_dwordx4 v[16:17], off
    v_mad_u64_u32 v[18:19], vcc, v14, s40, v[12:13]
    s_add_u32 m0, s44, 17408
    s_add_u32 s40, s40, 4
    global_load_lds_dwordx4 v[18:19], off
    v_mad_u64_u32 v[20:21], vcc, v14, s40, v[12:13]
    s_add_u32 m0, s44, 18432
    s_add_u32 s40, s40, 4
    global_load_lds_dwordx4 v[20:21], off
    v_mad_u64_u32 v[22:23], vcc, v14, s40, v[12:13]
    s_add_u32 m0, s44, 19456
    s_add_u32 s40, s40, 4
    global_load_lds_dwordx4 v[22:23], off
    v_mad_u64_u32 v[16:17], vcc, v14, s40, v[12:13]
    s_add_u32 m0, s44, 20480
    s_add_u32 s40, s40, 4
    global_load_lds_dwordx4 v[16:17], off
    v_mad_u64_u32 v[18:19], vcc, v14, s40, v[12:13]
    s_add_u32 m0, s44, 21504
    s_add_u32 s40, s40, 4
    global_load_lds_dwordx4 v[18:19], off
    v_mad_u64_u32 v[20:21], vcc, v14, s40, v[12:13]
    s_add_u32 m0, s44, 22528
    s_add_u32 s40, s40, 4
    global_load_lds_dwordx4 v[20:21], off
    v_mad_u64_u32 v[22:23], vcc, v14, s40, v[12:13]
    s_add_u32 m0, s44, 23552
    s_add_u32 s40, s40, 4
    global_load_lds_dwordx4 v[22:23], off
    s_add_u32 s39, s39, 1
    s_and_b32 s39, s39, 7
    s_waitcnt vmcnt(16)
    s_barrier
    s_lshl_b32 s40, s39, 6
    s_lshl_b32 s35, s43, 5
    s_add_u32 s40, s40, s35
    v_mad_u64_u32 v[16:17], vcc, v14, s40, v[12:13]
    s_add_u32 m0, s44, 49152
    s_add_u32 s40, s40, 4
    global_load_lds_dwordx4 v[16:17], off
    v_mad_u64_u32 v[18:19], vcc, v14, s40, v[12:13]
    s_add_u32 m0, s44, 50176
    s_add_u32 s40, s40, 4
    global_load_lds_dwordx4 v[18:19], off
    v_mad_u64_u32 v[20:21], vcc, v14, s40, v[12:13]
    s_add_u32 m0, s44, 51200
    s_add_u32 s40, s40, 4
    global_load_lds_dwordx4 v[20:21], off
    v_mad_u64_u32 v[22:23], vcc, v14, s40, v[12:13]
    s_add_u32 m0, s44, 52224
    s_add_u32 s40, s40, 4
    global_load_lds_dwordx4 v[22:23], off
    v_mad_u64_u32 v[16:17], vcc, v14, s40, v[12:13]
    s_add_u32 m0, s44, 53248
    s_add_u32 s40, s40, 4
    global_load_lds_dwordx4 v[16:17], off
    v_mad_u64_u32 v[18:19], vcc, v14, s40, v[12:13]
    s_add_u32 m0, s44, 54272
    s_add_u32 s40, s40, 4
    global_load_lds_dwordx4 v[18:19], off
    v_mad_u64_u32 v[20:21], vcc, v14, s40, v[12:13]
    s_add_u32 m0, s44, 55296
    s_add_u32 s40, s40, 4
    global_load_lds_dwordx4 v[20:21], off
    v_mad_u64_u32 v[22:23], vcc, v14, s40, v[12:13]
    s_add_u32 m0, s44, 56320
    s_add_u32 s40, s40, 4
    global_load_lds_dwordx4 v[22:23], off
    s_add_u32 s39, s39, 1
    s_and_b32 s39, s39, 7
    s_waitcnt vmcnt(16)
    s_barrier
    s_lshl_b32 s40, s39, 6
    s_lshl_b32 s35, s43, 5
    s_add_u32 s40, s40, s35
    v_mad_u64_u32 v[16:17], vcc, v14, s40, v[12:13]
    s_add_u32 m0, s44, 81920
    s_add_u32 s40, s40, 4
    global_load_lds_dwordx4 v[16:17], off
    v_mad_u64_u32 v[18:19], vcc, v14, s40, v[12:13]
    s_add_u32 m0, s44, 82944
    s_add_u32 s40, s40, 4
    global_load_lds_dwordx4 v[18:19], off
    v_mad_u64_u32 v[20:21], vcc, v14, s40, v[12:13]
    s_add_u32 m0, s44, 83968
    s_add_u32 s40, s40, 4
    global_load_lds_dwordx4 v[20:21], off
    v_mad_u64_u32 v[22:23], vcc, v14, s40, v[12:13]
    s_add_u32 m0, s44, 84992
    s_add_u32 s40, s40, 4
    global_load_lds_dwordx4 v[22:23], off
    v_mad_u64_u32 v[16:17], vcc, v14, s40, v[12:13]
    s_add_u32 m0, s44, 86016
    s_add_u32 s40, s40, 4
    global_load_lds_dwordx4 v[16:17], off
    v_mad_u64_u32 v[18:19], vcc, v14, s40, v[12:13]
    s_add_u32 m0, s44, 87040
    s_add_u32 s40, s40, 4
    global_load_lds_dwordx4 v[18:19], off
    v_mad_u64_u32 v[20:21], vcc, v14, s40, v[12:13]
    s_add_u32 m0, s44, 88064
    s_add_u32 s40, s40, 4
    global_load_lds_dwordx4 v[20:21], off
    v_mad_u64_u32 v[22:23], vcc, v14, s40, v[12:13]
    s_add_u32 m0, s44, 89088
    s_add_u32 s40, s40, 4
    global_load_lds_dwordx4 v[22:23], off
    s_add_u32 s39, s39, 1
    s_and_b32 s39, s39, 7
    s_mov_b32 s24, s94
    s_and_b32 s25, s95, 0xffff
    s_mov_b32 s26, 0x1c0000
    s_mov_b32 s27, 0x00020000
    s_mul_hi_u32 s36, s2, 153391690
    s_mul_i32 s37, s36, 28
    s_sub_u32 s37, s2, s37
    s_lshl_b32 s38, s36, 2
    s_add_u32 s38, s38, s28
    s_sub_u32 s38, s38, 8
    s_mul_i32 s40, s38, 229376
    s_lshl_b32 s39, s37, 7
    s_add_u32 s40, s40, s39
    s_cmp_lt_u32 s2, 56
    s_cselect_b32 s40, s40, 0x7f000000
    v_lshrrev_b32 v72, 3, v1
    v_mul_u32_u24 v72, 3584, v72
    v_and_b32 v2, 7, v1
    v_lshl_add_u32 v72, v2, 4, v72
    buffer_load_dwordx4 v[24:27], v72, s[24:27], s40 offen
    s_add_u32 s40, s40, 28672
    buffer_load_dwordx4 v[28:31], v72, s[24:27], s40 offen
    s_add_u32 s40, s40, 28672
    buffer_load_dwordx4 v[32:35], v72, s[24:27], s40 offen
    s_add_u32 s40, s40, 28672
    buffer_load_dwordx4 v[36:39], v72, s[24:27], s40 offen
    s_add_u32 s40, s40, 28672
    buffer_load_dwordx4 v[40:43], v72, s[24:27], s40 offen
    s_add_u32 s40, s40, 28672
    buffer_load_dwordx4 v[44:47], v72, s[24:27], s40 offen
    s_add_u32 s40, s40, 28672
    buffer_load_dwordx4 v[48:51], v72, s[24:27], s40 offen
    s_add_u32 s40, s40, 28672
    buffer_load_dwordx4 v[52:55], v72, s[24:27], s40 offen
    v_lshlrev_b32 v2, 4, v1
    s_lshr_b32 s39, s2, 3
    s_lshl_b32 s39, s39, 2
    s_add_u32 s39, s39, s28
    s_sub_u32 s39, s39, 8
    s_mov_b32 s20, s84
    s_and_b32 s21, s85, 0xffff
    s_mov_b32 s22, 0x80000
    s_mov_b32 s23, 0x00020000
    s_mul_i32 s40, s39, 4096
    buffer_load_dwordx4 v[64:67], v2, s[20:23], s40 offen offset:0
    buffer_load_dwordx4 v[68:71], v2, s[20:23], s40 offen offset:1024
    buffer_load_dwordx4 v[64:67], v2, s[20:23], s40 offen offset:2048
    buffer_load_dwordx4 v[68:71], v2, s[20:23], s40 offen offset:3072
    s_waitcnt vmcnt(28)
    s_barrier
    s_waitcnt vmcnt(20)
    s_barrier
    s_waitcnt vmcnt(12)
    s_barrier
    s_barrier
k1_pside_4:
    s_mov_b32 s16, s98
    s_and_b32 s17, s99, 0xffff
    s_mov_b32 s18, 0x10000000
    s_mov_b32 s19, 0x00020000
    s_cmp_lg_u32 s2, 100
    s_cbranch_scc1 k1_noz_5
    v_mov_b32 v56, 0
    v_mov_b32 v57, 0
    v_mov_b32 v58, 0
    v_mov_b32 v59, 0
    s_sub_u32 s35, s28, 8
    s_lshl_b32 s35, s35, 12
    s_add_u32 s35, s35, 25165824
    v_lshlrev_b32 v2, 4, v1
    buffer_store_dwordx4 v[56:59], v2, s[16:19], s35 offen offset:0
    buffer_store_dwordx4 v[56:59], v2, s[16:19], s35 offen offset:1024
    buffer_store_dwordx4 v[56:59], v2, s[16:19], s35 offen offset:2048
    buffer_store_dwordx4 v[56:59], v2, s[16:19], s35 offen offset:3072
k1_noz_5:
    s_cmp_ge_u32 s2, 56
    s_cbranch_scc1 k1_end_1
    s_mov_b32 s35, 0x00003f80
    s_mov_b32 s36, 0x3f800000
    v_mov_b32 v56, 0
    v_mov_b32 v57, 0
    v_mov_b32 v58, 0
    v_mov_b32 v59, 0
    v_mov_b32 v60, 0
    v_mov_b32 v61, 0
    v_mov_b32 v62, 0
    v_mov_b32 v63, 0
    s_waitcnt vmcnt(4)
    v_dot2_f32_bf16 v56, v24, s35, v56
    v_dot2_f32_bf16 v57, v24, s36, v57
    v_dot2_f32_bf16 v58, v25, s35, v58
    v_dot2_f32_bf16 v59, v25, s36, v59
    v_dot2_f32_bf16 v60, v26, s35, v60
    v_dot2_f32_bf16 v61, v26, s36, v61
    v_dot2_f32_bf16 v62, v27, s35, v62
    v_dot2_f32_bf16 v63, v27, s36, v63
    v_dot2_f32_bf16 v56, v28, s35, v56
    v_dot2_f32_bf16 v57, v28, s36, v57
    v_dot2_f32_bf16 v58, v29, s35, v58
    v_dot2_f32_bf16 v59, v29, s36, v59
    v_dot2_f32_bf16 v60, v30, s35, v60
    v_dot2_f32_bf16 v61, v30, s36, v61
    v_dot2_f32_bf16 v62, v31, s35, v62
    v_dot2_f32_bf16 v63, v31, s36, v63
    v_dot2_f32_bf16 v56, v32, s35, v56
    v_dot2_f32_bf16 v57, v32, s36, v57
    v_dot2_f32_bf16 v58, v33, s35, v58
    v_dot2_f32_bf16 v59, v33, s36, v59
    v_dot2_f32_bf16 v60, v34, s35, v60
    v_dot2_f32_bf16 v61, v34, s36, v61
    v_dot2_f32_bf16 v62, v35, s35, v62
    v_dot2_f32_bf16 v63, v35, s36, v63
    v_dot2_f32_bf16 v56, v36, s35, v56
    v_dot2_f32_bf16 v57, v36, s36, v57
    v_dot2_f32_bf16 v58, v37, s35, v58
    v_dot2_f32_bf16 v59, v37, s36, v59
    v_dot2_f32_bf16 v60, v38, s35, v60
    v_dot2_f32_bf16 v61, v38, s36, v61
    v_dot2_f32_bf16 v62, v39, s35, v62
    v_dot2_f32_bf16 v63, v39, s36, v63
    v_dot2_f32_bf16 v56, v40, s35, v56
    v_dot2_f32_bf16 v57, v40, s36, v57
    v_dot2_f32_bf16 v58, v41, s35, v58
    v_dot2_f32_bf16 v59, v41, s36, v59
    v_dot2_f32_bf16 v60, v42, s35, v60
    v_dot2_f32_bf16 v61, v42, s36, v61
    v_dot2_f32_bf16 v62, v43, s35, v62
    v_dot2_f32_bf16 v63, v43, s36, v63
    v_dot2_f32_bf16 v56, v44, s35, v56
    v_dot2_f32_bf16 v57, v44, s36, v57
    v_dot2_f32_bf16 v58, v45, s35, v58
    v_dot2_f32_bf16 v59, v45, s36, v59
    v_dot2_f32_bf16 v60, v46, s35, v60
    v_dot2_f32_bf16 v61, v46, s36, v61
    v_dot2_f32_bf16 v62, v47, s35, v62
    v_dot2_f32_bf16 v63, v47, s36, v63
    v_dot2_f32_bf16 v56, v48, s35, v56
    v_dot2_f32_bf16 v57, v48, s36, v57
    v_dot2_f32_bf16 v58, v49, s35, v58
    v_dot2_f32_bf16 v59, v49, s36, v59
    v_dot2_f32_bf16 v60, v50, s35, v60
    v_dot2_f32_bf16 v61, v50, s36, v61
    v_dot2_f32_bf16 v62, v51, s35, v62
    v_dot2_f32_bf16 v63, v51, s36, v63
    v_dot2_f32_bf16 v56, v52, s35, v56
    v_dot2_f32_bf16 v57, v52, s36, v57
    v_dot2_f32_bf16 v58, v53, s35, v58
    v_dot2_f32_bf16 v59, v53, s36, v59
    v_dot2_f32_bf16 v60, v54, s35, v60
    v_dot2_f32_bf16 v61, v54, s36, v61
    v_dot2_f32_bf16 v62, v55, s35, v62
    v_dot2_f32_bf16 v63, v55, s36, v63
    s_nop 3
    v_add_f32_dpp v56, v56, v56 row_ror:8 row_mask:0xf bank_mask:0xf
    v_add_f32_dpp v57, v57, v57 row_ror:8 row_mask:0xf bank_mask:0xf
    v_add_f32_dpp v58, v58, v58 row_ror:8 row_mask:0xf bank_mask:0xf
    v_add_f32_dpp v59, v59, v59 row_ror:8 row_mask:0xf bank_mask:0xf
    v_add_f32_dpp v60, v60, v60 row_ror:8 row_mask:0xf bank_mask:0xf
    v_add_f32_dpp v61, v61, v61 row_ror:8 row_mask:0xf bank_mask:0xf
    v_add_f32_dpp v62, v62, v62 row_ror:8 row_mask:0xf bank_mask:0xf
    v_add_f32_dpp v63, v63, v63 row_ror:8 row_mask:0xf bank_mask:0xf
    v_mov_b32 v24, v56
    v_mov_b32 v25, v57
    v_mov_b32 v26, v58
    v_mov_b32 v27, v59
    v_mov_b32 v28, v60
    v_mov_b32 v29, v61
    v_mov_b32 v30, v62
    v_mov_b32 v31, v63
    s_nop 1
    v_permlane16_swap_b32 v24, v56
    v_permlane16_swap_b32 v25, v57
    v_permlane16_swap_b32 v26, v58
    v_permlane16_swap_b32 v27, v59
    v_permlane16_swap_b32 v28, v60
    v_permlane16_swap_b32 v29, v61
    v_permlane16_swap_b32 v30, v62
    v_permlane16_swap_b32 v31, v63
    v_add_f32 v56, v56, v24
    v_add_f32 v57, v57, v25
    v_add_f32 v58, v58, v26
    v_add_f32 v59, v59, v27
    v_add_f32 v60, v60, v28
    v_add_f32 v61, v61, v29
    v_add_f32 v62, v62, v30
    v_add_f32 v63, v63, v31
    v_mov_b32 v24, v56
    v_mov_b32 v25, v57
    v_mov_b32 v26, v58
    v_mov_b32 v27, v59
    v_mov_b32 v28, v60
    v_mov_b32 v29, v61
    v_mov_b32 v30, v62
    v_mov_b32 v31, v63
    s_nop 1
    v_permlane32_swap_b32 v24, v56
    v_permlane32_swap_b32 v25, v57
    v_permlane32_swap_b32 v26, v58
    v_permlane32_swap_b32 v27, v59
    v_permlane32_swap_b32 v28, v60
    v_permlane32_swap_b32 v29, v61
    v_permlane32_swap_b32 v30, v62
    v_permlane32_swap_b32 v31, v63
    v_add_f32 v56, v56, v24
    v_add_f32 v57, v57, v25
    v_add_f32 v58, v58, v26
    v_add_f32 v59, v59, v27
    v_add_f32 v60, v60, v28
    v_add_f32 v61, v61, v29
    v_add_f32 v62, v62, v30
    v_add_f32 v63, v63, v31
    s_mul_i32 s35, s38, 7168
    s_lshl_b32 s36, s37, 8
    s_add_u32 s35, s35, s36
    s_add_u32 s35, s35, 23134208
    v_lshlrev_b32 v2, 5, v1
    s_mov_b64 exec, 0xff
    buffer_store_dwordx4 v[56:59], v2, s[16:19], s35 offen
    buffer_store_dwordx4 v[60:63], v2, s[16:19], s35 offen offset:16
    s_branch k1_end_1
k1_cons_2:
    s_lshr_b32 s29, s28, 2
    s_and_b32 s30, s28, 3
    s_mov_b32 s31, 0
    s_mov_b32 s41, 0x3f803f80
    s_mul_i32 s42, s33, 3
    s_lshl_b32 s35, s29, 1
    s_add_u32 s42, s42, s35
    v_and_b32 v2, 31, v1
    v_lshrrev_b32 v3, 5, v1
    v_bfe_u32 v4, v2, 1, 3
    s_mul_i32 s35, s30, 4096
    v_lshlrev_b32 v5, 7, v2
    v_add_u32 v5, s35, v5
    s_mul_i32 s36, s31, 8
    v_add_u32 v6, s36, v3
    v_xor_b32 v6, v6, v4
    v_lshl_add_u32 v80, v6, 4, v5
    v_add_u32 v81, 65536, v80
    v_add_u32 v82, 131072, v80
    v_add_u32 v6, s36, v3
    v_add_u32 v6, 2, v6
    v_xor_b32 v6, v6, v4
    v_lshl_add_u32 v83, v6, 4, v5
    v_add_u32 v84, 65536, v83
    v_add_u32 v85, 131072, v83
    v_add_u32 v6, s36, v3
    v_add_u32 v6, 4, v6
    v_xor_b32 v6, v6, v4
    v_lshl_add_u32 v86, v6, 4, v5
    v_add_u32 v87, 65536, v86
    v_add_u32 v88, 131072, v86
    v_add_u32 v6, s36, v3
    v_add_u32 v6, 6, v6
    v_xor_b32 v6, v6, v4
    v_lshl_add_u32 v89, v6, 4, v5
    v_add_u32 v90, 65536, v89
    v_add_u32 v91, 131072, v89
    v_bfe_u32 v4, v1, 2, 2
    v_and_b32 v5, 3, v1
    v_lshlrev_b32 v5, 3, v5
    v_bfe_u32 v6, v1, 4, 1
    v_lshl_add_u32 v5, v6, 5, v5
    v_lshlrev_b32 v6, 3, v3
    v_add_u32 v6, v6, v4
    s_mul_i32 s35, s31, 64
    v_add_u32 v6, s35, v6
    v_mul_u32_u24 v6, 256, v6
    v_add_u32 v5, v5, v6
    s_mul_i32 s35, s29, 2
    v_xor_b32 v6, s35, v4
    v_lshl_add_u32 v92, v6, 6, v5
    v_add_u32 v93, 65536, v92
    v_add_u32 v94, 131072, v92
    s_mul_i32 s35, s29, 2
    s_add_u32 s35, s35, 1
    v_xor_b32 v6, s35, v4
    v_lshl_add_u32 v95, v6, 6, v5
    v_add_u32 v96, 65536, v95
    v_add_u32 v97, 131072, v95
    v_lshrrev_b32 v100, 5, v1
    v_and_b32 v101, 31, v1
    v_mov_b32 v12, 0
    v_mov_b32 v13, 0
    v_mov_b32 v14, 0
    v_mov_b32 v15, 0
    v_mov_b32 v16, 0
    v_mov_b32 v17, 0
    v_mov_b32 v18, 0
    v_mov_b32 v19, 0
    v_mov_b32 v20, 0
    v_mov_b32 v21, 0
    v_mov_b32 v22, 0
    v_mov_b32 v23, 0
    v_mov_b32 v24, 0
    v_mov_b32 v25, 0
    v_mov_b32 v26, 0
    v_mov_b32 v27, 0
    v_mov_b32 v28, 0
    v_mov_b32 v29, 0
    v_mov_b32 v30, 0
    v_mov_b32 v31, 0
    v_mov_b32 v32, 0
    v_mov_b32 v33, 0
    v_mov_b32 v34, 0
    v_mov_b32 v35, 0
    v_mov_b32 v36, 0
    v_mov_b32 v37, 0
    v_mov_b32 v38, 0
    v_mov_b32 v39, 0
    v_mov_b32 v40, 0
    v_mov_b32 v41, 0
    v_mov_b32 v42, 0
    v_mov_b32 v43, 0
    v_mov_b32 v98, 0
    v_mov_b32 v99, 0
    v_lshlrev_b32 v112, 4, v1
    v_lshrrev_b32 v2, 4, v101
    v_lshlrev_b32 v113, 16, v2
    v_and_b32 v2, 15, v101
    v_lshl_add_u32 v113, v2, 4, v113
    v_lshl_add_u32 v113, v100, 8, v113
    v_mov_b32 v116, 0xc0135761
    s_mov_b32 s46, 0xbdd2d3e8
    s_lshl_b32 s45, s32, 2
    s_add_u32 s45, s45, s30
    s_waitcnt lgkmcnt(0)
    s_mov_b32 s16, s98
    s_and_b32 s17, s99, 0xffff
    s_mov_b32 s18, 0x10000000
    s_mov_b32 s19, 0x00020000
    v_mov_b32 v118, 0
    v_mov_b32 v119, 0
    v_mov_b32 v120, 0
    v_mov_b32 v121, 0
    s_cmp_eq_u32 s29, 1
    s_cbranch_scc1 k1_w1_12
    s_cmp_lt_u32 s42, 32
    s_cbranch_scc1 k1_0n_6
k1_0s_7:
    s_barrier
    ds_read_b128 v[44:47], v80 offset:0
    ds_read_b64_tr_b16 v[56:57], v92 offset:16384
    ds_read_b64_tr_b16 v[58:59], v92 offset:17408
    ds_read_b64_tr_b16 v[60:61], v95 offset:16384
    ds_read_b64_tr_b16 v[62:63], v95 offset:17408
    ds_read_b128 v[48:51], v83 offset:0
    ds_read_b64_tr_b16 v[64:65], v92 offset:20480
    ds_read_b64_tr_b16 v[66:67], v92 offset:21504
    ds_read_b64_tr_b16 v[68:69], v95 offset:20480
    ds_read_b64_tr_b16 v[70:71], v95 offset:21504
    ds_read_b128 v[52:55], v86 offset:0
    ds_read_b64_tr_b16 v[72:73], v92 offset:24576
    ds_read_b64_tr_b16 v[74:75], v92 offset:25600
    ds_read_b64_tr_b16 v[76:77], v95 offset:24576
    ds_read_b64_tr_b16 v[78:79], v95 offset:25600
    s_waitcnt lgkmcnt(10)
    v_mfma_f32_32x32x16_bf16 v[12:27], v[44:47], v[56:59], v[12:27]
    v_mfma_f32_32x32x16_bf16 v[28:43], v[44:47], v[60:63], v[28:43]
    v_lshlrev_b32 v104, 16, v44
    v_and_b32 v105, 0xffff0000, v44
    v_lshlrev_b32 v106, 16, v45
    v_and_b32 v107, 0xffff0000, v45
    v_lshlrev_b32 v108, 16, v46
    v_and_b32 v109, 0xffff0000, v46
    v_lshlrev_b32 v110, 16, v47
    v_and_b32 v111, 0xffff0000, v47
    v_add_f32 v118, v118, v104
    v_fmac_f32 v120, v104, v104
    v_add_f32 v119, v119, v105
    v_fmac_f32 v121, v105, v105
    v_add_f32 v118, v118, v106
    v_fmac_f32 v120, v106, v106
    v_add_f32 v119, v119, v107
    v_fmac_f32 v121, v107, v107
    v_add_f32 v118, v118, v108
    v_fmac_f32 v120, v108, v108
    v_add_f32 v119, v119, v109
    v_fmac_f32 v121, v109, v109
    v_add_f32 v118, v118, v110
    v_fmac_f32 v120, v110, v110
    v_add_f32 v119, v119, v111
    v_fmac_f32 v121, v111, v111
    ds_read_b128 v[44:47], v89 offset:0
    ds_read_b64_tr_b16 v[56:57], v92 offset:28672
    ds_read_b64_tr_b16 v[58:59], v92 offset:29696
    ds_read_b64_tr_b16 v[60:61], v95 offset:28672
    ds_read_b64_tr_b16 v[62:63], v95 offset:29696
    s_waitcnt lgkmcnt(10)
    v_mfma_f32_32x32x16_bf16 v[12:27], v[48:51], v[64:67], v[12:27]
    v_mfma_f32_32x32x16_bf16 v[28:43], v[48:51], v[68:71], v[28:43]
    v_lshlrev_b32 v104, 16, v48
    v_and_b32 v105, 0xffff0000, v48
    v_lshlrev_b32 v106, 16, v49
    v_and_b32 v107, 0xffff0000, v49
    v_lshlrev_b32 v108, 16, v50
    v_and_b32 v109, 0xffff0000, v50
    v_lshlrev_b32 v110, 16, v51
    v_and_b32 v111, 0xffff0000, v51
    v_add_f32 v118, v118, v104
    v_fmac_f32 v120, v104, v104
    v_add_f32 v119, v119, v105
    v_fmac_f32 v121, v105, v105
    v_add_f32 v118, v118, v106
    v_fmac_f32 v120, v106, v106
    v_add_f32 v119, v119, v107
    v_fmac_f32 v121, v107, v107
    v_add_f32 v118, v118, v108
    v_fmac_f32 v120, v108, v108
    v_add_f32 v119, v119, v109
    v_fmac_f32 v121, v109, v109
    v_add_f32 v118, v118, v110
    v_fmac_f32 v120, v110, v110
    v_add_f32 v119, v119, v111
    v_fmac_f32 v121, v111, v111
    s_barrier
    ds_read_b128 v[48:51], v80 offset:32768
    ds_read_b64_tr_b16 v[64:65], v92 offset:49152
    ds_read_b64_tr_b16 v[66:67], v92 offset:50176
    ds_read_b64_tr_b16 v[68:69], v95 offset:49152
    ds_read_b64_tr_b16 v[70:71], v95 offset:50176
    s_waitcnt lgkmcnt(10)
    v_mfma_f32_32x32x16_bf16 v[12:27], v[52:55], v[72:75], v[12:27]
    v_mfma_f32_32x32x16_bf16 v[28:43], v[52:55], v[76:79], v[28:43]
    v_lshlrev_b32 v104, 16, v52
    v_and_b32 v105, 0xffff0000, v52
    v_lshlrev_b32 v106, 16, v53
    v_and_b32 v107, 0xffff0000, v53
    v_lshlrev_b32 v108, 16, v54
    v_and_b32 v109, 0xffff0000, v54
    v_lshlrev_b32 v110, 16, v55
    v_and_b32 v111, 0xffff0000, v55
    v_add_f32 v118, v118, v104
    v_fmac_f32 v120, v104, v104
    v_add_f32 v119, v119, v105
    v_fmac_f32 v121, v105, v105
    v_add_f32 v118, v118, v106
    v_fmac_f32 v120, v106, v106
    v_add_f32 v119, v119, v107
    v_fmac_f32 v121, v107, v107
    v_add_f32 v118, v118, v108
    v_fmac_f32 v120, v108, v108
    v_add_f32 v119, v119, v109
    v_fmac_f32 v121, v109, v109
    v_add_f32 v118, v118, v110
    v_fmac_f32 v120, v110, v110
    v_add_f32 v119, v119, v111
    v_fmac_f32 v121, v111, v111
    ds_read_b128 v[52:55], v83 offset:32768
    ds_read_b64_tr_b16 v[72:73], v92 offset:53248
    ds_read_b64_tr_b16 v[74:75], v92 offset:54272
    ds_read_b64_tr_b16 v[76:77], v95 offset:53248
    ds_read_b64_tr_b16 v[78:79], v95 offset:54272
    s_waitcnt lgkmcnt(10)
    v_mfma_f32_32x32x16_bf16 v[12:27], v[44:47], v[56:59], v[12:27]
    v_mfma_f32_32x32x16_bf16 v[28:43], v[44:47], v[60:63], v[28:43]
    v_lshlrev_b32 v104, 16, v44
    v_and_b32 v105, 0xffff0000, v44
    v_lshlrev_b32 v106, 16, v45
    v_and_b32 v107, 0xffff0000, v45
    v_lshlrev_b32 v108, 16, v46
    v_and_b32 v109, 0xffff0000, v46
    v_lshlrev_b32 v110, 16, v47
    v_and_b32 v111, 0xffff0000, v47
    v_add_f32 v118, v118, v104
    v_fmac_f32 v120, v104, v104
    v_add_f32 v119, v119, v105
    v_fmac_f32 v121, v105, v105
    v_add_f32 v118, v118, v106
    v_fmac_f32 v120, v106, v106
    v_add_f32 v119, v119, v107
    v_fmac_f32 v121, v107, v107
    v_add_f32 v118, v118, v108
    v_fmac_f32 v120, v108, v108
    v_add_f32 v119, v119, v109
    v_fmac_f32 v121, v109, v109
    v_add_f32 v118, v118, v110
    v_fmac_f32 v120, v110, v110
    v_add_f32 v119, v119, v111
    v_fmac_f32 v121, v111, v111
    ds_read_b128 v[44:47], v86 offset:32768
    ds_read_b64_tr_b16 v[56:57], v92 offset:57344
    ds_read_b64_tr_b16 v[58:59], v92 offset:58368
    ds_read_b64_tr_b16 v[60:61], v95 offset:57344
    ds_read_b64_tr_b16 v[62:63], v95 offset:58368
    s_waitcnt lgkmcnt(10)
    v_mfma_f32_32x32x16_bf16 v[12:27], v[48:51], v[64:67], v[12:27]
    v_mfma_f32_32x32x16_bf16 v[28:43], v[48:51], v[68:71], v[28:43]
    v_lshlrev_b32 v104, 16, v48
    v_and_b32 v105, 0xffff0000, v48
    v_lshlrev_b32 v106, 16, v49
    v_and_b32 v107, 0xffff0000, v49
    v_lshlrev_b32 v108, 16, v50
    v_and_b32 v109, 0xffff0000, v50
    v_lshlrev_b32 v110, 16, v51
    v_and_b32 v111, 0xffff0000, v51
    v_add_f32 v118, v118, v104
    v_fmac_f32 v120, v104, v104
    v_add_f32 v119, v119, v105
    v_fmac_f32 v121, v105, v105
    v_add_f32 v118, v118, v106
    v_fmac_f32 v120, v106, v106
    v_add_f32 v119, v119, v107
    v_fmac_f32 v121, v107, v107
    v_add_f32 v118, v118, v108
    v_fmac_f32 v120, v108, v108
    v_add_f32 v119, v119, v109
    v_fmac_f32 v121, v109, v109
    v_add_f32 v118, v118, v110
    v_fmac_f32 v120, v110, v110
    v_add_f32 v119, v119, v111
    v_fmac_f32 v121, v111, v111
    ds_read_b128 v[48:51], v89 offset:32768
    ds_read_b64_tr_b16 v[64:65], v92 offset:61440
    ds_read_b64_tr_b16 v[66:67], v92 offset:62464
    ds_read_b64_tr_b16 v[68:69], v95 offset:61440
    ds_read_b64_tr_b16 v[70:71], v95 offset:62464
    s_waitcnt lgkmcnt(10)
    v_mfma_f32_32x32x16_bf16 v[12:27], v[52:55], v[72:75], v[12:27]
    v_mfma_f32_32x32x16_bf16 v[28:43], v[52:55], v[76:79], v[28:43]
    v_lshlrev_b32 v104, 16, v52
    v_and_b32 v105, 0xffff0000, v52
    v_lshlrev_b32 v106, 16, v53
    v_and_b32 v107, 0xffff0000, v53
    v_lshlrev_b32 v108, 16, v54
    v_and_b32 v109, 0xffff0000, v54
    v_lshlrev_b32 v110, 16, v55
    v_and_b32 v111, 0xffff0000, v55
    v_add_f32 v118, v118, v104
    v_fmac_f32 v120, v104, v104
    v_add_f32 v119, v119, v105
    v_fmac_f32 v121, v105, v105
    v_add_f32 v118, v118, v106
    v_fmac_f32 v120, v106, v106
    v_add_f32 v119, v119, v107
    v_fmac_f32 v121, v107, v107
    v_add_f32 v118, v118, v108
    v_fmac_f32 v120, v108, v108
    v_add_f32 v119, v119, v109
    v_fmac_f32 v121, v109, v109
    v_add_f32 v118, v118, v110
    v_fmac_f32 v120, v110, v110
    v_add_f32 v119, v119, v111
    v_fmac_f32 v121, v111, v111
    s_barrier
    ds_read_b128 v[52:55], v81 offset:0
    ds_read_b64_tr_b16 v[72:73], v93 offset:16384
    ds_read_b64_tr_b16 v[74:75], v93 offset:17408
    ds_read_b64_tr_b16 v[76:77], v96 offset:16384
    ds_read_b64_tr_b16 v[78:79], v96 offset:17408
    s_waitcnt lgkmcnt(10)
    v_mfma_f32_32x32x16_bf16 v[12:27], v[44:47], v[56:59], v[12:27]
    v_mfma_f32_32x32x16_bf16 v[28:43], v[44:47], v[60:63], v[28:43]
    v_lshlrev_b32 v104, 16, v44
    v_and_b32 v105, 0xffff0000, v44
    v_lshlrev_b32 v106, 16, v45
    v_and_b32 v107, 0xffff0000, v45
    v_lshlrev_b32 v108, 16, v46
    v_and_b32 v109, 0xffff0000, v46
    v_lshlrev_b32 v110, 16, v47
    v_and_b32 v111, 0xffff0000, v47
    v_add_f32 v118, v118, v104
    v_fmac_f32 v120, v104, v104
    v_add_f32 v119, v119, v105
    v_fmac_f32 v121, v105, v105
    v_add_f32 v118, v118, v106
    v_fmac_f32 v120, v106, v106
    v_add_f32 v119, v119, v107
    v_fmac_f32 v121, v107, v107
    v_add_f32 v118, v118, v108
    v_fmac_f32 v120, v108, v108
    v_add_f32 v119, v119, v109
    v_fmac_f32 v121, v109, v109
    v_add_f32 v118, v118, v110
    v_fmac_f32 v120, v110, v110
    v_add_f32 v119, v119, v111
    v_fmac_f32 v121, v111, v111
    ds_read_b128 v[44:47], v84 offset:0
    ds_read_b64_tr_b16 v[56:57], v93 offset:20480
    ds_read_b64_tr_b16 v[58:59], v93 offset:21504
    ds_read_b64_tr_b16 v[60:61], v96 offset:20480
    ds_read_b64_tr_b16 v[62:63], v96 offset:21504
    s_waitcnt lgkmcnt(10)
    v_mfma_f32_32x32x16_bf16 v[12:27], v[48:51], v[64:67], v[12:27]
    v_mfma_f32_32x32x16_bf16 v[28:43], v[48:51], v[68:71], v[28:43]
    v_lshlrev_b32 v104, 16, v48
    v_and_b32 v105, 0xffff0000, v48
    v_lshlrev_b32 v106, 16, v49
    v_and_b32 v107, 0xffff0000, v49
    v_lshlrev_b32 v108, 16, v50
    v_and_b32 v109, 0xffff0000, v50
    v_lshlrev_b32 v110, 16, v51
    v_and_b32 v111, 0xffff0000, v51
    v_add_f32 v118, v118, v104
    v_fmac_f32 v120, v104, v104
    v_add_f32 v119, v119, v105
    v_fmac_f32 v121, v105, v105
    v_add_f32 v118, v118, v106
    v_fmac_f32 v120, v106, v106
    v_add_f32 v119, v119, v107
    v_fmac_f32 v121, v107, v107
    v_add_f32 v118, v118, v108
    v_fmac_f32 v120, v108, v108
    v_add_f32 v119, v119, v109
    v_fmac_f32 v121, v109, v109
    v_add_f32 v118, v118, v110
    v_fmac_f32 v120, v110, v110
    v_add_f32 v119, v119, v111
    v_fmac_f32 v121, v111, v111
    ds_read_b128 v[48:51], v87 offset:0
    ds_read_b64_tr_b16 v[64:65], v93 offset:24576
    ds_read_b64_tr_b16 v[66:67], v93 offset:25600
    ds_read_b64_tr_b16 v[68:69], v96 offset:24576
    ds_read_b64_tr_b16 v[70:71], v96 offset:25600
    s_waitcnt lgkmcnt(10)
    v_mfma_f32_32x32x16_bf16 v[12:27], v[52:55], v[72:75], v[12:27]
    v_mfma_f32_32x32x16_bf16 v[28:43], v[52:55], v[76:79], v[28:43]
    v_lshlrev_b32 v104, 16, v52
    v_and_b32 v105, 0xffff0000, v52
    v_lshlrev_b32 v106, 16, v53
    v_and_b32 v107, 0xffff0000, v53
    v_lshlrev_b32 v108, 16, v54
    v_and_b32 v109, 0xffff0000, v54
    v_lshlrev_b32 v110, 16, v55
    v_and_b32 v111, 0xffff0000, v55
    v_add_f32 v118, v118, v104
    v_fmac_f32 v120, v104, v104
    v_add_f32 v119, v119, v105
    v_fmac_f32 v121, v105, v105
    v_add_f32 v118, v118, v106
    v_fmac_f32 v120, v106, v106
    v_add_f32 v119, v119, v107
    v_fmac_f32 v121, v107, v107
    v_add_f32 v118, v118, v108
    v_fmac_f32 v120, v108, v108
    v_add_f32 v119, v119, v109
    v_fmac_f32 v121, v109, v109
    v_add_f32 v118, v118, v110
    v_fmac_f32 v120, v110, v110
    v_add_f32 v119, v119, v111
    v_fmac_f32 v121, v111, v111
    ds_read_b128 v[52:55], v90 offset:0
    ds_read_b64_tr_b16 v[72:73], v93 offset:28672
    ds_read_b64_tr_b16 v[74:75], v93 offset:29696
    ds_read_b64_tr_b16 v[76:77], v96 offset:28672
    ds_read_b64_tr_b16 v[78:79], v96 offset:29696
    s_waitcnt lgkmcnt(10)
    v_mfma_f32_32x32x16_bf16 v[12:27], v[44:47], v[56:59], v[12:27]
    v_mfma_f32_32x32x16_bf16 v[28:43], v[44:47], v[60:63], v[28:43]
    v_lshlrev_b32 v104, 16, v44
    v_and_b32 v105, 0xffff0000, v44
    v_lshlrev_b32 v106, 16, v45
    v_and_b32 v107, 0xffff0000, v45
    v_lshlrev_b32 v108, 16, v46
    v_and_b32 v109, 0xffff0000, v46
    v_lshlrev_b32 v110, 16, v47
    v_and_b32 v111, 0xffff0000, v47
    v_add_f32 v118, v118, v104
    v_fmac_f32 v120, v104, v104
    v_add_f32 v119, v119, v105
    v_fmac_f32 v121, v105, v105
    v_add_f32 v118, v118, v106
    v_fmac_f32 v120, v106, v106
    v_add_f32 v119, v119, v107
    v_fmac_f32 v121, v107, v107
    v_add_f32 v118, v118, v108
    v_fmac_f32 v120, v108, v108
    v_add_f32 v119, v119, v109
    v_fmac_f32 v121, v109, v109
    v_add_f32 v118, v118, v110
    v_fmac_f32 v120, v110, v110
    v_add_f32 v119, v119, v111
    v_fmac_f32 v121, v111, v111
    s_barrier
    ds_read_b128 v[44:47], v81 offset:32768
    ds_read_b64_tr_b16 v[56:57], v93 offset:49152
    ds_read_b64_tr_b16 v[58:59], v93 offset:50176
    ds_read_b64_tr_b16 v[60:61], v96 offset:49152
    ds_read_b64_tr_b16 v[62:63], v96 offset:50176
    s_waitcnt lgkmcnt(10)
    v_mfma_f32_32x32x16_bf16 v[12:27], v[48:51], v[64:67], v[12:27]
    v_mfma_f32_32x32x16_bf16 v[28:43], v[48:51], v[68:71], v[28:43]
    v_lshlrev_b32 v104, 16, v48
    v_and_b32 v105, 0xffff0000, v48
    v_lshlrev_b32 v106, 16, v49
    v_and_b32 v107, 0xffff0000, v49
    v_lshlrev_b32 v108, 16, v50
    v_and_b32 v109, 0xffff0000, v50
    v_lshlrev_b32 v110, 16, v51
    v_and_b32 v111, 0xffff0000, v51
    v_add_f32 v118, v118, v104
    v_fmac_f32 v120, v104, v104
    v_add_f32 v119, v119, v105
    v_fmac_f32 v121, v105, v105
    v_add_f32 v118, v118, v106
    v_fmac_f32 v120, v106, v106
    v_add_f32 v119, v119, v107
    v_fmac_f32 v121, v107, v107
    v_add_f32 v118, v118, v108
    v_fmac_f32 v120, v108, v108
    v_add_f32 v119, v119, v109
    v_fmac_f32 v121, v109, v109
    v_add_f32 v118, v118, v110
    v_fmac_f32 v120, v110, v110
    v_add_f32 v119, v119, v111
    v_fmac_f32 v121, v111, v111
    ds_read_b128 v[48:51], v84 offset:32768
    ds_read_b64_tr_b16 v[64:65], v93 offset:53248
    ds_read_b64_tr_b16 v[66:67], v93 offset:54272
    ds_read_b64_tr_b16 v[68:69], v96 offset:53248
    ds_read_b64_tr_b16 v[70:71], v96 offset:54272
    s_waitcnt lgkmcnt(10)
    v_mfma_f32_32x32x16_bf16 v[12:27], v[52:55], v[72:75], v[12:27]
    v_mfma_f32_32x32x16_bf16 v[28:43], v[52:55], v[76:79], v[28:43]
    v_lshlrev_b32 v104, 16, v52
    v_and_b32 v105, 0xffff0000, v52
    v_lshlrev_b32 v106, 16, v53
    v_and_b32 v107, 0xffff0000, v53
    v_lshlrev_b32 v108, 16, v54
    v_and_b32 v109, 0xffff0000, v54
    v_lshlrev_b32 v110, 16, v55
    v_and_b32 v111, 0xffff0000, v55
    v_add_f32 v118, v118, v104
    v_fmac_f32 v120, v104, v104
    v_add_f32 v119, v119, v105
    v_fmac_f32 v121, v105, v105
    v_add_f32 v118, v118, v106
    v_fmac_f32 v120, v106, v106
    v_add_f32 v119, v119, v107
    v_fmac_f32 v121, v107, v107
    v_add_f32 v118, v118, v108
    v_fmac_f32 v120, v108, v108
    v_add_f32 v119, v119, v109
    v_fmac_f32 v121, v109, v109
    v_add_f32 v118, v118, v110
    v_fmac_f32 v120, v110, v110
    v_add_f32 v119, v119, v111
    v_fmac_f32 v121, v111, v111
    ds_read_b128 v[52:55], v87 offset:32768
    ds_read_b64_tr_b16 v[72:73], v93 offset:57344
    ds_read_b64_tr_b16 v[74:75], v93 offset:58368
    ds_read_b64_tr_b16 v[76:77], v96 offset:57344
    ds_read_b64_tr_b16 v[78:79], v96 offset:58368
    s_waitcnt lgkmcnt(10)
    v_mfma_f32_32x32x16_bf16 v[12:27], v[44:47], v[56:59], v[12:27]
    v_mfma_f32_32x32x16_bf16 v[28:43], v[44:47], v[60:63], v[28:43]
    v_lshlrev_b32 v104, 16, v44
    v_and_b32 v105, 0xffff0000, v44
    v_lshlrev_b32 v106, 16, v45
    v_and_b32 v107, 0xffff0000, v45
    v_lshlrev_b32 v108, 16, v46
    v_and_b32 v109, 0xffff0000, v46
    v_lshlrev_b32 v110, 16, v47
    v_and_b32 v111, 0xffff0000, v47
    v_add_f32 v118, v118, v104
    v_fmac_f32 v120, v104, v104
    v_add_f32 v119, v119, v105
    v_fmac_f32 v121, v105, v105
    v_add_f32 v118, v118, v106
    v_fmac_f32 v120, v106, v106
    v_add_f32 v119, v119, v107
    v_fmac_f32 v121, v107, v107
    v_add_f32 v118, v118, v108
    v_fmac_f32 v120, v108, v108
    v_add_f32 v119, v119, v109
    v_fmac_f32 v121, v109, v109
    v_add_f32 v118, v118, v110
    v_fmac_f32 v120, v110, v110
    v_add_f32 v119, v119, v111
    v_fmac_f32 v121, v111, v111
    ds_read_b128 v[44:47], v90 offset:32768
    ds_read_b64_tr_b16 v[56:57], v93 offset:61440
    ds_read_b64_tr_b16 v[58:59], v93 offset:62464
    ds_read_b64_tr_b16 v[60:61], v96 offset:61440
    ds_read_b64_tr_b16 v[62:63], v96 offset:62464
    s_waitcnt lgkmcnt(10)
    v_mfma_f32_32x32x16_bf16 v[12:27], v[48:51], v[64:67], v[12:27]
    v_mfma_f32_32x32x16_bf16 v[28:43], v[48:51], v[68:71], v[28:43]
    v_lshlrev_b32 v104, 16, v48
    v_and_b32 v105, 0xffff0000, v48
    v_lshlrev_b32 v106, 16, v49
    v_and_b32 v107, 0xffff0000, v49
    v_lshlrev_b32 v108, 16, v50
    v_and_b32 v109, 0xffff0000, v50
    v_lshlrev_b32 v110, 16, v51
    v_and_b32 v111, 0xffff0000, v51
    v_add_f32 v118, v118, v104
    v_fmac_f32 v120, v104, v104
    v_add_f32 v119, v119, v105
    v_fmac_f32 v121, v105, v105
    v_add_f32 v118, v118, v106
    v_fmac_f32 v120, v106, v106
    v_add_f32 v119, v119, v107
    v_fmac_f32 v121, v107, v107
    v_add_f32 v118, v118, v108
    v_fmac_f32 v120, v108, v108
    v_add_f32 v119, v119, v109
    v_fmac_f32 v121, v109, v109
    v_add_f32 v118, v118, v110
    v_fmac_f32 v120, v110, v110
    v_add_f32 v119, v119, v111
    v_fmac_f32 v121, v111, v111
    s_barrier
    ds_read_b128 v[48:51], v82 offset:0
    ds_read_b64_tr_b16 v[64:65], v94 offset:16384
    ds_read_b64_tr_b16 v[66:67], v94 offset:17408
    ds_read_b64_tr_b16 v[68:69], v97 offset:16384
    ds_read_b64_tr_b16 v[70:71], v97 offset:17408
    s_waitcnt lgkmcnt(10)
    v_mfma_f32_32x32x16_bf16 v[12:27], v[52:55], v[72:75], v[12:27]
    v_mfma_f32_32x32x16_bf16 v[28:43], v[52:55], v[76:79], v[28:43]
    v_lshlrev_b32 v104, 16, v52
    v_and_b32 v105, 0xffff0000, v52
    v_lshlrev_b32 v106, 16, v53
    v_and_b32 v107, 0xffff0000, v53
    v_lshlrev_b32 v108, 16, v54
    v_and_b32 v109, 0xffff0000, v54
    v_lshlrev_b32 v110, 16, v55
    v_and_b32 v111, 0xffff0000, v55
    v_add_f32 v118, v118, v104
    v_fmac_f32 v120, v104, v104
    v_add_f32 v119, v119, v105
    v_fmac_f32 v121, v105, v105
    v_add_f32 v118, v118, v106
    v_fmac_f32 v120, v106, v106
    v_add_f32 v119, v119, v107
    v_fmac_f32 v121, v107, v107
    v_add_f32 v118, v118, v108
    v_fmac_f32 v120, v108, v108
    v_add_f32 v119, v119, v109
    v_fmac_f32 v121, v109, v109
    v_add_f32 v118, v118, v110
    v_fmac_f32 v120, v110, v110
    v_add_f32 v119, v119, v111
    v_fmac_f32 v121, v111, v111
    ds_read_b128 v[52:55], v85 offset:0
    ds_read_b64_tr_b16 v[72:73], v94 offset:20480
    ds_read_b64_tr_b16 v[74:75], v94 offset:21504
    ds_read_b64_tr_b16 v[76:77], v97 offset:20480
    ds_read_b64_tr_b16 v[78:79], v97 offset:21504
    s_waitcnt lgkmcnt(10)
    v_mfma_f32_32x32x16_bf16 v[12:27], v[44:47], v[56:59], v[12:27]
    v_mfma_f32_32x32x16_bf16 v[28:43], v[44:47], v[60:63], v[28:43]
    v_lshlrev_b32 v104, 16, v44
    v_and_b32 v105, 0xffff0000, v44
    v_lshlrev_b32 v106, 16, v45
    v_and_b32 v107, 0xffff0000, v45
    v_lshlrev_b32 v108, 16, v46
    v_and_b32 v109, 0xffff0000, v46
    v_lshlrev_b32 v110, 16, v47
    v_and_b32 v111, 0xffff0000, v47
    v_add_f32 v118, v118, v104
    v_fmac_f32 v120, v104, v104
    v_add_f32 v119, v119, v105
    v_fmac_f32 v121, v105, v105
    v_add_f32 v118, v118, v106
    v_fmac_f32 v120, v106, v106
    v_add_f32 v119, v119, v107
    v_fmac_f32 v121, v107, v107
    v_add_f32 v118, v118, v108
    v_fmac_f32 v120, v108, v108
    v_add_f32 v119, v119, v109
    v_fmac_f32 v121, v109, v109
    v_add_f32 v118, v118, v110
    v_fmac_f32 v120, v110, v110
    v_add_f32 v119, v119, v111
    v_fmac_f32 v121, v111, v111
    ds_read_b128 v[44:47], v88 offset:0
    ds_read_b64_tr_b16 v[56:57], v94 offset:24576
    ds_read_b64_tr_b16 v[58:59], v94 offset:25600
    ds_read_b64_tr_b16 v[60:61], v97 offset:24576
    ds_read_b64_tr_b16 v[62:63], v97 offset:25600
    s_waitcnt lgkmcnt(10)
    v_mfma_f32_32x32x16_bf16 v[12:27], v[48:51], v[64:67], v[12:27]
    v_mfma_f32_32x32x16_bf16 v[28:43], v[48:51], v[68:71], v[28:43]
    v_lshlrev_b32 v104, 16, v48
    v_and_b32 v105, 0xffff0000, v48
    v_lshlrev_b32 v106, 16, v49
    v_and_b32 v107, 0xffff0000, v49
    v_lshlrev_b32 v108, 16, v50
    v_and_b32 v109, 0xffff0000, v50
    v_lshlrev_b32 v110, 16, v51
    v_and_b32 v111, 0xffff0000, v51
    v_add_f32 v118, v118, v104
    v_fmac_f32 v120, v104, v104
    v_add_f32 v119, v119, v105
    v_fmac_f32 v121, v105, v105
    v_add_f32 v118, v118, v106
    v_fmac_f32 v120, v106, v106
    v_add_f32 v119, v119, v107
    v_fmac_f32 v121, v107, v107
    v_add_f32 v118, v118, v108
    v_fmac_f32 v120, v108, v108
    v_add_f32 v119, v119, v109
    v_fmac_f32 v121, v109, v109
    v_add_f32 v118, v118, v110
    v_fmac_f32 v120, v110, v110
    v_add_f32 v119, v119, v111
    v_fmac_f32 v121, v111, v111
    ds_read_b128 v[48:51], v91 offset:0
    ds_read_b64_tr_b16 v[64:65], v94 offset:28672
    ds_read_b64_tr_b16 v[66:67], v94 offset:29696
    ds_read_b64_tr_b16 v[68:69], v97 offset:28672
    ds_read_b64_tr_b16 v[70:71], v97 offset:29696
    s_waitcnt lgkmcnt(10)
    v_mfma_f32_32x32x16_bf16 v[12:27], v[52:55], v[72:75], v[12:27]
    v_mfma_f32_32x32x16_bf16 v[28:43], v[52:55], v[76:79], v[28:43]
    v_lshlrev_b32 v104, 16, v52
    v_and_b32 v105, 0xffff0000, v52
    v_lshlrev_b32 v106, 16, v53
    v_and_b32 v107, 0xffff0000, v53
    v_lshlrev_b32 v108, 16, v54
    v_and_b32 v109, 0xffff0000, v54
    v_lshlrev_b32 v110, 16, v55
    v_and_b32 v111, 0xffff0000, v55
    v_add_f32 v118, v118, v104
    v_fmac_f32 v120, v104, v104
    v_add_f32 v119, v119, v105
    v_fmac_f32 v121, v105, v105
    v_add_f32 v118, v118, v106
    v_fmac_f32 v120, v106, v106
    v_add_f32 v119, v119, v107
    v_fmac_f32 v121, v107, v107
    v_add_f32 v118, v118, v108
    v_fmac_f32 v120, v108, v108
    v_add_f32 v119, v119, v109
    v_fmac_f32 v121, v109, v109
    v_add_f32 v118, v118, v110
    v_fmac_f32 v120, v110, v110
    v_add_f32 v119, v119, v111
    v_fmac_f32 v121, v111, v111
    s_barrier
    ds_read_b128 v[52:55], v80 offset:0
    ds_read_b64_tr_b16 v[72:73], v92 offset:16384
    ds_read_b64_tr_b16 v[74:75], v92 offset:17408
    ds_read_b64_tr_b16 v[76:77], v95 offset:16384
    ds_read_b64_tr_b16 v[78:79], v95 offset:17408
    s_waitcnt lgkmcnt(10)
    v_mfma_f32_32x32x16_bf16 v[12:27], v[44:47], v[56:59], v[12:27]
    v_mfma_f32_32x32x16_bf16 v[28:43], v[44:47], v[60:63], v[28:43]
    v_lshlrev_b32 v104, 16, v44
    v_and_b32 v105, 0xffff0000, v44
    v_lshlrev_b32 v106, 16, v45
    v_and_b32 v107, 0xffff0000, v45
    v_lshlrev_b32 v108, 16, v46
    v_and_b32 v109, 0xffff0000, v46
    v_lshlrev_b32 v110, 16, v47
    v_and_b32 v111, 0xffff0000, v47
    v_add_f32 v118, v118, v104
    v_fmac_f32 v120, v104, v104
    v_add_f32 v119, v119, v105
    v_fmac_f32 v121, v105, v105
    v_add_f32 v118, v118, v106
    v_fmac_f32 v120, v106, v106
    v_add_f32 v119, v119, v107
    v_fmac_f32 v121, v107, v107
    v_add_f32 v118, v118, v108
    v_fmac_f32 v120, v108, v108
    v_add_f32 v119, v119, v109
    v_fmac_f32 v121, v109, v109
    v_add_f32 v118, v118, v110
    v_fmac_f32 v120, v110, v110
    v_add_f32 v119, v119, v111
    v_fmac_f32 v121, v111, v111
    ds_read_b128 v[44:47], v83 offset:0
    ds_read_b64_tr_b16 v[56:57], v92 offset:20480
    ds_read_b64_tr_b16 v[58:59], v92 offset:21504
    ds_read_b64_tr_b16 v[60:61], v95 offset:20480
    ds_read_b64_tr_b16 v[62:63], v95 offset:21504
    s_waitcnt lgkmcnt(10)
    v_mfma_f32_32x32x16_bf16 v[12:27], v[48:51], v[64:67], v[12:27]
    v_mfma_f32_32x32x16_bf16 v[28:43], v[48:51], v[68:71], v[28:43]
    v_lshlrev_b32 v104, 16, v48
    v_and_b32 v105, 0xffff0000, v48
    v_lshlrev_b32 v106, 16, v49
    v_and_b32 v107, 0xffff0000, v49
    v_lshlrev_b32 v108, 16, v50
    v_and_b32 v109, 0xffff0000, v50
    v_lshlrev_b32 v110, 16, v51
    v_and_b32 v111, 0xffff0000, v51
    v_add_f32 v118, v118, v104
    v_fmac_f32 v120, v104, v104
    v_add_f32 v119, v119, v105
    v_fmac_f32 v121, v105, v105
    v_add_f32 v118, v118, v106
    v_fmac_f32 v120, v106, v106
    v_add_f32 v119, v119, v107
    v_fmac_f32 v121, v107, v107
    v_add_f32 v118, v118, v108
    v_fmac_f32 v120, v108, v108
    v_add_f32 v119, v119, v109
    v_fmac_f32 v121, v109, v109
    v_add_f32 v118, v118, v110
    v_fmac_f32 v120, v110, v110
    v_add_f32 v119, v119, v111
    v_fmac_f32 v121, v111, v111
    ds_read_b128 v[48:51], v86 offset:0
    ds_read_b64_tr_b16 v[64:65], v92 offset:24576
    ds_read_b64_tr_b16 v[66:67], v92 offset:25600
    ds_read_b64_tr_b16 v[68:69], v95 offset:24576
    ds_read_b64_tr_b16 v[70:71], v95 offset:25600
    s_waitcnt lgkmcnt(10)
    v_mfma_f32_32x32x16_bf16 v[12:27], v[52:55], v[72:75], v[12:27]
    v_mfma_f32_32x32x16_bf16 v[28:43], v[52:55], v[76:79], v[28:43]
    v_lshlrev_b32 v104, 16, v52
    v_and_b32 v105, 0xffff0000, v52
    v_lshlrev_b32 v106, 16, v53
    v_and_b32 v107, 0xffff0000, v53
    v_lshlrev_b32 v108, 16, v54
    v_and_b32 v109, 0xffff0000, v54
    v_lshlrev_b32 v110, 16, v55
    v_and_b32 v111, 0xffff0000, v55
    v_add_f32 v118, v118, v104
    v_fmac_f32 v120, v104, v104
    v_add_f32 v119, v119, v105
    v_fmac_f32 v121, v105, v105
    v_add_f32 v118, v118, v106
    v_fmac_f32 v120, v106, v106
    v_add_f32 v119, v119, v107
    v_fmac_f32 v121, v107, v107
    v_add_f32 v118, v118, v108
    v_fmac_f32 v120, v108, v108
    v_add_f32 v119, v119, v109
    v_fmac_f32 v121, v109, v109
    v_add_f32 v118, v118, v110
    v_fmac_f32 v120, v110, v110
    v_add_f32 v119, v119, v111
    v_fmac_f32 v121, v111, v111
    ds_read_b128 v[52:55], v89 offset:0
    ds_read_b64_tr_b16 v[72:73], v92 offset:28672
    ds_read_b64_tr_b16 v[74:75], v92 offset:29696
    ds_read_b64_tr_b16 v[76:77], v95 offset:28672
    ds_read_b64_tr_b16 v[78:79], v95 offset:29696
    s_waitcnt lgkmcnt(10)
    v_mfma_f32_32x32x16_bf16 v[12:27], v[44:47], v[56:59], v[12:27]
    v_mfma_f32_32x32x16_bf16 v[28:43], v[44:47], v[60:63], v[28:43]
    v_lshlrev_b32 v104, 16, v44
    v_and_b32 v105, 0xffff0000, v44
    v_lshlrev_b32 v106, 16, v45
    v_and_b32 v107, 0xffff0000, v45
    v_lshlrev_b32 v108, 16, v46
    v_and_b32 v109, 0xffff0000, v46
    v_lshlrev_b32 v110, 16, v47
    v_and_b32 v111, 0xffff0000, v47
    v_add_f32 v118, v118, v104
    v_fmac_f32 v120, v104, v104
    v_add_f32 v119, v119, v105
    v_fmac_f32 v121, v105, v105
    v_add_f32 v118, v118, v106
    v_fmac_f32 v120, v106, v106
    v_add_f32 v119, v119, v107
    v_fmac_f32 v121, v107, v107
    v_add_f32 v118, v118, v108
    v_fmac_f32 v120, v108, v108
    v_add_f32 v119, v119, v109
    v_fmac_f32 v121, v109, v109
    v_add_f32 v118, v118, v110
    v_fmac_f32 v120, v110, v110
    v_add_f32 v119, v119, v111
    v_fmac_f32 v121, v111, v111
    s_barrier
    ds_read_b128 v[44:47], v80 offset:32768
    ds_read_b64_tr_b16 v[56:57], v92 offset:49152
    ds_read_b64_tr_b16 v[58:59], v92 offset:50176
    ds_read_b64_tr_b16 v[60:61], v95 offset:49152
    ds_read_b64_tr_b16 v[62:63], v95 offset:50176
    s_waitcnt lgkmcnt(10)
    v_mfma_f32_32x32x16_bf16 v[12:27], v[48:51], v[64:67], v[12:27]
    v_mfma_f32_32x32x16_bf16 v[28:43], v[48:51], v[68:71], v[28:43]
    v_lshlrev_b32 v104, 16, v48
    v_and_b32 v105, 0xffff0000, v48
    v_lshlrev_b32 v106, 16, v49
    v_and_b32 v107, 0xffff0000, v49
    v_lshlrev_b32 v108, 16, v50
    v_and_b32 v109, 0xffff0000, v50
    v_lshlrev_b32 v110, 16, v51
    v_and_b32 v111, 0xffff0000, v51
    v_add_f32 v118, v118, v104
    v_fmac_f32 v120, v104, v104
    v_add_f32 v119, v119, v105
    v_fmac_f32 v121, v105, v105
    v_add_f32 v118, v118, v106
    v_fmac_f32 v120, v106, v106
    v_add_f32 v119, v119, v107
    v_fmac_f32 v121, v107, v107
    v_add_f32 v118, v118, v108
    v_fmac_f32 v120, v108, v108
    v_add_f32 v119, v119, v109
    v_fmac_f32 v121, v109, v109
    v_add_f32 v118, v118, v110
    v_fmac_f32 v120, v110, v110
    v_add_f32 v119, v119, v111
    v_fmac_f32 v121, v111, v111
    ds_read_b128 v[48:51], v83 offset:32768
    ds_read_b64_tr_b16 v[64:65], v92 offset:53248
    ds_read_b64_tr_b16 v[66:67], v92 offset:54272
    ds_read_b64_tr_b16 v[68:69], v95 offset:53248
    ds_read_b64_tr_b16 v[70:71], v95 offset:54272
    s_waitcnt lgkmcnt(10)
    v_mfma_f32_32x32x16_bf16 v[12:27], v[52:55], v[72:75], v[12:27]
    v_mfma_f32_32x32x16_bf16 v[28:43], v[52:55], v[76:79], v[28:43]
    v_lshlrev_b32 v104, 16, v52
    v_and_b32 v105, 0xffff0000, v52
    v_lshlrev_b32 v106, 16, v53
    v_and_b32 v107, 0xffff0000, v53
    v_lshlrev_b32 v108, 16, v54
    v_and_b32 v109, 0xffff0000, v54
    v_lshlrev_b32 v110, 16, v55
    v_and_b32 v111, 0xffff0000, v55
    v_add_f32 v118, v118, v104
    v_fmac_f32 v120, v104, v104
    v_add_f32 v119, v119, v105
    v_fmac_f32 v121, v105, v105
    v_add_f32 v118, v118, v106
    v_fmac_f32 v120, v106, v106
    v_add_f32 v119, v119, v107
    v_fmac_f32 v121, v107, v107
    v_add_f32 v118, v118, v108
    v_fmac_f32 v120, v108, v108
    v_add_f32 v119, v119, v109
    v_fmac_f32 v121, v109, v109
    v_add_f32 v118, v118, v110
    v_fmac_f32 v120, v110, v110
    v_add_f32 v119, v119, v111
    v_fmac_f32 v121, v111, v111
    ds_read_b128 v[52:55], v86 offset:32768
    ds_read_b64_tr_b16 v[72:73], v92 offset:57344
    ds_read_b64_tr_b16 v[74:75], v92 offset:58368
    ds_read_b64_tr_b16 v[76:77], v95 offset:57344
    ds_read_b64_tr_b16 v[78:79], v95 offset:58368
    s_waitcnt lgkmcnt(10)
    v_mfma_f32_32x32x16_bf16 v[12:27], v[44:47], v[56:59], v[12:27]
    v_mfma_f32_32x32x16_bf16 v[28:43], v[44:47], v[60:63], v[28:43]
    v_lshlrev_b32 v104, 16, v44
    v_and_b32 v105, 0xffff0000, v44
    v_lshlrev_b32 v106, 16, v45
    v_and_b32 v107, 0xffff0000, v45
    v_lshlrev_b32 v108, 16, v46
    v_and_b32 v109, 0xffff0000, v46
    v_lshlrev_b32 v110, 16, v47
    v_and_b32 v111, 0xffff0000, v47
    v_add_f32 v118, v118, v104
    v_fmac_f32 v120, v104, v104
    v_add_f32 v119, v119, v105
    v_fmac_f32 v121, v105, v105
    v_add_f32 v118, v118, v106
    v_fmac_f32 v120, v106, v106
    v_add_f32 v119, v119, v107
    v_fmac_f32 v121, v107, v107
    v_add_f32 v118, v118, v108
    v_fmac_f32 v120, v108, v108
    v_add_f32 v119, v119, v109
    v_fmac_f32 v121, v109, v109
    v_add_f32 v118, v118, v110
    v_fmac_f32 v120, v110, v110
    v_add_f32 v119, v119, v111
    v_fmac_f32 v121, v111, v111
    ds_read_b128 v[44:47], v89 offset:32768
    ds_read_b64_tr_b16 v[56:57], v92 offset:61440
    ds_read_b64_tr_b16 v[58:59], v92 offset:62464
    ds_read_b64_tr_b16 v[60:61], v95 offset:61440
    ds_read_b64_tr_b16 v[62:63], v95 offset:62464
    s_waitcnt lgkmcnt(10)
    v_mfma_f32_32x32x16_bf16 v[12:27], v[48:51], v[64:67], v[12:27]
    v_mfma_f32_32x32x16_bf16 v[28:43], v[48:51], v[68:71], v[28:43]
    v_lshlrev_b32 v104, 16, v48
    v_and_b32 v105, 0xffff0000, v48
    v_lshlrev_b32 v106, 16, v49
    v_and_b32 v107, 0xffff0000, v49
    v_lshlrev_b32 v108, 16, v50
    v_and_b32 v109, 0xffff0000, v50
    v_lshlrev_b32 v110, 16, v51
    v_and_b32 v111, 0xffff0000, v51
    v_add_f32 v118, v118, v104
    v_fmac_f32 v120, v104, v104
    v_add_f32 v119, v119, v105
    v_fmac_f32 v121, v105, v105
    v_add_f32 v118, v118, v106
    v_fmac_f32 v120, v106, v106
    v_add_f32 v119, v119, v107
    v_fmac_f32 v121, v107, v107
    v_add_f32 v118, v118, v108
    v_fmac_f32 v120, v108, v108
    v_add_f32 v119, v119, v109
    v_fmac_f32 v121, v109, v109
    v_add_f32 v118, v118, v110
    v_fmac_f32 v120, v110, v110
    v_add_f32 v119, v119, v111
    v_fmac_f32 v121, v111, v111
    s_barrier
    ds_read_b128 v[48:51], v81 offset:0
    ds_read_b64_tr_b16 v[64:65], v93 offset:16384
    ds_read_b64_tr_b16 v[66:67], v93 offset:17408
    ds_read_b64_tr_b16 v[68:69], v96 offset:16384
    ds_read_b64_tr_b16 v[70:71], v96 offset:17408
    s_waitcnt lgkmcnt(10)
    v_mfma_f32_32x32x16_bf16 v[12:27], v[52:55], v[72:75], v[12:27]
    v_mfma_f32_32x32x16_bf16 v[28:43], v[52:55], v[76:79], v[28:43]
    v_lshlrev_b32 v104, 16, v52
    v_and_b32 v105, 0xffff0000, v52
    v_lshlrev_b32 v106, 16, v53
    v_and_b32 v107, 0xffff0000, v53
    v_lshlrev_b32 v108, 16, v54
    v_and_b32 v109, 0xffff0000, v54
    v_lshlrev_b32 v110, 16, v55
    v_and_b32 v111, 0xffff0000, v55
    v_add_f32 v118, v118, v104
    v_fmac_f32 v120, v104, v104
    v_add_f32 v119, v119, v105
    v_fmac_f32 v121, v105, v105
    v_add_f32 v118, v118, v106
    v_fmac_f32 v120, v106, v106
    v_add_f32 v119, v119, v107
    v_fmac_f32 v121, v107, v107
    v_add_f32 v118, v118, v108
    v_fmac_f32 v120, v108, v108
    v_add_f32 v119, v119, v109
    v_fmac_f32 v121, v109, v109
    v_add_f32 v118, v118, v110
    v_fmac_f32 v120, v110, v110
    v_add_f32 v119, v119, v111
    v_fmac_f32 v121, v111, v111
    ds_read_b128 v[52:55], v84 offset:0
    ds_read_b64_tr_b16 v[72:73], v93 offset:20480
    ds_read_b64_tr_b16 v[74:75], v93 offset:21504
    ds_read_b64_tr_b16 v[76:77], v96 offset:20480
    ds_read_b64_tr_b16 v[78:79], v96 offset:21504
    s_waitcnt lgkmcnt(10)
    v_mfma_f32_32x32x16_bf16 v[12:27], v[44:47], v[56:59], v[12:27]
    v_mfma_f32_32x32x16_bf16 v[28:43], v[44:47], v[60:63], v[28:43]
    v_lshlrev_b32 v104, 16, v44
    v_and_b32 v105, 0xffff0000, v44
    v_lshlrev_b32 v106, 16, v45
    v_and_b32 v107, 0xffff0000, v45
    v_lshlrev_b32 v108, 16, v46
    v_and_b32 v109, 0xffff0000, v46
    v_lshlrev_b32 v110, 16, v47
    v_and_b32 v111, 0xffff0000, v47
    v_add_f32 v118, v118, v104
    v_fmac_f32 v120, v104, v104
    v_add_f32 v119, v119, v105
    v_fmac_f32 v121, v105, v105
    v_add_f32 v118, v118, v106
    v_fmac_f32 v120, v106, v106
    v_add_f32 v119, v119, v107
    v_fmac_f32 v121, v107, v107
    v_add_f32 v118, v118, v108
    v_fmac_f32 v120, v108, v108
    v_add_f32 v119, v119, v109
    v_fmac_f32 v121, v109, v109
    v_add_f32 v118, v118, v110
    v_fmac_f32 v120, v110, v110
    v_add_f32 v119, v119, v111
    v_fmac_f32 v121, v111, v111
    ds_read_b128 v[44:47], v87 offset:0
    ds_read_b64_tr_b16 v[56:57], v93 offset:24576
    ds_read_b64_tr_b16 v[58:59], v93 offset:25600
    ds_read_b64_tr_b16 v[60:61], v96 offset:24576
    ds_read_b64_tr_b16 v[62:63], v96 offset:25600
    s_waitcnt lgkmcnt(10)
    v_mfma_f32_32x32x16_bf16 v[12:27], v[48:51], v[64:67], v[12:27]
    v_mfma_f32_32x32x16_bf16 v[28:43], v[48:51], v[68:71], v[28:43]
    v_lshlrev_b32 v104, 16, v48
    v_and_b32 v105, 0xffff0000, v48
    v_lshlrev_b32 v106, 16, v49
    v_and_b32 v107, 0xffff0000, v49
    v_lshlrev_b32 v108, 16, v50
    v_and_b32 v109, 0xffff0000, v50
    v_lshlrev_b32 v110, 16, v51
    v_and_b32 v111, 0xffff0000, v51
    v_add_f32 v118, v118, v104
    v_fmac_f32 v120, v104, v104
    v_add_f32 v119, v119, v105
    v_fmac_f32 v121, v105, v105
    v_add_f32 v118, v118, v106
    v_fmac_f32 v120, v106, v106
    v_add_f32 v119, v119, v107
    v_fmac_f32 v121, v107, v107
    v_add_f32 v118, v118, v108
    v_fmac_f32 v120, v108, v108
    v_add_f32 v119, v119, v109
    v_fmac_f32 v121, v109, v109
    v_add_f32 v118, v118, v110
    v_fmac_f32 v120, v110, v110
    v_add_f32 v119, v119, v111
    v_fmac_f32 v121, v111, v111
    ds_read_b128 v[48:51], v90 offset:0
    ds_read_b64_tr_b16 v[64:65], v93 offset:28672
    ds_read_b64_tr_b16 v[66:67], v93 offset:29696
    ds_read_b64_tr_b16 v[68:69], v96 offset:28672
    ds_read_b64_tr_b16 v[70:71], v96 offset:29696
    s_waitcnt lgkmcnt(10)
    v_mfma_f32_32x32x16_bf16 v[12:27], v[52:55], v[72:75], v[12:27]
    v_mfma_f32_32x32x16_bf16 v[28:43], v[52:55], v[76:79], v[28:43]
    v_lshlrev_b32 v104, 16, v52
    v_and_b32 v105, 0xffff0000, v52
    v_lshlrev_b32 v106, 16, v53
    v_and_b32 v107, 0xffff0000, v53
    v_lshlrev_b32 v108, 16, v54
    v_and_b32 v109, 0xffff0000, v54
    v_lshlrev_b32 v110, 16, v55
    v_and_b32 v111, 0xffff0000, v55
    v_add_f32 v118, v118, v104
    v_fmac_f32 v120, v104, v104
    v_add_f32 v119, v119, v105
    v_fmac_f32 v121, v105, v105
    v_add_f32 v118, v118, v106
    v_fmac_f32 v120, v106, v106
    v_add_f32 v119, v119, v107
    v_fmac_f32 v121, v107, v107
    v_add_f32 v118, v118, v108
    v_fmac_f32 v120, v108, v108
    v_add_f32 v119, v119, v109
    v_fmac_f32 v121, v109, v109
    v_add_f32 v118, v118, v110
    v_fmac_f32 v120, v110, v110
    v_add_f32 v119, v119, v111
    v_fmac_f32 v121, v111, v111
    s_waitcnt lgkmcnt(5)
    v_mfma_f32_32x32x16_bf16 v[12:27], v[44:47], v[56:59], v[12:27]
    v_mfma_f32_32x32x16_bf16 v[28:43], v[44:47], v[60:63], v[28:43]
    v_lshlrev_b32 v104, 16, v44
    v_and_b32 v105, 0xffff0000, v44
    v_lshlrev_b32 v106, 16, v45
    v_and_b32 v107, 0xffff0000, v45
    v_lshlrev_b32 v108, 16, v46
    v_and_b32 v109, 0xffff0000, v46
    v_lshlrev_b32 v110, 16, v47
    v_and_b32 v111, 0xffff0000, v47
    v_add_f32 v118, v118, v104
    v_fmac_f32 v120, v104, v104
    v_add_f32 v119, v119, v105
    v_fmac_f32 v121, v105, v105
    v_add_f32 v118, v118, v106
    v_fmac_f32 v120, v106, v106
    v_add_f32 v119, v119, v107
    v_fmac_f32 v121, v107, v107
    v_add_f32 v118, v118, v108
    v_fmac_f32 v120, v108, v108
    v_add_f32 v119, v119, v109
    v_fmac_f32 v121, v109, v109
    v_add_f32 v118, v118, v110
    v_fmac_f32 v120, v110, v110
    v_add_f32 v119, v119, v111
    v_fmac_f32 v121, v111, v111
    s_waitcnt lgkmcnt(0)
    v_mfma_f32_32x32x16_bf16 v[12:27], v[48:51], v[64:67], v[12:27]
    v_mfma_f32_32x32x16_bf16 v[28:43], v[48:51], v[68:71], v[28:43]
    v_lshlrev_b32 v104, 16, v48
    v_and_b32 v105, 0xffff0000, v48
    v_lshlrev_b32 v106, 16, v49
    v_and_b32 v107, 0xffff0000, v49
    v_lshlrev_b32 v108, 16, v50
    v_and_b32 v109, 0xffff0000, v50
    v_lshlrev_b32 v110, 16, v51
    v_and_b32 v111, 0xffff0000, v51
    v_add_f32 v118, v118, v104
    v_fmac_f32 v120, v104, v104
    v_add_f32 v119, v119, v105
    v_fmac_f32 v121, v105, v105
    v_add_f32 v118, v118, v106
    v_fmac_f32 v120, v106, v106
    v_add_f32 v119, v119, v107
    v_fmac_f32 v121, v107, v107
    v_add_f32 v118, v118, v108
    v_fmac_f32 v120, v108, v108
    v_add_f32 v119, v119, v109
    v_fmac_f32 v121, v109, v109
    v_add_f32 v118, v118, v110
    v_fmac_f32 v120, v110, v110
    v_add_f32 v119, v119, v111
    v_fmac_f32 v121, v111, v111
    s_branch k1_e0_10
k1_0n_6:
    s_barrier
    ds_read_b128 v[44:47], v80 offset:0
    ds_read_b64_tr_b16 v[56:57], v92 offset:16384
    ds_read_b64_tr_b16 v[58:59], v92 offset:17408
    ds_read_b64_tr_b16 v[60:61], v95 offset:16384
    ds_read_b64_tr_b16 v[62:63], v95 offset:17408
    ds_read_b128 v[48:51], v83 offset:0
    ds_read_b64_tr_b16 v[64:65], v92 offset:20480
    ds_read_b64_tr_b16 v[66:67], v92 offset:21504
    ds_read_b64_tr_b16 v[68:69], v95 offset:20480
    ds_read_b64_tr_b16 v[70:71], v95 offset:21504
    ds_read_b128 v[52:55], v86 offset:0
    ds_read_b64_tr_b16 v[72:73], v92 offset:24576
    ds_read_b64_tr_b16 v[74:75], v92 offset:25600
    ds_read_b64_tr_b16 v[76:77], v95 offset:24576
    ds_read_b64_tr_b16 v[78:79], v95 offset:25600
    s_waitcnt lgkmcnt(10)
    v_mfma_f32_32x32x16_bf16 v[12:27], v[56:59], v[44:47], v[12:27]
    v_mfma_f32_32x32x16_bf16 v[28:43], v[60:63], v[44:47], v[28:43]
    v_lshlrev_b32 v104, 16, v44
    v_and_b32 v105, 0xffff0000, v44
    v_lshlrev_b32 v106, 16, v45
    v_and_b32 v107, 0xffff0000, v45
    v_lshlrev_b32 v108, 16, v46
    v_and_b32 v109, 0xffff0000, v46
    v_lshlrev_b32 v110, 16, v47
    v_and_b32 v111, 0xffff0000, v47
    v_add_f32 v118, v118, v104
    v_fmac_f32 v120, v104, v104
    v_add_f32 v119, v119, v105
    v_fmac_f32 v121, v105, v105
    v_add_f32 v118, v118, v106
    v_fmac_f32 v120, v106, v106
    v_add_f32 v119, v119, v107
    v_fmac_f32 v121, v107, v107
    v_add_f32 v118, v118, v108
    v_fmac_f32 v120, v108, v108
    v_add_f32 v119, v119, v109
    v_fmac_f32 v121, v109, v109
    v_add_f32 v118, v118, v110
    v_fmac_f32 v120, v110, v110
    v_add_f32 v119, v119, v111
    v_fmac_f32 v121, v111, v111
    ds_read_b128 v[44:47], v89 offset:0
    ds_read_b64_tr_b16 v[56:57], v92 offset:28672
    ds_read_b64_tr_b16 v[58:59], v92 offset:29696
    ds_read_b64_tr_b16 v[60:61], v95 offset:28672
    ds_read_b64_tr_b16 v[62:63], v95 offset:29696
    s_waitcnt lgkmcnt(10)
    v_mfma_f32_32x32x16_bf16 v[12:27], v[64:67], v[48:51], v[12:27]
    v_mfma_f32_32x32x16_bf16 v[28:43], v[68:71], v[48:51], v[28:43]
    v_lshlrev_b32 v104, 16, v48
    v_and_b32 v105, 0xffff0000, v48
    v_lshlrev_b32 v106, 16, v49
    v_and_b32 v107, 0xffff0000, v49
    v_lshlrev_b32 v108, 16, v50
    v_and_b32 v109, 0xffff0000, v50
    v_lshlrev_b32 v110, 16, v51
    v_and_b32 v111, 0xffff0000, v51
    v_add_f32 v118, v118, v104
    v_fmac_f32 v120, v104, v104
    v_add_f32 v119, v119, v105
    v_fmac_f32 v121, v105, v105
    v_add_f32 v118, v118, v106
    v_fmac_f32 v120, v106, v106
    v_add_f32 v119, v119, v107
    v_fmac_f32 v121, v107, v107
    v_add_f32 v118, v118, v108
    v_fmac_f32 v120, v108, v108
    v_add_f32 v119, v119, v109
    v_fmac_f32 v121, v109, v109
    v_add_f32 v118, v118, v110
    v_fmac_f32 v120, v110, v110
    v_add_f32 v119, v119, v111
    v_fmac_f32 v121, v111, v111
    s_barrier
    ds_read_b128 v[48:51], v80 offset:32768
    ds_read_b64_tr_b16 v[64:65], v92 offset:49152
    ds_read_b64_tr_b16 v[66:67], v92 offset:50176
    ds_read_b64_tr_b16 v[68:69], v95 offset:49152
    ds_read_b64_tr_b16 v[70:71], v95 offset:50176
    s_waitcnt lgkmcnt(10)
    v_mfma_f32_32x32x16_bf16 v[12:27], v[72:75], v[52:55], v[12:27]
    v_mfma_f32_32x32x16_bf16 v[28:43], v[76:79], v[52:55], v[28:43]
    v_lshlrev_b32 v104, 16, v52
    v_and_b32 v105, 0xffff0000, v52
    v_lshlrev_b32 v106, 16, v53
    v_and_b32 v107, 0xffff0000, v53
    v_lshlrev_b32 v108, 16, v54
    v_and_b32 v109, 0xffff0000, v54
    v_lshlrev_b32 v110, 16, v55
    v_and_b32 v111, 0xffff0000, v55
    v_add_f32 v118, v118, v104
    v_fmac_f32 v120, v104, v104
    v_add_f32 v119, v119, v105
    v_fmac_f32 v121, v105, v105
    v_add_f32 v118, v118, v106
    v_fmac_f32 v120, v106, v106
    v_add_f32 v119, v119, v107
    v_fmac_f32 v121, v107, v107
    v_add_f32 v118, v118, v108
    v_fmac_f32 v120, v108, v108
    v_add_f32 v119, v119, v109
    v_fmac_f32 v121, v109, v109
    v_add_f32 v118, v118, v110
    v_fmac_f32 v120, v110, v110
    v_add_f32 v119, v119, v111
    v_fmac_f32 v121, v111, v111
    ds_read_b128 v[52:55], v83 offset:32768
    ds_read_b64_tr_b16 v[72:73], v92 offset:53248
    ds_read_b64_tr_b16 v[74:75], v92 offset:54272
    ds_read_b64_tr_b16 v[76:77], v95 offset:53248
    ds_read_b64_tr_b16 v[78:79], v95 offset:54272
    s_waitcnt lgkmcnt(10)
    v_mfma_f32_32x32x16_bf16 v[12:27], v[56:59], v[44:47], v[12:27]
    v_mfma_f32_32x32x16_bf16 v[28:43], v[60:63], v[44:47], v[28:43]
    v_lshlrev_b32 v104, 16, v44
    v_and_b32 v105, 0xffff0000, v44
    v_lshlrev_b32 v106, 16, v45
    v_and_b32 v107, 0xffff0000, v45
    v_lshlrev_b32 v108, 16, v46
    v_and_b32 v109, 0xffff0000, v46
    v_lshlrev_b32 v110, 16, v47
    v_and_b32 v111, 0xffff0000, v47
    v_add_f32 v118, v118, v104
    v_fmac_f32 v120, v104, v104
    v_add_f32 v119, v119, v105
    v_fmac_f32 v121, v105, v105
    v_add_f32 v118, v118, v106
    v_fmac_f32 v120, v106, v106
    v_add_f32 v119, v119, v107
    v_fmac_f32 v121, v107, v107
    v_add_f32 v118, v118, v108
    v_fmac_f32 v120, v108, v108
    v_add_f32 v119, v119, v109
    v_fmac_f32 v121, v109, v109
    v_add_f32 v118, v118, v110
    v_fmac_f32 v120, v110, v110
    v_add_f32 v119, v119, v111
    v_fmac_f32 v121, v111, v111
    ds_read_b128 v[44:47], v86 offset:32768
    ds_read_b64_tr_b16 v[56:57], v92 offset:57344
    ds_read_b64_tr_b16 v[58:59], v92 offset:58368
    ds_read_b64_tr_b16 v[60:61], v95 offset:57344
    ds_read_b64_tr_b16 v[62:63], v95 offset:58368
    s_waitcnt lgkmcnt(10)
    v_mfma_f32_32x32x16_bf16 v[12:27], v[64:67], v[48:51], v[12:27]
    v_mfma_f32_32x32x16_bf16 v[28:43], v[68:71], v[48:51], v[28:43]
    v_lshlrev_b32 v104, 16, v48
    v_and_b32 v105, 0xffff0000, v48
    v_lshlrev_b32 v106, 16, v49
    v_and_b32 v107, 0xffff0000, v49
    v_lshlrev_b32 v108, 16, v50
    v_and_b32 v109, 0xffff0000, v50
    v_lshlrev_b32 v110, 16, v51
    v_and_b32 v111, 0xffff0000, v51
    v_add_f32 v118, v118, v104
    v_fmac_f32 v120, v104, v104
    v_add_f32 v119, v119, v105
    v_fmac_f32 v121, v105, v105
    v_add_f32 v118, v118, v106
    v_fmac_f32 v120, v106, v106
    v_add_f32 v119, v119, v107
    v_fmac_f32 v121, v107, v107
    v_add_f32 v118, v118, v108
    v_fmac_f32 v120, v108, v108
    v_add_f32 v119, v119, v109
    v_fmac_f32 v121, v109, v109
    v_add_f32 v118, v118, v110
    v_fmac_f32 v120, v110, v110
    v_add_f32 v119, v119, v111
    v_fmac_f32 v121, v111, v111
    ds_read_b128 v[48:51], v89 offset:32768
    ds_read_b64_tr_b16 v[64:65], v92 offset:61440
    ds_read_b64_tr_b16 v[66:67], v92 offset:62464
    ds_read_b64_tr_b16 v[68:69], v95 offset:61440
    ds_read_b64_tr_b16 v[70:71], v95 offset:62464
    s_waitcnt lgkmcnt(10)
    v_mfma_f32_32x32x16_bf16 v[12:27], v[72:75], v[52:55], v[12:27]
    v_mfma_f32_32x32x16_bf16 v[28:43], v[76:79], v[52:55], v[28:43]
    v_lshlrev_b32 v104, 16, v52
    v_and_b32 v105, 0xffff0000, v52
    v_lshlrev_b32 v106, 16, v53
    v_and_b32 v107, 0xffff0000, v53
    v_lshlrev_b32 v108, 16, v54
    v_and_b32 v109, 0xffff0000, v54
    v_lshlrev_b32 v110, 16, v55
    v_and_b32 v111, 0xffff0000, v55
    v_add_f32 v118, v118, v104
    v_fmac_f32 v120, v104, v104
    v_add_f32 v119, v119, v105
    v_fmac_f32 v121, v105, v105
    v_add_f32 v118, v118, v106
    v_fmac_f32 v120, v106, v106
    v_add_f32 v119, v119, v107
    v_fmac_f32 v121, v107, v107
    v_add_f32 v118, v118, v108
    v_fmac_f32 v120, v108, v108
    v_add_f32 v119, v119, v109
    v_fmac_f32 v121, v109, v109
    v_add_f32 v118, v118, v110
    v_fmac_f32 v120, v110, v110
    v_add_f32 v119, v119, v111
    v_fmac_f32 v121, v111, v111
    s_barrier
    ds_read_b128 v[52:55], v81 offset:0
    ds_read_b64_tr_b16 v[72:73], v93 offset:16384
    ds_read_b64_tr_b16 v[74:75], v93 offset:17408
    ds_read_b64_tr_b16 v[76:77], v96 offset:16384
    ds_read_b64_tr_b16 v[78:79], v96 offset:17408
    s_waitcnt lgkmcnt(10)
    v_mfma_f32_32x32x16_bf16 v[12:27], v[56:59], v[44:47], v[12:27]
    v_mfma_f32_32x32x16_bf16 v[28:43], v[60:63], v[44:47], v[28:43]
    v_lshlrev_b32 v104, 16, v44
    v_and_b32 v105, 0xffff0000, v44
    v_lshlrev_b32 v106, 16, v45
    v_and_b32 v107, 0xffff0000, v45
    v_lshlrev_b32 v108, 16, v46
    v_and_b32 v109, 0xffff0000, v46
    v_lshlrev_b32 v110, 16, v47
    v_and_b32 v111, 0xffff0000, v47
    v_add_f32 v118, v118, v104
    v_fmac_f32 v120, v104, v104
    v_add_f32 v119, v119, v105
    v_fmac_f32 v121, v105, v105
    v_add_f32 v118, v118, v106
    v_fmac_f32 v120, v106, v106
    v_add_f32 v119, v119, v107
    v_fmac_f32 v121, v107, v107
    v_add_f32 v118, v118, v108
    v_fmac_f32 v120, v108, v108
    v_add_f32 v119, v119, v109
    v_fmac_f32 v121, v109, v109
    v_add_f32 v118, v118, v110
    v_fmac_f32 v120, v110, v110
    v_add_f32 v119, v119, v111
    v_fmac_f32 v121, v111, v111
    ds_read_b128 v[44:47], v84 offset:0
    ds_read_b64_tr_b16 v[56:57], v93 offset:20480
    ds_read_b64_tr_b16 v[58:59], v93 offset:21504
    ds_read_b64_tr_b16 v[60:61], v96 offset:20480
    ds_read_b64_tr_b16 v[62:63], v96 offset:21504
    s_waitcnt lgkmcnt(10)
    v_mfma_f32_32x32x16_bf16 v[12:27], v[64:67], v[48:51], v[12:27]
    v_mfma_f32_32x32x16_bf16 v[28:43], v[68:71], v[48:51], v[28:43]
    v_lshlrev_b32 v104, 16, v48
    v_and_b32 v105, 0xffff0000, v48
    v_lshlrev_b32 v106, 16, v49
    v_and_b32 v107, 0xffff0000, v49
    v_lshlrev_b32 v108, 16, v50
    v_and_b32 v109, 0xffff0000, v50
    v_lshlrev_b32 v110, 16, v51
    v_and_b32 v111, 0xffff0000, v51
    v_add_f32 v118, v118, v104
    v_fmac_f32 v120, v104, v104
    v_add_f32 v119, v119, v105
    v_fmac_f32 v121, v105, v105
    v_add_f32 v118, v118, v106
    v_fmac_f32 v120, v106, v106
    v_add_f32 v119, v119, v107
    v_fmac_f32 v121, v107, v107
    v_add_f32 v118, v118, v108
    v_fmac_f32 v120, v108, v108
    v_add_f32 v119, v119, v109
    v_fmac_f32 v121, v109, v109
    v_add_f32 v118, v118, v110
    v_fmac_f32 v120, v110, v110
    v_add_f32 v119, v119, v111
    v_fmac_f32 v121, v111, v111
    ds_read_b128 v[48:51], v87 offset:0
    ds_read_b64_tr_b16 v[64:65], v93 offset:24576
    ds_read_b64_tr_b16 v[66:67], v93 offset:25600
    ds_read_b64_tr_b16 v[68:69], v96 offset:24576
    ds_read_b64_tr_b16 v[70:71], v96 offset:25600
    s_waitcnt lgkmcnt(10)
    v_mfma_f32_32x32x16_bf16 v[12:27], v[72:75], v[52:55], v[12:27]
    v_mfma_f32_32x32x16_bf16 v[28:43], v[76:79], v[52:55], v[28:43]
    v_lshlrev_b32 v104, 16, v52
    v_and_b32 v105, 0xffff0000, v52
    v_lshlrev_b32 v106, 16, v53
    v_and_b32 v107, 0xffff0000, v53
    v_lshlrev_b32 v108, 16, v54
    v_and_b32 v109, 0xffff0000, v54
    v_lshlrev_b32 v110, 16, v55
    v_and_b32 v111, 0xffff0000, v55
    v_add_f32 v118, v118, v104
    v_fmac_f32 v120, v104, v104
    v_add_f32 v119, v119, v105
    v_fmac_f32 v121, v105, v105
    v_add_f32 v118, v118, v106
    v_fmac_f32 v120, v106, v106
    v_add_f32 v119, v119, v107
    v_fmac_f32 v121, v107, v107
    v_add_f32 v118, v118, v108
    v_fmac_f32 v120, v108, v108
    v_add_f32 v119, v119, v109
    v_fmac_f32 v121, v109, v109
    v_add_f32 v118, v118, v110
    v_fmac_f32 v120, v110, v110
    v_add_f32 v119, v119, v111
    v_fmac_f32 v121, v111, v111
    ds_read_b128 v[52:55], v90 offset:0
    ds_read_b64_tr_b16 v[72:73], v93 offset:28672
    ds_read_b64_tr_b16 v[74:75], v93 offset:29696
    ds_read_b64_tr_b16 v[76:77], v96 offset:28672
    ds_read_b64_tr_b16 v[78:79], v96 offset:29696
    s_waitcnt lgkmcnt(10)
    v_mfma_f32_32x32x16_bf16 v[12:27], v[56:59], v[44:47], v[12:27]
    v_mfma_f32_32x32x16_bf16 v[28:43], v[60:63], v[44:47], v[28:43]
    v_lshlrev_b32 v104, 16, v44
    v_and_b32 v105, 0xffff0000, v44
    v_lshlrev_b32 v106, 16, v45
    v_and_b32 v107, 0xffff0000, v45
    v_lshlrev_b32 v108, 16, v46
    v_and_b32 v109, 0xffff0000, v46
    v_lshlrev_b32 v110, 16, v47
    v_and_b32 v111, 0xffff0000, v47
    v_add_f32 v118, v118, v104
    v_fmac_f32 v120, v104, v104
    v_add_f32 v119, v119, v105
    v_fmac_f32 v121, v105, v105
    v_add_f32 v118, v118, v106
    v_fmac_f32 v120, v106, v106
    v_add_f32 v119, v119, v107
    v_fmac_f32 v121, v107, v107
    v_add_f32 v118, v118, v108
    v_fmac_f32 v120, v108, v108
    v_add_f32 v119, v119, v109
    v_fmac_f32 v121, v109, v109
    v_add_f32 v118, v118, v110
    v_fmac_f32 v120, v110, v110
    v_add_f32 v119, v119, v111
    v_fmac_f32 v121, v111, v111
    s_barrier
    ds_read_b128 v[44:47], v81 offset:32768
    ds_read_b64_tr_b16 v[56:57], v93 offset:49152
    ds_read_b64_tr_b16 v[58:59], v93 offset:50176
    ds_read_b64_tr_b16 v[60:61], v96 offset:49152
    ds_read_b64_tr_b16 v[62:63], v96 offset:50176
    s_waitcnt lgkmcnt(10)
    v_mfma_f32_32x32x16_bf16 v[12:27], v[64:67], v[48:51], v[12:27]
    v_mfma_f32_32x32x16_bf16 v[28:43], v[68:71], v[48:51], v[28:43]
    v_lshlrev_b32 v104, 16, v48
    v_and_b32 v105, 0xffff0000, v48
    v_lshlrev_b32 v106, 16, v49
    v_and_b32 v107, 0xffff0000, v49
    v_lshlrev_b32 v108, 16, v50
    v_and_b32 v109, 0xffff0000, v50
    v_lshlrev_b32 v110, 16, v51
    v_and_b32 v111, 0xffff0000, v51
    v_add_f32 v118, v118, v104
    v_fmac_f32 v120, v104, v104
    v_add_f32 v119, v119, v105
    v_fmac_f32 v121, v105, v105
    v_add_f32 v118, v118, v106
    v_fmac_f32 v120, v106, v106
    v_add_f32 v119, v119, v107
    v_fmac_f32 v121, v107, v107
    v_add_f32 v118, v118, v108
    v_fmac_f32 v120, v108, v108
    v_add_f32 v119, v119, v109
    v_fmac_f32 v121, v109, v109
    v_add_f32 v118, v118, v110
    v_fmac_f32 v120, v110, v110
    v_add_f32 v119, v119, v111
    v_fmac_f32 v121, v111, v111
    ds_read_b128 v[48:51], v84 offset:32768
    ds_read_b64_tr_b16 v[64:65], v93 offset:53248
    ds_read_b64_tr_b16 v[66:67], v93 offset:54272
    ds_read_b64_tr_b16 v[68:69], v96 offset:53248
    ds_read_b64_tr_b16 v[70:71], v96 offset:54272
    s_waitcnt lgkmcnt(10)
    v_mfma_f32_32x32x16_bf16 v[12:27], v[72:75], v[52:55], v[12:27]
    v_mfma_f32_32x32x16_bf16 v[28:43], v[76:79], v[52:55], v[28:43]
    v_lshlrev_b32 v104, 16, v52
    v_and_b32 v105, 0xffff0000, v52
    v_lshlrev_b32 v106, 16, v53
    v_and_b32 v107, 0xffff0000, v53
    v_lshlrev_b32 v108, 16, v54
    v_and_b32 v109, 0xffff0000, v54
    v_lshlrev_b32 v110, 16, v55
    v_and_b32 v111, 0xffff0000, v55
    v_add_f32 v118, v118, v104
    v_fmac_f32 v120, v104, v104
    v_add_f32 v119, v119, v105
    v_fmac_f32 v121, v105, v105
    v_add_f32 v118, v118, v106
    v_fmac_f32 v120, v106, v106
    v_add_f32 v119, v119, v107
    v_fmac_f32 v121, v107, v107
    v_add_f32 v118, v118, v108
    v_fmac_f32 v120, v108, v108
    v_add_f32 v119, v119, v109
    v_fmac_f32 v121, v109, v109
    v_add_f32 v118, v118, v110
    v_fmac_f32 v120, v110, v110
    v_add_f32 v119, v119, v111
    v_fmac_f32 v121, v111, v111
    ds_read_b128 v[52:55], v87 offset:32768
    ds_read_b64_tr_b16 v[72:73], v93 offset:57344
    ds_read_b64_tr_b16 v[74:75], v93 offset:58368
    ds_read_b64_tr_b16 v[76:77], v96 offset:57344
    ds_read_b64_tr_b16 v[78:79], v96 offset:58368
    s_waitcnt lgkmcnt(10)
    v_mfma_f32_32x32x16_bf16 v[12:27], v[56:59], v[44:47], v[12:27]
    v_mfma_f32_32x32x16_bf16 v[28:43], v[60:63], v[44:47], v[28:43]
    v_lshlrev_b32 v104, 16, v44
    v_and_b32 v105, 0xffff0000, v44
    v_lshlrev_b32 v106, 16, v45
    v_and_b32 v107, 0xffff0000, v45
    v_lshlrev_b32 v108, 16, v46
    v_and_b32 v109, 0xffff0000, v46
    v_lshlrev_b32 v110, 16, v47
    v_and_b32 v111, 0xffff0000, v47
    v_add_f32 v118, v118, v104
    v_fmac_f32 v120, v104, v104
    v_add_f32 v119, v119, v105
    v_fmac_f32 v121, v105, v105
    v_add_f32 v118, v118, v106
    v_fmac_f32 v120, v106, v106
    v_add_f32 v119, v119, v107
    v_fmac_f32 v121, v107, v107
    v_add_f32 v118, v118, v108
    v_fmac_f32 v120, v108, v108
    v_add_f32 v119, v119, v109
    v_fmac_f32 v121, v109, v109
    v_add_f32 v118, v118, v110
    v_fmac_f32 v120, v110, v110
    v_add_f32 v119, v119, v111
    v_fmac_f32 v121, v111, v111
    ds_read_b128 v[44:47], v90 offset:32768
    ds_read_b64_tr_b16 v[56:57], v93 offset:61440
    ds_read_b64_tr_b16 v[58:59], v93 offset:62464
    ds_read_b64_tr_b16 v[60:61], v96 offset:61440
    ds_read_b64_tr_b16 v[62:63], v96 offset:62464
    s_waitcnt lgkmcnt(10)
    v_mfma_f32_32x32x16_bf16 v[12:27], v[64:67], v[48:51], v[12:27]
    v_mfma_f32_32x32x16_bf16 v[28:43], v[68:71], v[48:51], v[28:43]
    v_lshlrev_b32 v104, 16, v48
    v_and_b32 v105, 0xffff0000, v48
    v_lshlrev_b32 v106, 16, v49
    v_and_b32 v107, 0xffff0000, v49
    v_lshlrev_b32 v108, 16, v50
    v_and_b32 v109, 0xffff0000, v50
    v_lshlrev_b32 v110, 16, v51
    v_and_b32 v111, 0xffff0000, v51
    v_add_f32 v118, v118, v104
    v_fmac_f32 v120, v104, v104
    v_add_f32 v119, v119, v105
    v_fmac_f32 v121, v105, v105
    v_add_f32 v118, v118, v106
    v_fmac_f32 v120, v106, v106
    v_add_f32 v119, v119, v107
    v_fmac_f32 v121, v107, v107
    v_add_f32 v118, v118, v108
    v_fmac_f32 v120, v108, v108
    v_add_f32 v119, v119, v109
    v_fmac_f32 v121, v109, v109
    v_add_f32 v118, v118, v110
    v_fmac_f32 v120, v110, v110
    v_add_f32 v119, v119, v111
    v_fmac_f32 v121, v111, v111
    s_barrier
    ds_read_b128 v[48:51], v82 offset:0
    ds_read_b64_tr_b16 v[64:65], v94 offset:16384
    ds_read_b64_tr_b16 v[66:67], v94 offset:17408
    ds_read_b64_tr_b16 v[68:69], v97 offset:16384
    ds_read_b64_tr_b16 v[70:71], v97 offset:17408
    s_waitcnt lgkmcnt(10)
    v_mfma_f32_32x32x16_bf16 v[12:27], v[72:75], v[52:55], v[12:27]
    v_mfma_f32_32x32x16_bf16 v[28:43], v[76:79], v[52:55], v[28:43]
    v_lshlrev_b32 v104, 16, v52
    v_and_b32 v105, 0xffff0000, v52
    v_lshlrev_b32 v106, 16, v53
    v_and_b32 v107, 0xffff0000, v53
    v_lshlrev_b32 v108, 16, v54
    v_and_b32 v109, 0xffff0000, v54
    v_lshlrev_b32 v110, 16, v55
    v_and_b32 v111, 0xffff0000, v55
    v_add_f32 v118, v118, v104
    v_fmac_f32 v120, v104, v104
    v_add_f32 v119, v119, v105
    v_fmac_f32 v121, v105, v105
    v_add_f32 v118, v118, v106
    v_fmac_f32 v120, v106, v106
    v_add_f32 v119, v119, v107
    v_fmac_f32 v121, v107, v107
    v_add_f32 v118, v118, v108
    v_fmac_f32 v120, v108, v108
    v_add_f32 v119, v119, v109
    v_fmac_f32 v121, v109, v109
    v_add_f32 v118, v118, v110
    v_fmac_f32 v120, v110, v110
    v_add_f32 v119, v119, v111
    v_fmac_f32 v121, v111, v111
    ds_read_b128 v[52:55], v85 offset:0
    ds_read_b64_tr_b16 v[72:73], v94 offset:20480
    ds_read_b64_tr_b16 v[74:75], v94 offset:21504
    ds_read_b64_tr_b16 v[76:77], v97 offset:20480
    ds_read_b64_tr_b16 v[78:79], v97 offset:21504
    s_waitcnt lgkmcnt(10)
    v_mfma_f32_32x32x16_bf16 v[12:27], v[56:59], v[44:47], v[12:27]
    v_mfma_f32_32x32x16_bf16 v[28:43], v[60:63], v[44:47], v[28:43]
    v_lshlrev_b32 v104, 16, v44
    v_and_b32 v105, 0xffff0000, v44
    v_lshlrev_b32 v106, 16, v45
    v_and_b32 v107, 0xffff0000, v45
    v_lshlrev_b32 v108, 16, v46
    v_and_b32 v109, 0xffff0000, v46
    v_lshlrev_b32 v110, 16, v47
    v_and_b32 v111, 0xffff0000, v47
    v_add_f32 v118, v118, v104
    v_fmac_f32 v120, v104, v104
    v_add_f32 v119, v119, v105
    v_fmac_f32 v121, v105, v105
    v_add_f32 v118, v118, v106
    v_fmac_f32 v120, v106, v106
    v_add_f32 v119, v119, v107
    v_fmac_f32 v121, v107, v107
    v_add_f32 v118, v118, v108
    v_fmac_f32 v120, v108, v108
    v_add_f32 v119, v119, v109
    v_fmac_f32 v121, v109, v109
    v_add_f32 v118, v118, v110
    v_fmac_f32 v120, v110, v110
    v_add_f32 v119, v119, v111
    v_fmac_f32 v121, v111, v111
    ds_read_b128 v[44:47], v88 offset:0
    ds_read_b64_tr_b16 v[56:57], v94 offset:24576
    ds_read_b64_tr_b16 v[58:59], v94 offset:25600
    ds_read_b64_tr_b16 v[60:61], v97 offset:24576
    ds_read_b64_tr_b16 v[62:63], v97 offset:25600
    s_waitcnt lgkmcnt(10)
    v_mfma_f32_32x32x16_bf16 v[12:27], v[64:67], v[48:51], v[12:27]
    v_mfma_f32_32x32x16_bf16 v[28:43], v[68:71], v[48:51], v[28:43]
    v_lshlrev_b32 v104, 16, v48
    v_and_b32 v105, 0xffff0000, v48
    v_lshlrev_b32 v106, 16, v49
    v_and_b32 v107, 0xffff0000, v49
    v_lshlrev_b32 v108, 16, v50
    v_and_b32 v109, 0xffff0000, v50
    v_lshlrev_b32 v110, 16, v51
    v_and_b32 v111, 0xffff0000, v51
    v_add_f32 v118, v118, v104
    v_fmac_f32 v120, v104, v104
    v_add_f32 v119, v119, v105
    v_fmac_f32 v121, v105, v105
    v_add_f32 v118, v118, v106
    v_fmac_f32 v120, v106, v106
    v_add_f32 v119, v119, v107
    v_fmac_f32 v121, v107, v107
    v_add_f32 v118, v118, v108
    v_fmac_f32 v120, v108, v108
    v_add_f32 v119, v119, v109
    v_fmac_f32 v121, v109, v109
    v_add_f32 v118, v118, v110
    v_fmac_f32 v120, v110, v110
    v_add_f32 v119, v119, v111
    v_fmac_f32 v121, v111, v111
    ds_read_b128 v[48:51], v91 offset:0
    ds_read_b64_tr_b16 v[64:65], v94 offset:28672
    ds_read_b64_tr_b16 v[66:67], v94 offset:29696
    ds_read_b64_tr_b16 v[68:69], v97 offset:28672
    ds_read_b64_tr_b16 v[70:71], v97 offset:29696
    s_waitcnt lgkmcnt(10)
    v_mfma_f32_32x32x16_bf16 v[12:27], v[72:75], v[52:55], v[12:27]
    v_mfma_f32_32x32x16_bf16 v[28:43], v[76:79], v[52:55], v[28:43]
    v_lshlrev_b32 v104, 16, v52
    v_and_b32 v105, 0xffff0000, v52
    v_lshlrev_b32 v106, 16, v53
    v_and_b32 v107, 0xffff0000, v53
    v_lshlrev_b32 v108, 16, v54
    v_and_b32 v109, 0xffff0000, v54
    v_lshlrev_b32 v110, 16, v55
    v_and_b32 v111, 0xffff0000, v55
    v_add_f32 v118, v118, v104
    v_fmac_f32 v120, v104, v104
    v_add_f32 v119, v119, v105
    v_fmac_f32 v121, v105, v105
    v_add_f32 v118, v118, v106
    v_fmac_f32 v120, v106, v106
    v_add_f32 v119, v119, v107
    v_fmac_f32 v121, v107, v107
    v_add_f32 v118, v118, v108
    v_fmac_f32 v120, v108, v108
    v_add_f32 v119, v119, v109
    v_fmac_f32 v121, v109, v109
    v_add_f32 v118, v118, v110
    v_fmac_f32 v120, v110, v110
    v_add_f32 v119, v119, v111
    v_fmac_f32 v121, v111, v111
    s_barrier
    ds_read_b128 v[52:55], v80 offset:0
    ds_read_b64_tr_b16 v[72:73], v92 offset:16384
    ds_read_b64_tr_b16 v[74:75], v92 offset:17408
    ds_read_b64_tr_b16 v[76:77], v95 offset:16384
    ds_read_b64_tr_b16 v[78:79], v95 offset:17408
    s_waitcnt lgkmcnt(10)
    v_mfma_f32_32x32x16_bf16 v[12:27], v[56:59], v[44:47], v[12:27]
    v_mfma_f32_32x32x16_bf16 v[28:43], v[60:63], v[44:47], v[28:43]
    v_lshlrev_b32 v104, 16, v44
    v_and_b32 v105, 0xffff0000, v44
    v_lshlrev_b32 v106, 16, v45
    v_and_b32 v107, 0xffff0000, v45
    v_lshlrev_b32 v108, 16, v46
    v_and_b32 v109, 0xffff0000, v46
    v_lshlrev_b32 v110, 16, v47
    v_and_b32 v111, 0xffff0000, v47
    v_add_f32 v118, v118, v104
    v_fmac_f32 v120, v104, v104
    v_add_f32 v119, v119, v105
    v_fmac_f32 v121, v105, v105
    v_add_f32 v118, v118, v106
    v_fmac_f32 v120, v106, v106
    v_add_f32 v119, v119, v107
    v_fmac_f32 v121, v107, v107
    v_add_f32 v118, v118, v108
    v_fmac_f32 v120, v108, v108
    v_add_f32 v119, v119, v109
    v_fmac_f32 v121, v109, v109
    v_add_f32 v118, v118, v110
    v_fmac_f32 v120, v110, v110
    v_add_f32 v119, v119, v111
    v_fmac_f32 v121, v111, v111
    ds_read_b128 v[44:47], v83 offset:0
    ds_read_b64_tr_b16 v[56:57], v92 offset:20480
    ds_read_b64_tr_b16 v[58:59], v92 offset:21504
    ds_read_b64_tr_b16 v[60:61], v95 offset:20480
    ds_read_b64_tr_b16 v[62:63], v95 offset:21504
    s_waitcnt lgkmcnt(10)
    v_mfma_f32_32x32x16_bf16 v[12:27], v[64:67], v[48:51], v[12:27]
    v_mfma_f32_32x32x16_bf16 v[28:43], v[68:71], v[48:51], v[28:43]
    v_lshlrev_b32 v104, 16, v48
    v_and_b32 v105, 0xffff0000, v48
    v_lshlrev_b32 v106, 16, v49
    v_and_b32 v107, 0xffff0000, v49
    v_lshlrev_b32 v108, 16, v50
    v_and_b32 v109, 0xffff0000, v50
    v_lshlrev_b32 v110, 16, v51
    v_and_b32 v111, 0xffff0000, v51
    v_add_f32 v118, v118, v104
    v_fmac_f32 v120, v104, v104
    v_add_f32 v119, v119, v105
    v_fmac_f32 v121, v105, v105
    v_add_f32 v118, v118, v106
    v_fmac_f32 v120, v106, v106
    v_add_f32 v119, v119, v107
    v_fmac_f32 v121, v107, v107
    v_add_f32 v118, v118, v108
    v_fmac_f32 v120, v108, v108
    v_add_f32 v119, v119, v109
    v_fmac_f32 v121, v109, v109
    v_add_f32 v118, v118, v110
    v_fmac_f32 v120, v110, v110
    v_add_f32 v119, v119, v111
    v_fmac_f32 v121, v111, v111
    ds_read_b128 v[48:51], v86 offset:0
    ds_read_b64_tr_b16 v[64:65], v92 offset:24576
    ds_read_b64_tr_b16 v[66:67], v92 offset:25600
    ds_read_b64_tr_b16 v[68:69], v95 offset:24576
    ds_read_b64_tr_b16 v[70:71], v95 offset:25600
    s_waitcnt lgkmcnt(10)
    v_mfma_f32_32x32x16_bf16 v[12:27], v[72:75], v[52:55], v[12:27]
    v_mfma_f32_32x32x16_bf16 v[28:43], v[76:79], v[52:55], v[28:43]
    v_lshlrev_b32 v104, 16, v52
    v_and_b32 v105, 0xffff0000, v52
    v_lshlrev_b32 v106, 16, v53
    v_and_b32 v107, 0xffff0000, v53
    v_lshlrev_b32 v108, 16, v54
    v_and_b32 v109, 0xffff0000, v54
    v_lshlrev_b32 v110, 16, v55
    v_and_b32 v111, 0xffff0000, v55
    v_add_f32 v118, v118, v104
    v_fmac_f32 v120, v104, v104
    v_add_f32 v119, v119, v105
    v_fmac_f32 v121, v105, v105
    v_add_f32 v118, v118, v106
    v_fmac_f32 v120, v106, v106
    v_add_f32 v119, v119, v107
    v_fmac_f32 v121, v107, v107
    v_add_f32 v118, v118, v108
    v_fmac_f32 v120, v108, v108
    v_add_f32 v119, v119, v109
    v_fmac_f32 v121, v109, v109
    v_add_f32 v118, v118, v110
    v_fmac_f32 v120, v110, v110
    v_add_f32 v119, v119, v111
    v_fmac_f32 v121, v111, v111
    ds_read_b128 v[52:55], v89 offset:0
    ds_read_b64_tr_b16 v[72:73], v92 offset:28672
    ds_read_b64_tr_b16 v[74:75], v92 offset:29696
    ds_read_b64_tr_b16 v[76:77], v95 offset:28672
    ds_read_b64_tr_b16 v[78:79], v95 offset:29696
    s_waitcnt lgkmcnt(10)
    v_mfma_f32_32x32x16_bf16 v[12:27], v[56:59], v[44:47], v[12:27]
    v_mfma_f32_32x32x16_bf16 v[28:43], v[60:63], v[44:47], v[28:43]
    v_lshlrev_b32 v104, 16, v44
    v_and_b32 v105, 0xffff0000, v44
    v_lshlrev_b32 v106, 16, v45
    v_and_b32 v107, 0xffff0000, v45
    v_lshlrev_b32 v108, 16, v46
    v_and_b32 v109, 0xffff0000, v46
    v_lshlrev_b32 v110, 16, v47
    v_and_b32 v111, 0xffff0000, v47
    v_add_f32 v118, v118, v104
    v_fmac_f32 v120, v104, v104
    v_add_f32 v119, v119, v105
    v_fmac_f32 v121, v105, v105
    v_add_f32 v118, v118, v106
    v_fmac_f32 v120, v106, v106
    v_add_f32 v119, v119, v107
    v_fmac_f32 v121, v107, v107
    v_add_f32 v118, v118, v108
    v_fmac_f32 v120, v108, v108
    v_add_f32 v119, v119, v109
    v_fmac_f32 v121, v109, v109
    v_add_f32 v118, v118, v110
    v_fmac_f32 v120, v110, v110
    v_add_f32 v119, v119, v111
    v_fmac_f32 v121, v111, v111
    s_barrier
    ds_read_b128 v[44:47], v80 offset:32768
    ds_read_b64_tr_b16 v[56:57], v92 offset:49152
    ds_read_b64_tr_b16 v[58:59], v92 offset:50176
    ds_read_b64_tr_b16 v[60:61], v95 offset:49152
    ds_read_b64_tr_b16 v[62:63], v95 offset:50176
    s_waitcnt lgkmcnt(10)
    v_mfma_f32_32x32x16_bf16 v[12:27], v[64:67], v[48:51], v[12:27]
    v_mfma_f32_32x32x16_bf16 v[28:43], v[68:71], v[48:51], v[28:43]
    v_lshlrev_b32 v104, 16, v48
    v_and_b32 v105, 0xffff0000, v48
    v_lshlrev_b32 v106, 16, v49
    v_and_b32 v107, 0xffff0000, v49
    v_lshlrev_b32 v108, 16, v50
    v_and_b32 v109, 0xffff0000, v50
    v_lshlrev_b32 v110, 16, v51
    v_and_b32 v111, 0xffff0000, v51
    v_add_f32 v118, v118, v104
    v_fmac_f32 v120, v104, v104
    v_add_f32 v119, v119, v105
    v_fmac_f32 v121, v105, v105
    v_add_f32 v118, v118, v106
    v_fmac_f32 v120, v106, v106
    v_add_f32 v119, v119, v107
    v_fmac_f32 v121, v107, v107
    v_add_f32 v118, v118, v108
    v_fmac_f32 v120, v108, v108
    v_add_f32 v119, v119, v109
    v_fmac_f32 v121, v109, v109
    v_add_f32 v118, v118, v110
    v_fmac_f32 v120, v110, v110
    v_add_f32 v119, v119, v111
    v_fmac_f32 v121, v111, v111
    ds_read_b128 v[48:51], v83 offset:32768
    ds_read_b64_tr_b16 v[64:65], v92 offset:53248
    ds_read_b64_tr_b16 v[66:67], v92 offset:54272
    ds_read_b64_tr_b16 v[68:69], v95 offset:53248
    ds_read_b64_tr_b16 v[70:71], v95 offset:54272
    s_waitcnt lgkmcnt(10)
    v_mfma_f32_32x32x16_bf16 v[12:27], v[72:75], v[52:55], v[12:27]
    v_mfma_f32_32x32x16_bf16 v[28:43], v[76:79], v[52:55], v[28:43]
    v_lshlrev_b32 v104, 16, v52
    v_and_b32 v105, 0xffff0000, v52
    v_lshlrev_b32 v106, 16, v53
    v_and_b32 v107, 0xffff0000, v53
    v_lshlrev_b32 v108, 16, v54
    v_and_b32 v109, 0xffff0000, v54
    v_lshlrev_b32 v110, 16, v55
    v_and_b32 v111, 0xffff0000, v55
    v_add_f32 v118, v118, v104
    v_fmac_f32 v120, v104, v104
    v_add_f32 v119, v119, v105
    v_fmac_f32 v121, v105, v105
    v_add_f32 v118, v118, v106
    v_fmac_f32 v120, v106, v106
    v_add_f32 v119, v119, v107
    v_fmac_f32 v121, v107, v107
    v_add_f32 v118, v118, v108
    v_fmac_f32 v120, v108, v108
    v_add_f32 v119, v119, v109
    v_fmac_f32 v121, v109, v109
    v_add_f32 v118, v118, v110
    v_fmac_f32 v120, v110, v110
    v_add_f32 v119, v119, v111
    v_fmac_f32 v121, v111, v111
    ds_read_b128 v[52:55], v86 offset:32768
    ds_read_b64_tr_b16 v[72:73], v92 offset:57344
    ds_read_b64_tr_b16 v[74:75], v92 offset:58368
    ds_read_b64_tr_b16 v[76:77], v95 offset:57344
    ds_read_b64_tr_b16 v[78:79], v95 offset:58368
    s_waitcnt lgkmcnt(10)
    v_mfma_f32_32x32x16_bf16 v[12:27], v[56:59], v[44:47], v[12:27]
    v_mfma_f32_32x32x16_bf16 v[28:43], v[60:63], v[44:47], v[28:43]
    v_lshlrev_b32 v104, 16, v44
    v_and_b32 v105, 0xffff0000, v44
    v_lshlrev_b32 v106, 16, v45
    v_and_b32 v107, 0xffff0000, v45
    v_lshlrev_b32 v108, 16, v46
    v_and_b32 v109, 0xffff0000, v46
    v_lshlrev_b32 v110, 16, v47
    v_and_b32 v111, 0xffff0000, v47
    v_add_f32 v118, v118, v104
    v_fmac_f32 v120, v104, v104
    v_add_f32 v119, v119, v105
    v_fmac_f32 v121, v105, v105
    v_add_f32 v118, v118, v106
    v_fmac_f32 v120, v106, v106
    v_add_f32 v119, v119, v107
    v_fmac_f32 v121, v107, v107
    v_add_f32 v118, v118, v108
    v_fmac_f32 v120, v108, v108
    v_add_f32 v119, v119, v109
    v_fmac_f32 v121, v109, v109
    v_add_f32 v118, v118, v110
    v_fmac_f32 v120, v110, v110
    v_add_f32 v119, v119, v111
    v_fmac_f32 v121, v111, v111
    ds_read_b128 v[44:47], v89 offset:32768
    ds_read_b64_tr_b16 v[56:57], v92 offset:61440
    ds_read_b64_tr_b16 v[58:59], v92 offset:62464
    ds_read_b64_tr_b16 v[60:61], v95 offset:61440
    ds_read_b64_tr_b16 v[62:63], v95 offset:62464
    s_waitcnt lgkmcnt(10)
    v_mfma_f32_32x32x16_bf16 v[12:27], v[64:67], v[48:51], v[12:27]
    v_mfma_f32_32x32x16_bf16 v[28:43], v[68:71], v[48:51], v[28:43]
    v_lshlrev_b32 v104, 16, v48
    v_and_b32 v105, 0xffff0000, v48
    v_lshlrev_b32 v106, 16, v49
    v_and_b32 v107, 0xffff0000, v49
    v_lshlrev_b32 v108, 16, v50
    v_and_b32 v109, 0xffff0000, v50
    v_lshlrev_b32 v110, 16, v51
    v_and_b32 v111, 0xffff0000, v51
    v_add_f32 v118, v118, v104
    v_fmac_f32 v120, v104, v104
    v_add_f32 v119, v119, v105
    v_fmac_f32 v121, v105, v105
    v_add_f32 v118, v118, v106
    v_fmac_f32 v120, v106, v106
    v_add_f32 v119, v119, v107
    v_fmac_f32 v121, v107, v107
    v_add_f32 v118, v118, v108
    v_fmac_f32 v120, v108, v108
    v_add_f32 v119, v119, v109
    v_fmac_f32 v121, v109, v109
    v_add_f32 v118, v118, v110
    v_fmac_f32 v120, v110, v110
    v_add_f32 v119, v119, v111
    v_fmac_f32 v121, v111, v111
    s_barrier
    ds_read_b128 v[48:51], v81 offset:0
    ds_read_b64_tr_b16 v[64:65], v93 offset:16384
    ds_read_b64_tr_b16 v[66:67], v93 offset:17408
    ds_read_b64_tr_b16 v[68:69], v96 offset:16384
    ds_read_b64_tr_b16 v[70:71], v96 offset:17408
    s_waitcnt lgkmcnt(10)
    v_mfma_f32_32x32x16_bf16 v[12:27], v[72:75], v[52:55], v[12:27]
    v_mfma_f32_32x32x16_bf16 v[28:43], v[76:79], v[52:55], v[28:43]
    v_lshlrev_b32 v104, 16, v52
    v_and_b32 v105, 0xffff0000, v52
    v_lshlrev_b32 v106, 16, v53
    v_and_b32 v107, 0xffff0000, v53
    v_lshlrev_b32 v108, 16, v54
    v_and_b32 v109, 0xffff0000, v54
    v_lshlrev_b32 v110, 16, v55
    v_and_b32 v111, 0xffff0000, v55
    v_add_f32 v118, v118, v104
    v_fmac_f32 v120, v104, v104
    v_add_f32 v119, v119, v105
    v_fmac_f32 v121, v105, v105
    v_add_f32 v118, v118, v106
    v_fmac_f32 v120, v106, v106
    v_add_f32 v119, v119, v107
    v_fmac_f32 v121, v107, v107
    v_add_f32 v118, v118, v108
    v_fmac_f32 v120, v108, v108
    v_add_f32 v119, v119, v109
    v_fmac_f32 v121, v109, v109
    v_add_f32 v118, v118, v110
    v_fmac_f32 v120, v110, v110
    v_add_f32 v119, v119, v111
    v_fmac_f32 v121, v111, v111
    ds_read_b128 v[52:55], v84 offset:0
    ds_read_b64_tr_b16 v[72:73], v93 offset:20480
    ds_read_b64_tr_b16 v[74:75], v93 offset:21504
    ds_read_b64_tr_b16 v[76:77], v96 offset:20480
    ds_read_b64_tr_b16 v[78:79], v96 offset:21504
    s_waitcnt lgkmcnt(10)
    v_mfma_f32_32x32x16_bf16 v[12:27], v[56:59], v[44:47], v[12:27]
    v_mfma_f32_32x32x16_bf16 v[28:43], v[60:63], v[44:47], v[28:43]
    v_lshlrev_b32 v104, 16, v44
    v_and_b32 v105, 0xffff0000, v44
    v_lshlrev_b32 v106, 16, v45
    v_and_b32 v107, 0xffff0000, v45
    v_lshlrev_b32 v108, 16, v46
    v_and_b32 v109, 0xffff0000, v46
    v_lshlrev_b32 v110, 16, v47
    v_and_b32 v111, 0xffff0000, v47
    v_add_f32 v118, v118, v104
    v_fmac_f32 v120, v104, v104
    v_add_f32 v119, v119, v105
    v_fmac_f32 v121, v105, v105
    v_add_f32 v118, v118, v106
    v_fmac_f32 v120, v106, v106
    v_add_f32 v119, v119, v107
    v_fmac_f32 v121, v107, v107
    v_add_f32 v118, v118, v108
    v_fmac_f32 v120, v108, v108
    v_add_f32 v119, v119, v109
    v_fmac_f32 v121, v109, v109
    v_add_f32 v118, v118, v110
    v_fmac_f32 v120, v110, v110
    v_add_f32 v119, v119, v111
    v_fmac_f32 v121, v111, v111
    ds_read_b128 v[44:47], v87 offset:0
    ds_read_b64_tr_b16 v[56:57], v93 offset:24576
    ds_read_b64_tr_b16 v[58:59], v93 offset:25600
    ds_read_b64_tr_b16 v[60:61], v96 offset:24576
    ds_read_b64_tr_b16 v[62:63], v96 offset:25600
    s_waitcnt lgkmcnt(10)
    v_mfma_f32_32x32x16_bf16 v[12:27], v[64:67], v[48:51], v[12:27]
    v_mfma_f32_32x32x16_bf16 v[28:43], v[68:71], v[48:51], v[28:43]
    v_lshlrev_b32 v104, 16, v48
    v_and_b32 v105, 0xffff0000, v48
    v_lshlrev_b32 v106, 16, v49
    v_and_b32 v107, 0xffff0000, v49
    v_lshlrev_b32 v108, 16, v50
    v_and_b32 v109, 0xffff0000, v50
    v_lshlrev_b32 v110, 16, v51
    v_and_b32 v111, 0xffff0000, v51
    v_add_f32 v118, v118, v104
    v_fmac_f32 v120, v104, v104
    v_add_f32 v119, v119, v105
    v_fmac_f32 v121, v105, v105
    v_add_f32 v118, v118, v106
    v_fmac_f32 v120, v106, v106
    v_add_f32 v119, v119, v107
    v_fmac_f32 v121, v107, v107
    v_add_f32 v118, v118, v108
    v_fmac_f32 v120, v108, v108
    v_add_f32 v119, v119, v109
    v_fmac_f32 v121, v109, v109
    v_add_f32 v118, v118, v110
    v_fmac_f32 v120, v110, v110
    v_add_f32 v119, v119, v111
    v_fmac_f32 v121, v111, v111
    ds_read_b128 v[48:51], v90 offset:0
    ds_read_b64_tr_b16 v[64:65], v93 offset:28672
    ds_read_b64_tr_b16 v[66:67], v93 offset:29696
    ds_read_b64_tr_b16 v[68:69], v96 offset:28672
    ds_read_b64_tr_b16 v[70:71], v96 offset:29696
    s_waitcnt lgkmcnt(10)
    v_mfma_f32_32x32x16_bf16 v[12:27], v[72:75], v[52:55], v[12:27]
    v_mfma_f32_32x32x16_bf16 v[28:43], v[76:79], v[52:55], v[28:43]
    v_lshlrev_b32 v104, 16, v52
    v_and_b32 v105, 0xffff0000, v52
    v_lshlrev_b32 v106, 16, v53
    v_and_b32 v107, 0xffff0000, v53
    v_lshlrev_b32 v108, 16, v54
    v_and_b32 v109, 0xffff0000, v54
    v_lshlrev_b32 v110, 16, v55
    v_and_b32 v111, 0xffff0000, v55
    v_add_f32 v118, v118, v104
    v_fmac_f32 v120, v104, v104
    v_add_f32 v119, v119, v105
    v_fmac_f32 v121, v105, v105
    v_add_f32 v118, v118, v106
    v_fmac_f32 v120, v106, v106
    v_add_f32 v119, v119, v107
    v_fmac_f32 v121, v107, v107
    v_add_f32 v118, v118, v108
    v_fmac_f32 v120, v108, v108
    v_add_f32 v119, v119, v109
    v_fmac_f32 v121, v109, v109
    v_add_f32 v118, v118, v110
    v_fmac_f32 v120, v110, v110
    v_add_f32 v119, v119, v111
    v_fmac_f32 v121, v111, v111
    s_waitcnt lgkmcnt(5)
    v_mfma_f32_32x32x16_bf16 v[12:27], v[56:59], v[44:47], v[12:27]
    v_mfma_f32_32x32x16_bf16 v[28:43], v[60:63], v[44:47], v[28:43]
    v_lshlrev_b32 v104, 16, v44
    v_and_b32 v105, 0xffff0000, v44
    v_lshlrev_b32 v106, 16, v45
    v_and_b32 v107, 0xffff0000, v45
    v_lshlrev_b32 v108, 16, v46
    v_and_b32 v109, 0xffff0000, v46
    v_lshlrev_b32 v110, 16, v47
    v_and_b32 v111, 0xffff0000, v47
    v_add_f32 v118, v118, v104
    v_fmac_f32 v120, v104, v104
    v_add_f32 v119, v119, v105
    v_fmac_f32 v121, v105, v105
    v_add_f32 v118, v118, v106
    v_fmac_f32 v120, v106, v106
    v_add_f32 v119, v119, v107
    v_fmac_f32 v121, v107, v107
    v_add_f32 v118, v118, v108
    v_fmac_f32 v120, v108, v108
    v_add_f32 v119, v119, v109
    v_fmac_f32 v121, v109, v109
    v_add_f32 v118, v118, v110
    v_fmac_f32 v120, v110, v110
    v_add_f32 v119, v119, v111
    v_fmac_f32 v121, v111, v111
    s_waitcnt lgkmcnt(0)
    v_mfma_f32_32x32x16_bf16 v[12:27], v[64:67], v[48:51], v[12:27]
    v_mfma_f32_32x32x16_bf16 v[28:43], v[68:71], v[48:51], v[28:43]
    v_lshlrev_b32 v104, 16, v48
    v_and_b32 v105, 0xffff0000, v48
    v_lshlrev_b32 v106, 16, v49
    v_and_b32 v107, 0xffff0000, v49
    v_lshlrev_b32 v108, 16, v50
    v_and_b32 v109, 0xffff0000, v50
    v_lshlrev_b32 v110, 16, v51
    v_and_b32 v111, 0xffff0000, v51
    v_add_f32 v118, v118, v104
    v_fmac_f32 v120, v104, v104
    v_add_f32 v119, v119, v105
    v_fmac_f32 v121, v105, v105
    v_add_f32 v118, v118, v106
    v_fmac_f32 v120, v106, v106
    v_add_f32 v119, v119, v107
    v_fmac_f32 v121, v107, v107
    v_add_f32 v118, v118, v108
    v_fmac_f32 v120, v108, v108
    v_add_f32 v119, v119, v109
    v_fmac_f32 v121, v109, v109
    v_add_f32 v118, v118, v110
    v_fmac_f32 v120, v110, v110
    v_add_f32 v119, v119, v111
    v_fmac_f32 v121, v111, v111
k1_e0_10:
    v_add_f32 v98, v118, v119
    v_add_f32 v99, v120, v121
    v_mov_b32 v4, v98
    v_mov_b32 v5, v99
    s_nop 1
    v_permlane32_swap_b32 v4, v98
    v_permlane32_swap_b32 v5, v99
    v_add_f32 v98, v98, v4
    v_add_f32 v99, v99, v5
    s_lshl_b32 s35, s30, 8
    v_lshlrev_b32 v2, 3, v101
    v_add_u32 v2, s35, v2
    ds_write_b64 v2, v[98:99]
    s_waitcnt lgkmcnt(0)
    s_barrier
    s_add_u32 s39, s42, 0
    s_and_b32 s35, s39, 15
    s_lshl_b32 s35, s35, 7
    s_add_u32 s35, s35, s45
    s_lshl_b32 s35, s35, 10
    s_lshr_b32 s36, s39, 4
    s_lshl_b32 s36, s36, 21
    s_add_u32 s35, s35, s36
    s_cmp_ge_u32 s39, 32
    s_cbranch_scc1 k1_ev_13
    s_cmp_lt_u32 s39, 16
    s_cselect_b32 s37, 0x3eb8aa3b, 1.0
    v_mul_f32 v12, s37, v12
    v_mul_f32 v13, s37, v13
    v_mul_f32 v14, s37, v14
    v_mul_f32 v15, s37, v15
    v_mul_f32 v16, s37, v16
    v_mul_f32 v17, s37, v17
    v_mul_f32 v18, s37, v18
    v_mul_f32 v19, s37, v19
    v_cvt_pk_bf16_f32 v104, v12, v13
    v_cvt_pk_bf16_f32 v105, v14, v15
    v_cvt_pk_bf16_f32 v106, v16, v17
    v_cvt_pk_bf16_f32 v107, v18, v19
    s_add_u32 s38, s35, 0
    buffer_store_dwordx4 v[104:107], v112, s[16:19], s38 offen
    v_mul_f32 v20, s37, v20
    v_mul_f32 v21, s37, v21
    v_mul_f32 v22, s37, v22
    v_mul_f32 v23, s37, v23
    v_mul_f32 v24, s37, v24
    v_mul_f32 v25, s37, v25
    v_mul_f32 v26, s37, v26
    v_mul_f32 v27, s37, v27
    v_cvt_pk_bf16_f32 v108, v20, v21
    v_cvt_pk_bf16_f32 v109, v22, v23
    v_cvt_pk_bf16_f32 v110, v24, v25
    v_cvt_pk_bf16_f32 v111, v26, v27
    s_add_u32 s38, s35, 65536
    buffer_store_dwordx4 v[108:111], v112, s[16:19], s38 offen
    s_branch k1_ed_14
k1_ev_13:
    v_cvt_pk_bf16_f32 v104, v12, v13
    v_cvt_pk_bf16_f32 v105, v14, v15
    v_cvt_pk_bf16_f32 v106, v16, v17
    v_cvt_pk_bf16_f32 v107, v18, v19
    buffer_store_dwordx4 v[104:107], v113, s[16:19], s35 offen offset:0
    v_cvt_pk_bf16_f32 v108, v20, v21
    v_cvt_pk_bf16_f32 v109, v22, v23
    v_cvt_pk_bf16_f32 v110, v24, v25
    v_cvt_pk_bf16_f32 v111, v26, v27
    buffer_store_dwordx4 v[108:111], v113, s[16:19], s35 offen offset:512
k1_ed_14:
    s_nop 1
    s_add_u32 s39, s42, 1
    s_and_b32 s35, s39, 15
    s_lshl_b32 s35, s35, 7
    s_add_u32 s35, s35, s45
    s_lshl_b32 s35, s35, 10
    s_lshr_b32 s36, s39, 4
    s_lshl_b32 s36, s36, 21
    s_add_u32 s35, s35, s36
    s_cmp_ge_u32 s39, 32
    s_cbranch_scc1 k1_ev_15
    s_cmp_lt_u32 s39, 16
    s_cselect_b32 s37, 0x3eb8aa3b, 1.0
    v_mul_f32 v28, s37, v28
    v_mul_f32 v29, s37, v29
    v_mul_f32 v30, s37, v30
    v_mul_f32 v31, s37, v31
    v_mul_f32 v32, s37, v32
    v_mul_f32 v33, s37, v33
    v_mul_f32 v34, s37, v34
    v_mul_f32 v35, s37, v35
    v_cvt_pk_bf16_f32 v104, v28, v29
    v_cvt_pk_bf16_f32 v105, v30, v31
    v_cvt_pk_bf16_f32 v106, v32, v33
    v_cvt_pk_bf16_f32 v107, v34, v35
    s_add_u32 s38, s35, 0
    buffer_store_dwordx4 v[104:107], v112, s[16:19], s38 offen
    v_mul_f32 v36, s37, v36
    v_mul_f32 v37, s37, v37
    v_mul_f32 v38, s37, v38
    v_mul_f32 v39, s37, v39
    v_mul_f32 v40, s37, v40
    v_mul_f32 v41, s37, v41
    v_mul_f32 v42, s37, v42
    v_mul_f32 v43, s37, v43
    v_cvt_pk_bf16_f32 v108, v36, v37
    v_cvt_pk_bf16_f32 v109, v38, v39
    v_cvt_pk_bf16_f32 v110, v40, v41
    v_cvt_pk_bf16_f32 v111, v42, v43
    s_add_u32 s38, s35, 65536
    buffer_store_dwordx4 v[108:111], v112, s[16:19], s38 offen
    s_branch k1_ed_16
k1_ev_15:
    v_cvt_pk_bf16_f32 v104, v28, v29
    v_cvt_pk_bf16_f32 v105, v30, v31
    v_cvt_pk_bf16_f32 v106, v32, v33
    v_cvt_pk_bf16_f32 v107, v34, v35
    buffer_store_dwordx4 v[104:107], v113, s[16:19], s35 offen offset:0
    v_cvt_pk_bf16_f32 v108, v36, v37
    v_cvt_pk_bf16_f32 v109, v38, v39
    v_cvt_pk_bf16_f32 v110, v40, v41
    v_cvt_pk_bf16_f32 v111, v42, v43
    buffer_store_dwordx4 v[108:111], v113, s[16:19], s35 offen offset:512
k1_ed_16:
    s_nop 1
    s_branch k1_done_17
k1_w1_12:
    s_cmp_lt_u32 s42, 32
    s_cbranch_scc1 k1_1n_8
k1_1s_9:
    s_barrier
    ds_read_b128 v[44:47], v80 offset:0
    ds_read_b64_tr_b16 v[56:57], v92 offset:16384
    ds_read_b64_tr_b16 v[58:59], v92 offset:17408
    ds_read_b64_tr_b16 v[60:61], v95 offset:16384
    ds_read_b64_tr_b16 v[62:63], v95 offset:17408
    ds_read_b128 v[48:51], v83 offset:0
    ds_read_b64_tr_b16 v[64:65], v92 offset:20480
    ds_read_b64_tr_b16 v[66:67], v92 offset:21504
    ds_read_b64_tr_b16 v[68:69], v95 offset:20480
    ds_read_b64_tr_b16 v[70:71], v95 offset:21504
    ds_read_b128 v[52:55], v86 offset:0
    ds_read_b64_tr_b16 v[72:73], v92 offset:24576
    ds_read_b64_tr_b16 v[74:75], v92 offset:25600
    ds_read_b64_tr_b16 v[76:77], v95 offset:24576
    ds_read_b64_tr_b16 v[78:79], v95 offset:25600
    s_waitcnt lgkmcnt(10)
    v_mfma_f32_32x32x16_bf16 v[12:27], v[44:47], v[56:59], v[12:27]
    v_mfma_f32_32x32x16_bf16 v[28:43], v[60:63], v[44:47], v[28:43]
    v_lshlrev_b32 v104, 16, v60
    v_and_b32 v105, 0xffff0000, v60
    v_lshlrev_b32 v106, 16, v61
    v_and_b32 v107, 0xffff0000, v61
    v_lshlrev_b32 v108, 16, v62
    v_and_b32 v109, 0xffff0000, v62
    v_lshlrev_b32 v110, 16, v63
    v_and_b32 v111, 0xffff0000, v63
    v_add_f32 v118, v118, v104
    v_add_f32 v119, v119, v105
    v_add_f32 v120, v120, v106
    v_add_f32 v121, v121, v107
    v_add_f32 v118, v118, v108
    v_add_f32 v119, v119, v109
    v_add_f32 v120, v120, v110
    v_add_f32 v121, v121, v111
    ds_read_b128 v[44:47], v89 offset:0
    ds_read_b64_tr_b16 v[56:57], v92 offset:28672
    ds_read_b64_tr_b16 v[58:59], v92 offset:29696
    ds_read_b64_tr_b16 v[60:61], v95 offset:28672
    ds_read_b64_tr_b16 v[62:63], v95 offset:29696
    s_waitcnt lgkmcnt(10)
    v_mfma_f32_32x32x16_bf16 v[12:27], v[48:51], v[64:67], v[12:27]
    v_mfma_f32_32x32x16_bf16 v[28:43], v[68:71], v[48:51], v[28:43]
    v_lshlrev_b32 v104, 16, v68
    v_and_b32 v105, 0xffff0000, v68
    v_lshlrev_b32 v106, 16, v69
    v_and_b32 v107, 0xffff0000, v69
    v_lshlrev_b32 v108, 16, v70
    v_and_b32 v109, 0xffff0000, v70
    v_lshlrev_b32 v110, 16, v71
    v_and_b32 v111, 0xffff0000, v71
    v_add_f32 v118, v118, v104
    v_add_f32 v119, v119, v105
    v_add_f32 v120, v120, v106
    v_add_f32 v121, v121, v107
    v_add_f32 v118, v118, v108
    v_add_f32 v119, v119, v109
    v_add_f32 v120, v120, v110
    v_add_f32 v121, v121, v111
    s_barrier
    ds_read_b128 v[48:51], v80 offset:32768
    ds_read_b64_tr_b16 v[64:65], v92 offset:49152
    ds_read_b64_tr_b16 v[66:67], v92 offset:50176
    ds_read_b64_tr_b16 v[68:69], v95 offset:49152
    ds_read_b64_tr_b16 v[70:71], v95 offset:50176
    s_waitcnt lgkmcnt(10)
    v_mfma_f32_32x32x16_bf16 v[12:27], v[52:55], v[72:75], v[12:27]
    v_mfma_f32_32x32x16_bf16 v[28:43], v[76:79], v[52:55], v[28:43]
    v_lshlrev_b32 v104, 16, v76
    v_and_b32 v105, 0xffff0000, v76
    v_lshlrev_b32 v106, 16, v77
    v_and_b32 v107, 0xffff0000, v77
    v_lshlrev_b32 v108, 16, v78
    v_and_b32 v109, 0xffff0000, v78
    v_lshlrev_b32 v110, 16, v79
    v_and_b32 v111, 0xffff0000, v79
    v_add_f32 v118, v118, v104
    v_add_f32 v119, v119, v105
    v_add_f32 v120, v120, v106
    v_add_f32 v121, v121, v107
    v_add_f32 v118, v118, v108
    v_add_f32 v119, v119, v109
    v_add_f32 v120, v120, v110
    v_add_f32 v121, v121, v111
    ds_read_b128 v[52:55], v83 offset:32768
    ds_read_b64_tr_b16 v[72:73], v92 offset:53248
    ds_read_b64_tr_b16 v[74:75], v92 offset:54272
    ds_read_b64_tr_b16 v[76:77], v95 offset:53248
    ds_read_b64_tr_b16 v[78:79], v95 offset:54272
    s_waitcnt lgkmcnt(10)
    v_mfma_f32_32x32x16_bf16 v[12:27], v[44:47], v[56:59], v[12:27]
    v_mfma_f32_32x32x16_bf16 v[28:43], v[60:63], v[44:47], v[28:43]
    v_lshlrev_b32 v104, 16, v60
    v_and_b32 v105, 0xffff0000, v60
    v_lshlrev_b32 v106, 16, v61
    v_and_b32 v107, 0xffff0000, v61
    v_lshlrev_b32 v108, 16, v62
    v_and_b32 v109, 0xffff0000, v62
    v_lshlrev_b32 v110, 16, v63
    v_and_b32 v111, 0xffff0000, v63
    v_add_f32 v118, v118, v104
    v_add_f32 v119, v119, v105
    v_add_f32 v120, v120, v106
    v_add_f32 v121, v121, v107
    v_add_f32 v118, v118, v108
    v_add_f32 v119, v119, v109
    v_add_f32 v120, v120, v110
    v_add_f32 v121, v121, v111
    ds_read_b128 v[44:47], v86 offset:32768
    ds_read_b64_tr_b16 v[56:57], v92 offset:57344
    ds_read_b64_tr_b16 v[58:59], v92 offset:58368
    ds_read_b64_tr_b16 v[60:61], v95 offset:57344
    ds_read_b64_tr_b16 v[62:63], v95 offset:58368
    s_waitcnt lgkmcnt(10)
    v_mfma_f32_32x32x16_bf16 v[12:27], v[48:51], v[64:67], v[12:27]
    v_mfma_f32_32x32x16_bf16 v[28:43], v[68:71], v[48:51], v[28:43]
    v_lshlrev_b32 v104, 16, v68
    v_and_b32 v105, 0xffff0000, v68
    v_lshlrev_b32 v106, 16, v69
    v_and_b32 v107, 0xffff0000, v69
    v_lshlrev_b32 v108, 16, v70
    v_and_b32 v109, 0xffff0000, v70
    v_lshlrev_b32 v110, 16, v71
    v_and_b32 v111, 0xffff0000, v71
    v_add_f32 v118, v118, v104
    v_add_f32 v119, v119, v105
    v_add_f32 v120, v120, v106
    v_add_f32 v121, v121, v107
    v_add_f32 v118, v118, v108
    v_add_f32 v119, v119, v109
    v_add_f32 v120, v120, v110
    v_add_f32 v121, v121, v111
    ds_read_b128 v[48:51], v89 offset:32768
    ds_read_b64_tr_b16 v[64:65], v92 offset:61440
    ds_read_b64_tr_b16 v[66:67], v92 offset:62464
    ds_read_b64_tr_b16 v[68:69], v95 offset:61440
    ds_read_b64_tr_b16 v[70:71], v95 offset:62464
    s_waitcnt lgkmcnt(10)
    v_mfma_f32_32x32x16_bf16 v[12:27], v[52:55], v[72:75], v[12:27]
    v_mfma_f32_32x32x16_bf16 v[28:43], v[76:79], v[52:55], v[28:43]
    v_lshlrev_b32 v104, 16, v76
    v_and_b32 v105, 0xffff0000, v76
    v_lshlrev_b32 v106, 16, v77
    v_and_b32 v107, 0xffff0000, v77
    v_lshlrev_b32 v108, 16, v78
    v_and_b32 v109, 0xffff0000, v78
    v_lshlrev_b32 v110, 16, v79
    v_and_b32 v111, 0xffff0000, v79
    v_add_f32 v118, v118, v104
    v_add_f32 v119, v119, v105
    v_add_f32 v120, v120, v106
    v_add_f32 v121, v121, v107
    v_add_f32 v118, v118, v108
    v_add_f32 v119, v119, v109
    v_add_f32 v120, v120, v110
    v_add_f32 v121, v121, v111
    s_barrier
    ds_read_b128 v[52:55], v81 offset:0
    ds_read_b64_tr_b16 v[72:73], v93 offset:16384
    ds_read_b64_tr_b16 v[74:75], v93 offset:17408
    ds_read_b64_tr_b16 v[76:77], v96 offset:16384
    ds_read_b64_tr_b16 v[78:79], v96 offset:17408
    s_waitcnt lgkmcnt(10)
    v_mfma_f32_32x32x16_bf16 v[12:27], v[44:47], v[56:59], v[12:27]
    v_mfma_f32_32x32x16_bf16 v[28:43], v[60:63], v[44:47], v[28:43]
    v_lshlrev_b32 v104, 16, v60
    v_and_b32 v105, 0xffff0000, v60
    v_lshlrev_b32 v106, 16, v61
    v_and_b32 v107, 0xffff0000, v61
    v_lshlrev_b32 v108, 16, v62
    v_and_b32 v109, 0xffff0000, v62
    v_lshlrev_b32 v110, 16, v63
    v_and_b32 v111, 0xffff0000, v63
    v_add_f32 v118, v118, v104
    v_add_f32 v119, v119, v105
    v_add_f32 v120, v120, v106
    v_add_f32 v121, v121, v107
    v_add_f32 v118, v118, v108
    v_add_f32 v119, v119, v109
    v_add_f32 v120, v120, v110
    v_add_f32 v121, v121, v111
    ds_read_b128 v[44:47], v84 offset:0
    ds_read_b64_tr_b16 v[56:57], v93 offset:20480
    ds_read_b64_tr_b16 v[58:59], v93 offset:21504
    ds_read_b64_tr_b16 v[60:61], v96 offset:20480
    ds_read_b64_tr_b16 v[62:63], v96 offset:21504
    s_waitcnt lgkmcnt(10)
    v_mfma_f32_32x32x16_bf16 v[12:27], v[48:51], v[64:67], v[12:27]
    v_mfma_f32_32x32x16_bf16 v[28:43], v[68:71], v[48:51], v[28:43]
    v_lshlrev_b32 v104, 16, v68
    v_and_b32 v105, 0xffff0000, v68
    v_lshlrev_b32 v106, 16, v69
    v_and_b32 v107, 0xffff0000, v69
    v_lshlrev_b32 v108, 16, v70
    v_and_b32 v109, 0xffff0000, v70
    v_lshlrev_b32 v110, 16, v71
    v_and_b32 v111, 0xffff0000, v71
    v_add_f32 v118, v118, v104
    v_add_f32 v119, v119, v105
    v_add_f32 v120, v120, v106
    v_add_f32 v121, v121, v107
    v_add_f32 v118, v118, v108
    v_add_f32 v119, v119, v109
    v_add_f32 v120, v120, v110
    v_add_f32 v121, v121, v111
    ds_read_b128 v[48:51], v87 offset:0
    ds_read_b64_tr_b16 v[64:65], v93 offset:24576
    ds_read_b64_tr_b16 v[66:67], v93 offset:25600
    ds_read_b64_tr_b16 v[68:69], v96 offset:24576
    ds_read_b64_tr_b16 v[70:71], v96 offset:25600
    s_waitcnt lgkmcnt(10)
    v_mfma_f32_32x32x16_bf16 v[12:27], v[52:55], v[72:75], v[12:27]
    v_mfma_f32_32x32x16_bf16 v[28:43], v[76:79], v[52:55], v[28:43]
    v_lshlrev_b32 v104, 16, v76
    v_and_b32 v105, 0xffff0000, v76
    v_lshlrev_b32 v106, 16, v77
    v_and_b32 v107, 0xffff0000, v77
    v_lshlrev_b32 v108, 16, v78
    v_and_b32 v109, 0xffff0000, v78
    v_lshlrev_b32 v110, 16, v79
    v_and_b32 v111, 0xffff0000, v79
    v_add_f32 v118, v118, v104
    v_add_f32 v119, v119, v105
    v_add_f32 v120, v120, v106
    v_add_f32 v121, v121, v107
    v_add_f32 v118, v118, v108
    v_add_f32 v119, v119, v109
    v_add_f32 v120, v120, v110
    v_add_f32 v121, v121, v111
    ds_read_b128 v[52:55], v90 offset:0
    ds_read_b64_tr_b16 v[72:73], v93 offset:28672
    ds_read_b64_tr_b16 v[74:75], v93 offset:29696
    ds_read_b64_tr_b16 v[76:77], v96 offset:28672
    ds_read_b64_tr_b16 v[78:79], v96 offset:29696
    s_waitcnt lgkmcnt(10)
    v_mfma_f32_32x32x16_bf16 v[12:27], v[44:47], v[56:59], v[12:27]
    v_mfma_f32_32x32x16_bf16 v[28:43], v[60:63], v[44:47], v[28:43]
    v_lshlrev_b32 v104, 16, v60
    v_and_b32 v105, 0xffff0000, v60
    v_lshlrev_b32 v106, 16, v61
    v_and_b32 v107, 0xffff0000, v61
    v_lshlrev_b32 v108, 16, v62
    v_and_b32 v109, 0xffff0000, v62
    v_lshlrev_b32 v110, 16, v63
    v_and_b32 v111, 0xffff0000, v63
    v_add_f32 v118, v118, v104
    v_add_f32 v119, v119, v105
    v_add_f32 v120, v120, v106
    v_add_f32 v121, v121, v107
    v_add_f32 v118, v118, v108
    v_add_f32 v119, v119, v109
    v_add_f32 v120, v120, v110
    v_add_f32 v121, v121, v111
    s_barrier
    ds_read_b128 v[44:47], v81 offset:32768
    ds_read_b64_tr_b16 v[56:57], v93 offset:49152
    ds_read_b64_tr_b16 v[58:59], v93 offset:50176
    ds_read_b64_tr_b16 v[60:61], v96 offset:49152
    ds_read_b64_tr_b16 v[62:63], v96 offset:50176
    s_waitcnt lgkmcnt(10)
    v_mfma_f32_32x32x16_bf16 v[12:27], v[48:51], v[64:67], v[12:27]
    v_mfma_f32_32x32x16_bf16 v[28:43], v[68:71], v[48:51], v[28:43]
    v_lshlrev_b32 v104, 16, v68
    v_and_b32 v105, 0xffff0000, v68
    v_lshlrev_b32 v106, 16, v69
    v_and_b32 v107, 0xffff0000, v69
    v_lshlrev_b32 v108, 16, v70
    v_and_b32 v109, 0xffff0000, v70
    v_lshlrev_b32 v110, 16, v71
    v_and_b32 v111, 0xffff0000, v71
    v_add_f32 v118, v118, v104
    v_add_f32 v119, v119, v105
    v_add_f32 v120, v120, v106
    v_add_f32 v121, v121, v107
    v_add_f32 v118, v118, v108
    v_add_f32 v119, v119, v109
    v_add_f32 v120, v120, v110
    v_add_f32 v121, v121, v111
    ds_read_b128 v[48:51], v84 offset:32768
    ds_read_b64_tr_b16 v[64:65], v93 offset:53248
    ds_read_b64_tr_b16 v[66:67], v93 offset:54272
    ds_read_b64_tr_b16 v[68:69], v96 offset:53248
    ds_read_b64_tr_b16 v[70:71], v96 offset:54272
    s_waitcnt lgkmcnt(10)
    v_mfma_f32_32x32x16_bf16 v[12:27], v[52:55], v[72:75], v[12:27]
    v_mfma_f32_32x32x16_bf16 v[28:43], v[76:79], v[52:55], v[28:43]
    v_lshlrev_b32 v104, 16, v76
    v_and_b32 v105, 0xffff0000, v76
    v_lshlrev_b32 v106, 16, v77
    v_and_b32 v107, 0xffff0000, v77
    v_lshlrev_b32 v108, 16, v78
    v_and_b32 v109, 0xffff0000, v78
    v_lshlrev_b32 v110, 16, v79
    v_and_b32 v111, 0xffff0000, v79
    v_add_f32 v118, v118, v104
    v_add_f32 v119, v119, v105
    v_add_f32 v120, v120, v106
    v_add_f32 v121, v121, v107
    v_add_f32 v118, v118, v108
    v_add_f32 v119, v119, v109
    v_add_f32 v120, v120, v110
    v_add_f32 v121, v121, v111
    ds_read_b128 v[52:55], v87 offset:32768
    ds_read_b64_tr_b16 v[72:73], v93 offset:57344
    ds_read_b64_tr_b16 v[74:75], v93 offset:58368
    ds_read_b64_tr_b16 v[76:77], v96 offset:57344
    ds_read_b64_tr_b16 v[78:79], v96 offset:58368
    s_waitcnt lgkmcnt(10)
    v_mfma_f32_32x32x16_bf16 v[12:27], v[44:47], v[56:59], v[12:27]
    v_mfma_f32_32x32x16_bf16 v[28:43], v[60:63], v[44:47], v[28:43]
    v_lshlrev_b32 v104, 16, v60
    v_and_b32 v105, 0xffff0000, v60
    v_lshlrev_b32 v106, 16, v61
    v_and_b32 v107, 0xffff0000, v61
    v_lshlrev_b32 v108, 16, v62
    v_and_b32 v109, 0xffff0000, v62
    v_lshlrev_b32 v110, 16, v63
    v_and_b32 v111, 0xffff0000, v63
    v_add_f32 v118, v118, v104
    v_add_f32 v119, v119, v105
    v_add_f32 v120, v120, v106
    v_add_f32 v121, v121, v107
    v_add_f32 v118, v118, v108
    v_add_f32 v119, v119, v109
    v_add_f32 v120, v120, v110
    v_add_f32 v121, v121, v111
    ds_read_b128 v[44:47], v90 offset:32768
    ds_read_b64_tr_b16 v[56:57], v93 offset:61440
    ds_read_b64_tr_b16 v[58:59], v93 offset:62464
    ds_read_b64_tr_b16 v[60:61], v96 offset:61440
    ds_read_b64_tr_b16 v[62:63], v96 offset:62464
    s_waitcnt lgkmcnt(10)
    v_mfma_f32_32x32x16_bf16 v[12:27], v[48:51], v[64:67], v[12:27]
    v_mfma_f32_32x32x16_bf16 v[28:43], v[68:71], v[48:51], v[28:43]
    v_lshlrev_b32 v104, 16, v68
    v_and_b32 v105, 0xffff0000, v68
    v_lshlrev_b32 v106, 16, v69
    v_and_b32 v107, 0xffff0000, v69
    v_lshlrev_b32 v108, 16, v70
    v_and_b32 v109, 0xffff0000, v70
    v_lshlrev_b32 v110, 16, v71
    v_and_b32 v111, 0xffff0000, v71
    v_add_f32 v118, v118, v104
    v_add_f32 v119, v119, v105
    v_add_f32 v120, v120, v106
    v_add_f32 v121, v121, v107
    v_add_f32 v118, v118, v108
    v_add_f32 v119, v119, v109
    v_add_f32 v120, v120, v110
    v_add_f32 v121, v121, v111
    s_barrier
    ds_read_b128 v[48:51], v82 offset:0
    ds_read_b64_tr_b16 v[64:65], v94 offset:16384
    ds_read_b64_tr_b16 v[66:67], v94 offset:17408
    ds_read_b64_tr_b16 v[68:69], v97 offset:16384
    ds_read_b64_tr_b16 v[70:71], v97 offset:17408
    s_waitcnt lgkmcnt(10)
    v_mfma_f32_32x32x16_bf16 v[12:27], v[52:55], v[72:75], v[12:27]
    v_mfma_f32_32x32x16_bf16 v[28:43], v[76:79], v[52:55], v[28:43]
    v_lshlrev_b32 v104, 16, v76
    v_and_b32 v105, 0xffff0000, v76
    v_lshlrev_b32 v106, 16, v77
    v_and_b32 v107, 0xffff0000, v77
    v_lshlrev_b32 v108, 16, v78
    v_and_b32 v109, 0xffff0000, v78
    v_lshlrev_b32 v110, 16, v79
    v_and_b32 v111, 0xffff0000, v79
    v_add_f32 v118, v118, v104
    v_add_f32 v119, v119, v105
    v_add_f32 v120, v120, v106
    v_add_f32 v121, v121, v107
    v_add_f32 v118, v118, v108
    v_add_f32 v119, v119, v109
    v_add_f32 v120, v120, v110
    v_add_f32 v121, v121, v111
    ds_read_b128 v[52:55], v85 offset:0
    ds_read_b64_tr_b16 v[72:73], v94 offset:20480
    ds_read_b64_tr_b16 v[74:75], v94 offset:21504
    ds_read_b64_tr_b16 v[76:77], v97 offset:20480
    ds_read_b64_tr_b16 v[78:79], v97 offset:21504
    s_waitcnt lgkmcnt(10)
    v_mfma_f32_32x32x16_bf16 v[12:27], v[44:47], v[56:59], v[12:27]
    v_mfma_f32_32x32x16_bf16 v[28:43], v[60:63], v[44:47], v[28:43]
    v_lshlrev_b32 v104, 16, v60
    v_and_b32 v105, 0xffff0000, v60
    v_lshlrev_b32 v106, 16, v61
    v_and_b32 v107, 0xffff0000, v61
    v_lshlrev_b32 v108, 16, v62
    v_and_b32 v109, 0xffff0000, v62
    v_lshlrev_b32 v110, 16, v63
    v_and_b32 v111, 0xffff0000, v63
    v_add_f32 v118, v118, v104
    v_add_f32 v119, v119, v105
    v_add_f32 v120, v120, v106
    v_add_f32 v121, v121, v107
    v_add_f32 v118, v118, v108
    v_add_f32 v119, v119, v109
    v_add_f32 v120, v120, v110
    v_add_f32 v121, v121, v111
    ds_read_b128 v[44:47], v88 offset:0
    ds_read_b64_tr_b16 v[56:57], v94 offset:24576
    ds_read_b64_tr_b16 v[58:59], v94 offset:25600
    ds_read_b64_tr_b16 v[60:61], v97 offset:24576
    ds_read_b64_tr_b16 v[62:63], v97 offset:25600
    s_waitcnt lgkmcnt(10)
    v_mfma_f32_32x32x16_bf16 v[12:27], v[48:51], v[64:67], v[12:27]
    v_mfma_f32_32x32x16_bf16 v[28:43], v[68:71], v[48:51], v[28:43]
    v_lshlrev_b32 v104, 16, v68
    v_and_b32 v105, 0xffff0000, v68
    v_lshlrev_b32 v106, 16, v69
    v_and_b32 v107, 0xffff0000, v69
    v_lshlrev_b32 v108, 16, v70
    v_and_b32 v109, 0xffff0000, v70
    v_lshlrev_b32 v110, 16, v71
    v_and_b32 v111, 0xffff0000, v71
    v_add_f32 v118, v118, v104
    v_add_f32 v119, v119, v105
    v_add_f32 v120, v120, v106
    v_add_f32 v121, v121, v107
    v_add_f32 v118, v118, v108
    v_add_f32 v119, v119, v109
    v_add_f32 v120, v120, v110
    v_add_f32 v121, v121, v111
    ds_read_b128 v[48:51], v91 offset:0
    ds_read_b64_tr_b16 v[64:65], v94 offset:28672
    ds_read_b64_tr_b16 v[66:67], v94 offset:29696
    ds_read_b64_tr_b16 v[68:69], v97 offset:28672
    ds_read_b64_tr_b16 v[70:71], v97 offset:29696
    s_waitcnt lgkmcnt(10)
    v_mfma_f32_32x32x16_bf16 v[12:27], v[52:55], v[72:75], v[12:27]
    v_mfma_f32_32x32x16_bf16 v[28:43], v[76:79], v[52:55], v[28:43]
    v_lshlrev_b32 v104, 16, v76
    v_and_b32 v105, 0xffff0000, v76
    v_lshlrev_b32 v106, 16, v77
    v_and_b32 v107, 0xffff0000, v77
    v_lshlrev_b32 v108, 16, v78
    v_and_b32 v109, 0xffff0000, v78
    v_lshlrev_b32 v110, 16, v79
    v_and_b32 v111, 0xffff0000, v79
    v_add_f32 v118, v118, v104
    v_add_f32 v119, v119, v105
    v_add_f32 v120, v120, v106
    v_add_f32 v121, v121, v107
    v_add_f32 v118, v118, v108
    v_add_f32 v119, v119, v109
    v_add_f32 v120, v120, v110
    v_add_f32 v121, v121, v111
    s_barrier
    ds_read_b128 v[52:55], v80 offset:0
    ds_read_b64_tr_b16 v[72:73], v92 offset:16384
    ds_read_b64_tr_b16 v[74:75], v92 offset:17408
    ds_read_b64_tr_b16 v[76:77], v95 offset:16384
    ds_read_b64_tr_b16 v[78:79], v95 offset:17408
    s_waitcnt lgkmcnt(10)
    v_mfma_f32_32x32x16_bf16 v[12:27], v[44:47], v[56:59], v[12:27]
    v_mfma_f32_32x32x16_bf16 v[28:43], v[60:63], v[44:47], v[28:43]
    v_lshlrev_b32 v104, 16, v60
    v_and_b32 v105, 0xffff0000, v60
    v_lshlrev_b32 v106, 16, v61
    v_and_b32 v107, 0xffff0000, v61
    v_lshlrev_b32 v108, 16, v62
    v_and_b32 v109, 0xffff0000, v62
    v_lshlrev_b32 v110, 16, v63
    v_and_b32 v111, 0xffff0000, v63
    v_add_f32 v118, v118, v104
    v_add_f32 v119, v119, v105
    v_add_f32 v120, v120, v106
    v_add_f32 v121, v121, v107
    v_add_f32 v118, v118, v108
    v_add_f32 v119, v119, v109
    v_add_f32 v120, v120, v110
    v_add_f32 v121, v121, v111
    ds_read_b128 v[44:47], v83 offset:0
    ds_read_b64_tr_b16 v[56:57], v92 offset:20480
    ds_read_b64_tr_b16 v[58:59], v92 offset:21504
    ds_read_b64_tr_b16 v[60:61], v95 offset:20480
    ds_read_b64_tr_b16 v[62:63], v95 offset:21504
    s_waitcnt lgkmcnt(10)
    v_mfma_f32_32x32x16_bf16 v[12:27], v[48:51], v[64:67], v[12:27]
    v_mfma_f32_32x32x16_bf16 v[28:43], v[68:71], v[48:51], v[28:43]
    v_lshlrev_b32 v104, 16, v68
    v_and_b32 v105, 0xffff0000, v68
    v_lshlrev_b32 v106, 16, v69
    v_and_b32 v107, 0xffff0000, v69
    v_lshlrev_b32 v108, 16, v70
    v_and_b32 v109, 0xffff0000, v70
    v_lshlrev_b32 v110, 16, v71
    v_and_b32 v111, 0xffff0000, v71
    v_add_f32 v118, v118, v104
    v_add_f32 v119, v119, v105
    v_add_f32 v120, v120, v106
    v_add_f32 v121, v121, v107
    v_add_f32 v118, v118, v108
    v_add_f32 v119, v119, v109
    v_add_f32 v120, v120, v110
    v_add_f32 v121, v121, v111
    ds_read_b128 v[48:51], v86 offset:0
    ds_read_b64_tr_b16 v[64:65], v92 offset:24576
    ds_read_b64_tr_b16 v[66:67], v92 offset:25600
    ds_read_b64_tr_b16 v[68:69], v95 offset:24576
    ds_read_b64_tr_b16 v[70:71], v95 offset:25600
    s_waitcnt lgkmcnt(10)
    v_mfma_f32_32x32x16_bf16 v[12:27], v[52:55], v[72:75], v[12:27]
    v_mfma_f32_32x32x16_bf16 v[28:43], v[76:79], v[52:55], v[28:43]
    v_lshlrev_b32 v104, 16, v76
    v_and_b32 v105, 0xffff0000, v76
    v_lshlrev_b32 v106, 16, v77
    v_and_b32 v107, 0xffff0000, v77
    v_lshlrev_b32 v108, 16, v78
    v_and_b32 v109, 0xffff0000, v78
    v_lshlrev_b32 v110, 16, v79
    v_and_b32 v111, 0xffff0000, v79
    v_add_f32 v118, v118, v104
    v_add_f32 v119, v119, v105
    v_add_f32 v120, v120, v106
    v_add_f32 v121, v121, v107
    v_add_f32 v118, v118, v108
    v_add_f32 v119, v119, v109
    v_add_f32 v120, v120, v110
    v_add_f32 v121, v121, v111
    ds_read_b128 v[52:55], v89 offset:0
    ds_read_b64_tr_b16 v[72:73], v92 offset:28672
    ds_read_b64_tr_b16 v[74:75], v92 offset:29696
    ds_read_b64_tr_b16 v[76:77], v95 offset:28672
    ds_read_b64_tr_b16 v[78:79], v95 offset:29696
    s_waitcnt lgkmcnt(10)
    v_mfma_f32_32x32x16_bf16 v[12:27], v[44:47], v[56:59], v[12:27]
    v_mfma_f32_32x32x16_bf16 v[28:43], v[60:63], v[44:47], v[28:43]
    v_lshlrev_b32 v104, 16, v60
    v_and_b32 v105, 0xffff0000, v60
    v_lshlrev_b32 v106, 16, v61
    v_and_b32 v107, 0xffff0000, v61
    v_lshlrev_b32 v108, 16, v62
    v_and_b32 v109, 0xffff0000, v62
    v_lshlrev_b32 v110, 16, v63
    v_and_b32 v111, 0xffff0000, v63
    v_add_f32 v118, v118, v104
    v_add_f32 v119, v119, v105
    v_add_f32 v120, v120, v106
    v_add_f32 v121, v121, v107
    v_add_f32 v118, v118, v108
    v_add_f32 v119, v119, v109
    v_add_f32 v120, v120, v110
    v_add_f32 v121, v121, v111
    s_barrier
    ds_read_b128 v[44:47], v80 offset:32768
    ds_read_b64_tr_b16 v[56:57], v92 offset:49152
    ds_read_b64_tr_b16 v[58:59], v92 offset:50176
    ds_read_b64_tr_b16 v[60:61], v95 offset:49152
    ds_read_b64_tr_b16 v[62:63], v95 offset:50176
    s_waitcnt lgkmcnt(10)
    v_mfma_f32_32x32x16_bf16 v[12:27], v[48:51], v[64:67], v[12:27]
    v_mfma_f32_32x32x16_bf16 v[28:43], v[68:71], v[48:51], v[28:43]
    v_lshlrev_b32 v104, 16, v68
    v_and_b32 v105, 0xffff0000, v68
    v_lshlrev_b32 v106, 16, v69
    v_and_b32 v107, 0xffff0000, v69
    v_lshlrev_b32 v108, 16, v70
    v_and_b32 v109, 0xffff0000, v70
    v_lshlrev_b32 v110, 16, v71
    v_and_b32 v111, 0xffff0000, v71
    v_add_f32 v118, v118, v104
    v_add_f32 v119, v119, v105
    v_add_f32 v120, v120, v106
    v_add_f32 v121, v121, v107
    v_add_f32 v118, v118, v108
    v_add_f32 v119, v119, v109
    v_add_f32 v120, v120, v110
    v_add_f32 v121, v121, v111
    ds_read_b128 v[48:51], v83 offset:32768
    ds_read_b64_tr_b16 v[64:65], v92 offset:53248
    ds_read_b64_tr_b16 v[66:67], v92 offset:54272
    ds_read_b64_tr_b16 v[68:69], v95 offset:53248
    ds_read_b64_tr_b16 v[70:71], v95 offset:54272
    s_waitcnt lgkmcnt(10)
    v_mfma_f32_32x32x16_bf16 v[12:27], v[52:55], v[72:75], v[12:27]
    v_mfma_f32_32x32x16_bf16 v[28:43], v[76:79], v[52:55], v[28:43]
    v_lshlrev_b32 v104, 16, v76
    v_and_b32 v105, 0xffff0000, v76
    v_lshlrev_b32 v106, 16, v77
    v_and_b32 v107, 0xffff0000, v77
    v_lshlrev_b32 v108, 16, v78
    v_and_b32 v109, 0xffff0000, v78
    v_lshlrev_b32 v110, 16, v79
    v_and_b32 v111, 0xffff0000, v79
    v_add_f32 v118, v118, v104
    v_add_f32 v119, v119, v105
    v_add_f32 v120, v120, v106
    v_add_f32 v121, v121, v107
    v_add_f32 v118, v118, v108
    v_add_f32 v119, v119, v109
    v_add_f32 v120, v120, v110
    v_add_f32 v121, v121, v111
    ds_read_b128 v[52:55], v86 offset:32768
    ds_read_b64_tr_b16 v[72:73], v92 offset:57344
    ds_read_b64_tr_b16 v[74:75], v92 offset:58368
    ds_read_b64_tr_b16 v[76:77], v95 offset:57344
    ds_read_b64_tr_b16 v[78:79], v95 offset:58368
    s_waitcnt lgkmcnt(10)
    v_mfma_f32_32x32x16_bf16 v[12:27], v[44:47], v[56:59], v[12:27]
    v_mfma_f32_32x32x16_bf16 v[28:43], v[60:63], v[44:47], v[28:43]
    v_lshlrev_b32 v104, 16, v60
    v_and_b32 v105, 0xffff0000, v60
    v_lshlrev_b32 v106, 16, v61
    v_and_b32 v107, 0xffff0000, v61
    v_lshlrev_b32 v108, 16, v62
    v_and_b32 v109, 0xffff0000, v62
    v_lshlrev_b32 v110, 16, v63
    v_and_b32 v111, 0xffff0000, v63
    v_add_f32 v118, v118, v104
    v_add_f32 v119, v119, v105
    v_add_f32 v120, v120, v106
    v_add_f32 v121, v121, v107
    v_add_f32 v118, v118, v108
    v_add_f32 v119, v119, v109
    v_add_f32 v120, v120, v110
    v_add_f32 v121, v121, v111
    ds_read_b128 v[44:47], v89 offset:32768
    ds_read_b64_tr_b16 v[56:57], v92 offset:61440
    ds_read_b64_tr_b16 v[58:59], v92 offset:62464
    ds_read_b64_tr_b16 v[60:61], v95 offset:61440
    ds_read_b64_tr_b16 v[62:63], v95 offset:62464
    s_waitcnt lgkmcnt(10)
    v_mfma_f32_32x32x16_bf16 v[12:27], v[48:51], v[64:67], v[12:27]
    v_mfma_f32_32x32x16_bf16 v[28:43], v[68:71], v[48:51], v[28:43]
    v_lshlrev_b32 v104, 16, v68
    v_and_b32 v105, 0xffff0000, v68
    v_lshlrev_b32 v106, 16, v69
    v_and_b32 v107, 0xffff0000, v69
    v_lshlrev_b32 v108, 16, v70
    v_and_b32 v109, 0xffff0000, v70
    v_lshlrev_b32 v110, 16, v71
    v_and_b32 v111, 0xffff0000, v71
    v_add_f32 v118, v118, v104
    v_add_f32 v119, v119, v105
    v_add_f32 v120, v120, v106
    v_add_f32 v121, v121, v107
    v_add_f32 v118, v118, v108
    v_add_f32 v119, v119, v109
    v_add_f32 v120, v120, v110
    v_add_f32 v121, v121, v111
    s_barrier
    ds_read_b128 v[48:51], v81 offset:0
    ds_read_b64_tr_b16 v[64:65], v93 offset:16384
    ds_read_b64_tr_b16 v[66:67], v93 offset:17408
    ds_read_b64_tr_b16 v[68:69], v96 offset:16384
    ds_read_b64_tr_b16 v[70:71], v96 offset:17408
    s_waitcnt lgkmcnt(10)
    v_mfma_f32_32x32x16_bf16 v[12:27], v[52:55], v[72:75], v[12:27]
    v_mfma_f32_32x32x16_bf16 v[28:43], v[76:79], v[52:55], v[28:43]
    v_lshlrev_b32 v104, 16, v76
    v_and_b32 v105, 0xffff0000, v76
    v_lshlrev_b32 v106, 16, v77
    v_and_b32 v107, 0xffff0000, v77
    v_lshlrev_b32 v108, 16, v78
    v_and_b32 v109, 0xffff0000, v78
    v_lshlrev_b32 v110, 16, v79
    v_and_b32 v111, 0xffff0000, v79
    v_add_f32 v118, v118, v104
    v_add_f32 v119, v119, v105
    v_add_f32 v120, v120, v106
    v_add_f32 v121, v121, v107
    v_add_f32 v118, v118, v108
    v_add_f32 v119, v119, v109
    v_add_f32 v120, v120, v110
    v_add_f32 v121, v121, v111
    ds_read_b128 v[52:55], v84 offset:0
    ds_read_b64_tr_b16 v[72:73], v93 offset:20480
    ds_read_b64_tr_b16 v[74:75], v93 offset:21504
    ds_read_b64_tr_b16 v[76:77], v96 offset:20480
    ds_read_b64_tr_b16 v[78:79], v96 offset:21504
    s_waitcnt lgkmcnt(10)
    v_mfma_f32_32x32x16_bf16 v[12:27], v[44:47], v[56:59], v[12:27]
    v_mfma_f32_32x32x16_bf16 v[28:43], v[60:63], v[44:47], v[28:43]
    v_lshlrev_b32 v104, 16, v60
    v_and_b32 v105, 0xffff0000, v60
    v_lshlrev_b32 v106, 16, v61
    v_and_b32 v107, 0xffff0000, v61
    v_lshlrev_b32 v108, 16, v62
    v_and_b32 v109, 0xffff0000, v62
    v_lshlrev_b32 v110, 16, v63
    v_and_b32 v111, 0xffff0000, v63
    v_add_f32 v118, v118, v104
    v_add_f32 v119, v119, v105
    v_add_f32 v120, v120, v106
    v_add_f32 v121, v121, v107
    v_add_f32 v118, v118, v108
    v_add_f32 v119, v119, v109
    v_add_f32 v120, v120, v110
    v_add_f32 v121, v121, v111
    ds_read_b128 v[44:47], v87 offset:0
    ds_read_b64_tr_b16 v[56:57], v93 offset:24576
    ds_read_b64_tr_b16 v[58:59], v93 offset:25600
    ds_read_b64_tr_b16 v[60:61], v96 offset:24576
    ds_read_b64_tr_b16 v[62:63], v96 offset:25600
    s_waitcnt lgkmcnt(10)
    v_mfma_f32_32x32x16_bf16 v[12:27], v[48:51], v[64:67], v[12:27]
    v_mfma_f32_32x32x16_bf16 v[28:43], v[68:71], v[48:51], v[28:43]
    v_lshlrev_b32 v104, 16, v68
    v_and_b32 v105, 0xffff0000, v68
    v_lshlrev_b32 v106, 16, v69
    v_and_b32 v107, 0xffff0000, v69
    v_lshlrev_b32 v108, 16, v70
    v_and_b32 v109, 0xffff0000, v70
    v_lshlrev_b32 v110, 16, v71
    v_and_b32 v111, 0xffff0000, v71
    v_add_f32 v118, v118, v104
    v_add_f32 v119, v119, v105
    v_add_f32 v120, v120, v106
    v_add_f32 v121, v121, v107
    v_add_f32 v118, v118, v108
    v_add_f32 v119, v119, v109
    v_add_f32 v120, v120, v110
    v_add_f32 v121, v121, v111
    ds_read_b128 v[48:51], v90 offset:0
    ds_read_b64_tr_b16 v[64:65], v93 offset:28672
    ds_read_b64_tr_b16 v[66:67], v93 offset:29696
    ds_read_b64_tr_b16 v[68:69], v96 offset:28672
    ds_read_b64_tr_b16 v[70:71], v96 offset:29696
    s_waitcnt lgkmcnt(10)
    v_mfma_f32_32x32x16_bf16 v[12:27], v[52:55], v[72:75], v[12:27]
    v_mfma_f32_32x32x16_bf16 v[28:43], v[76:79], v[52:55], v[28:43]
    v_lshlrev_b32 v104, 16, v76
    v_and_b32 v105, 0xffff0000, v76
    v_lshlrev_b32 v106, 16, v77
    v_and_b32 v107, 0xffff0000, v77
    v_lshlrev_b32 v108, 16, v78
    v_and_b32 v109, 0xffff0000, v78
    v_lshlrev_b32 v110, 16, v79
    v_and_b32 v111, 0xffff0000, v79
    v_add_f32 v118, v118, v104
    v_add_f32 v119, v119, v105
    v_add_f32 v120, v120, v106
    v_add_f32 v121, v121, v107
    v_add_f32 v118, v118, v108
    v_add_f32 v119, v119, v109
    v_add_f32 v120, v120, v110
    v_add_f32 v121, v121, v111
    s_waitcnt lgkmcnt(5)
    v_mfma_f32_32x32x16_bf16 v[12:27], v[44:47], v[56:59], v[12:27]
    v_mfma_f32_32x32x16_bf16 v[28:43], v[60:63], v[44:47], v[28:43]
    v_lshlrev_b32 v104, 16, v60
    v_and_b32 v105, 0xffff0000, v60
    v_lshlrev_b32 v106, 16, v61
    v_and_b32 v107, 0xffff0000, v61
    v_lshlrev_b32 v108, 16, v62
    v_and_b32 v109, 0xffff0000, v62
    v_lshlrev_b32 v110, 16, v63
    v_and_b32 v111, 0xffff0000, v63
    v_add_f32 v118, v118, v104
    v_add_f32 v119, v119, v105
    v_add_f32 v120, v120, v106
    v_add_f32 v121, v121, v107
    v_add_f32 v118, v118, v108
    v_add_f32 v119, v119, v109
    v_add_f32 v120, v120, v110
    v_add_f32 v121, v121, v111
    s_waitcnt lgkmcnt(0)
    v_mfma_f32_32x32x16_bf16 v[12:27], v[48:51], v[64:67], v[12:27]
    v_mfma_f32_32x32x16_bf16 v[28:43], v[68:71], v[48:51], v[28:43]
    v_lshlrev_b32 v104, 16, v68
    v_and_b32 v105, 0xffff0000, v68
    v_lshlrev_b32 v106, 16, v69
    v_and_b32 v107, 0xffff0000, v69
    v_lshlrev_b32 v108, 16, v70
    v_and_b32 v109, 0xffff0000, v70
    v_lshlrev_b32 v110, 16, v71
    v_and_b32 v111, 0xffff0000, v71
    v_add_f32 v118, v118, v104
    v_add_f32 v119, v119, v105
    v_add_f32 v120, v120, v106
    v_add_f32 v121, v121, v107
    v_add_f32 v118, v118, v108
    v_add_f32 v119, v119, v109
    v_add_f32 v120, v120, v110
    v_add_f32 v121, v121, v111
    s_branch k1_e1_11
k1_1n_8:
    s_barrier
    ds_read_b128 v[44:47], v80 offset:0
    ds_read_b64_tr_b16 v[56:57], v92 offset:16384
    ds_read_b64_tr_b16 v[58:59], v92 offset:17408
    ds_read_b64_tr_b16 v[60:61], v95 offset:16384
    ds_read_b64_tr_b16 v[62:63], v95 offset:17408
    ds_read_b128 v[48:51], v83 offset:0
    ds_read_b64_tr_b16 v[64:65], v92 offset:20480
    ds_read_b64_tr_b16 v[66:67], v92 offset:21504
    ds_read_b64_tr_b16 v[68:69], v95 offset:20480
    ds_read_b64_tr_b16 v[70:71], v95 offset:21504
    ds_read_b128 v[52:55], v86 offset:0
    ds_read_b64_tr_b16 v[72:73], v92 offset:24576
    ds_read_b64_tr_b16 v[74:75], v92 offset:25600
    ds_read_b64_tr_b16 v[76:77], v95 offset:24576
    ds_read_b64_tr_b16 v[78:79], v95 offset:25600
    s_waitcnt lgkmcnt(10)
    v_mfma_f32_32x32x16_bf16 v[12:27], v[56:59], v[44:47], v[12:27]
    v_mfma_f32_32x32x16_bf16 v[28:43], v[60:63], v[44:47], v[28:43]
    v_lshlrev_b32 v104, 16, v60
    v_and_b32 v105, 0xffff0000, v60
    v_lshlrev_b32 v106, 16, v61
    v_and_b32 v107, 0xffff0000, v61
    v_lshlrev_b32 v108, 16, v62
    v_and_b32 v109, 0xffff0000, v62
    v_lshlrev_b32 v110, 16, v63
    v_and_b32 v111, 0xffff0000, v63
    v_add_f32 v118, v118, v104
    v_add_f32 v119, v119, v105
    v_add_f32 v120, v120, v106
    v_add_f32 v121, v121, v107
    v_add_f32 v118, v118, v108
    v_add_f32 v119, v119, v109
    v_add_f32 v120, v120, v110
    v_add_f32 v121, v121, v111
    ds_read_b128 v[44:47], v89 offset:0
    ds_read_b64_tr_b16 v[56:57], v92 offset:28672
    ds_read_b64_tr_b16 v[58:59], v92 offset:29696
    ds_read_b64_tr_b16 v[60:61], v95 offset:28672
    ds_read_b64_tr_b16 v[62:63], v95 offset:29696
    s_waitcnt lgkmcnt(10)
    v_mfma_f32_32x32x16_bf16 v[12:27], v[64:67], v[48:51], v[12:27]
    v_mfma_f32_32x32x16_bf16 v[28:43], v[68:71], v[48:51], v[28:43]
    v_lshlrev_b32 v104, 16, v68
    v_and_b32 v105, 0xffff0000, v68
    v_lshlrev_b32 v106, 16, v69
    v_and_b32 v107, 0xffff0000, v69
    v_lshlrev_b32 v108, 16, v70
    v_and_b32 v109, 0xffff0000, v70
    v_lshlrev_b32 v110, 16, v71
    v_and_b32 v111, 0xffff0000, v71
    v_add_f32 v118, v118, v104
    v_add_f32 v119, v119, v105
    v_add_f32 v120, v120, v106
    v_add_f32 v121, v121, v107
    v_add_f32 v118, v118, v108
    v_add_f32 v119, v119, v109
    v_add_f32 v120, v120, v110
    v_add_f32 v121, v121, v111
    s_barrier
    ds_read_b128 v[48:51], v80 offset:32768
    ds_read_b64_tr_b16 v[64:65], v92 offset:49152
    ds_read_b64_tr_b16 v[66:67], v92 offset:50176
    ds_read_b64_tr_b16 v[68:69], v95 offset:49152
    ds_read_b64_tr_b16 v[70:71], v95 offset:50176
    s_waitcnt lgkmcnt(10)
    v_mfma_f32_32x32x16_bf16 v[12:27], v[72:75], v[52:55], v[12:27]
    v_mfma_f32_32x32x16_bf16 v[28:43], v[76:79], v[52:55], v[28:43]
    v_lshlrev_b32 v104, 16, v76
    v_and_b32 v105, 0xffff0000, v76
    v_lshlrev_b32 v106, 16, v77
    v_and_b32 v107, 0xffff0000, v77
    v_lshlrev_b32 v108, 16, v78
    v_and_b32 v109, 0xffff0000, v78
    v_lshlrev_b32 v110, 16, v79
    v_and_b32 v111, 0xffff0000, v79
    v_add_f32 v118, v118, v104
    v_add_f32 v119, v119, v105
    v_add_f32 v120, v120, v106
    v_add_f32 v121, v121, v107
    v_add_f32 v118, v118, v108
    v_add_f32 v119, v119, v109
    v_add_f32 v120, v120, v110
    v_add_f32 v121, v121, v111
    ds_read_b128 v[52:55], v83 offset:32768
    ds_read_b64_tr_b16 v[72:73], v92 offset:53248
    ds_read_b64_tr_b16 v[74:75], v92 offset:54272
    ds_read_b64_tr_b16 v[76:77], v95 offset:53248
    ds_read_b64_tr_b16 v[78:79], v95 offset:54272
    s_waitcnt lgkmcnt(10)
    v_mfma_f32_32x32x16_bf16 v[12:27], v[56:59], v[44:47], v[12:27]
    v_mfma_f32_32x32x16_bf16 v[28:43], v[60:63], v[44:47], v[28:43]
    v_lshlrev_b32 v104, 16, v60
    v_and_b32 v105, 0xffff0000, v60
    v_lshlrev_b32 v106, 16, v61
    v_and_b32 v107, 0xffff0000, v61
    v_lshlrev_b32 v108, 16, v62
    v_and_b32 v109, 0xffff0000, v62
    v_lshlrev_b32 v110, 16, v63
    v_and_b32 v111, 0xffff0000, v63
    v_add_f32 v118, v118, v104
    v_add_f32 v119, v119, v105
    v_add_f32 v120, v120, v106
    v_add_f32 v121, v121, v107
    v_add_f32 v118, v118, v108
    v_add_f32 v119, v119, v109
    v_add_f32 v120, v120, v110
    v_add_f32 v121, v121, v111
    ds_read_b128 v[44:47], v86 offset:32768
    ds_read_b64_tr_b16 v[56:57], v92 offset:57344
    ds_read_b64_tr_b16 v[58:59], v92 offset:58368
    ds_read_b64_tr_b16 v[60:61], v95 offset:57344
    ds_read_b64_tr_b16 v[62:63], v95 offset:58368
    s_waitcnt lgkmcnt(10)
    v_mfma_f32_32x32x16_bf16 v[12:27], v[64:67], v[48:51], v[12:27]
    v_mfma_f32_32x32x16_bf16 v[28:43], v[68:71], v[48:51], v[28:43]
    v_lshlrev_b32 v104, 16, v68
    v_and_b32 v105, 0xffff0000, v68
    v_lshlrev_b32 v106, 16, v69
    v_and_b32 v107, 0xffff0000, v69
    v_lshlrev_b32 v108, 16, v70
    v_and_b32 v109, 0xffff0000, v70
    v_lshlrev_b32 v110, 16, v71
    v_and_b32 v111, 0xffff0000, v71
    v_add_f32 v118, v118, v104
    v_add_f32 v119, v119, v105
    v_add_f32 v120, v120, v106
    v_add_f32 v121, v121, v107
    v_add_f32 v118, v118, v108
    v_add_f32 v119, v119, v109
    v_add_f32 v120, v120, v110
    v_add_f32 v121, v121, v111
    ds_read_b128 v[48:51], v89 offset:32768
    ds_read_b64_tr_b16 v[64:65], v92 offset:61440
    ds_read_b64_tr_b16 v[66:67], v92 offset:62464
    ds_read_b64_tr_b16 v[68:69], v95 offset:61440
    ds_read_b64_tr_b16 v[70:71], v95 offset:62464
    s_waitcnt lgkmcnt(10)
    v_mfma_f32_32x32x16_bf16 v[12:27], v[72:75], v[52:55], v[12:27]
    v_mfma_f32_32x32x16_bf16 v[28:43], v[76:79], v[52:55], v[28:43]
    v_lshlrev_b32 v104, 16, v76
    v_and_b32 v105, 0xffff0000, v76
    v_lshlrev_b32 v106, 16, v77
    v_and_b32 v107, 0xffff0000, v77
    v_lshlrev_b32 v108, 16, v78
    v_and_b32 v109, 0xffff0000, v78
    v_lshlrev_b32 v110, 16, v79
    v_and_b32 v111, 0xffff0000, v79
    v_add_f32 v118, v118, v104
    v_add_f32 v119, v119, v105
    v_add_f32 v120, v120, v106
    v_add_f32 v121, v121, v107
    v_add_f32 v118, v118, v108
    v_add_f32 v119, v119, v109
    v_add_f32 v120, v120, v110
    v_add_f32 v121, v121, v111
    s_barrier
    ds_read_b128 v[52:55], v81 offset:0
    ds_read_b64_tr_b16 v[72:73], v93 offset:16384
    ds_read_b64_tr_b16 v[74:75], v93 offset:17408
    ds_read_b64_tr_b16 v[76:77], v96 offset:16384
    ds_read_b64_tr_b16 v[78:79], v96 offset:17408
    s_waitcnt lgkmcnt(10)
    v_mfma_f32_32x32x16_bf16 v[12:27], v[56:59], v[44:47], v[12:27]
    v_mfma_f32_32x32x16_bf16 v[28:43], v[60:63], v[44:47], v[28:43]
    v_lshlrev_b32 v104, 16, v60
    v_and_b32 v105, 0xffff0000, v60
    v_lshlrev_b32 v106, 16, v61
    v_and_b32 v107, 0xffff0000, v61
    v_lshlrev_b32 v108, 16, v62
    v_and_b32 v109, 0xffff0000, v62
    v_lshlrev_b32 v110, 16, v63
    v_and_b32 v111, 0xffff0000, v63
    v_add_f32 v118, v118, v104
    v_add_f32 v119, v119, v105
    v_add_f32 v120, v120, v106
    v_add_f32 v121, v121, v107
    v_add_f32 v118, v118, v108
    v_add_f32 v119, v119, v109
    v_add_f32 v120, v120, v110
    v_add_f32 v121, v121, v111
    ds_read_b128 v[44:47], v84 offset:0
    ds_read_b64_tr_b16 v[56:57], v93 offset:20480
    ds_read_b64_tr_b16 v[58:59], v93 offset:21504
    ds_read_b64_tr_b16 v[60:61], v96 offset:20480
    ds_read_b64_tr_b16 v[62:63], v96 offset:21504
    s_waitcnt lgkmcnt(10)
    v_mfma_f32_32x32x16_bf16 v[12:27], v[64:67], v[48:51], v[12:27]
    v_mfma_f32_32x32x16_bf16 v[28:43], v[68:71], v[48:51], v[28:43]
    v_lshlrev_b32 v104, 16, v68
    v_and_b32 v105, 0xffff0000, v68
    v_lshlrev_b32 v106, 16, v69
    v_and_b32 v107, 0xffff0000, v69
    v_lshlrev_b32 v108, 16, v70
    v_and_b32 v109, 0xffff0000, v70
    v_lshlrev_b32 v110, 16, v71
    v_and_b32 v111, 0xffff0000, v71
    v_add_f32 v118, v118, v104
    v_add_f32 v119, v119, v105
    v_add_f32 v120, v120, v106
    v_add_f32 v121, v121, v107
    v_add_f32 v118, v118, v108
    v_add_f32 v119, v119, v109
    v_add_f32 v120, v120, v110
    v_add_f32 v121, v121, v111
    ds_read_b128 v[48:51], v87 offset:0
    ds_read_b64_tr_b16 v[64:65], v93 offset:24576
    ds_read_b64_tr_b16 v[66:67], v93 offset:25600
    ds_read_b64_tr_b16 v[68:69], v96 offset:24576
    ds_read_b64_tr_b16 v[70:71], v96 offset:25600
    s_waitcnt lgkmcnt(10)
    v_mfma_f32_32x32x16_bf16 v[12:27], v[72:75], v[52:55], v[12:27]
    v_mfma_f32_32x32x16_bf16 v[28:43], v[76:79], v[52:55], v[28:43]
    v_lshlrev_b32 v104, 16, v76
    v_and_b32 v105, 0xffff0000, v76
    v_lshlrev_b32 v106, 16, v77
    v_and_b32 v107, 0xffff0000, v77
    v_lshlrev_b32 v108, 16, v78
    v_and_b32 v109, 0xffff0000, v78
    v_lshlrev_b32 v110, 16, v79
    v_and_b32 v111, 0xffff0000, v79
    v_add_f32 v118, v118, v104
    v_add_f32 v119, v119, v105
    v_add_f32 v120, v120, v106
    v_add_f32 v121, v121, v107
    v_add_f32 v118, v118, v108
    v_add_f32 v119, v119, v109
    v_add_f32 v120, v120, v110
    v_add_f32 v121, v121, v111
    ds_read_b128 v[52:55], v90 offset:0
    ds_read_b64_tr_b16 v[72:73], v93 offset:28672
    ds_read_b64_tr_b16 v[74:75], v93 offset:29696
    ds_read_b64_tr_b16 v[76:77], v96 offset:28672
    ds_read_b64_tr_b16 v[78:79], v96 offset:29696
    s_waitcnt lgkmcnt(10)
    v_mfma_f32_32x32x16_bf16 v[12:27], v[56:59], v[44:47], v[12:27]
    v_mfma_f32_32x32x16_bf16 v[28:43], v[60:63], v[44:47], v[28:43]
    v_lshlrev_b32 v104, 16, v60
    v_and_b32 v105, 0xffff0000, v60
    v_lshlrev_b32 v106, 16, v61
    v_and_b32 v107, 0xffff0000, v61
    v_lshlrev_b32 v108, 16, v62
    v_and_b32 v109, 0xffff0000, v62
    v_lshlrev_b32 v110, 16, v63
    v_and_b32 v111, 0xffff0000, v63
    v_add_f32 v118, v118, v104
    v_add_f32 v119, v119, v105
    v_add_f32 v120, v120, v106
    v_add_f32 v121, v121, v107
    v_add_f32 v118, v118, v108
    v_add_f32 v119, v119, v109
    v_add_f32 v120, v120, v110
    v_add_f32 v121, v121, v111
    s_barrier
    ds_read_b128 v[44:47], v81 offset:32768
    ds_read_b64_tr_b16 v[56:57], v93 offset:49152
    ds_read_b64_tr_b16 v[58:59], v93 offset:50176
    ds_read_b64_tr_b16 v[60:61], v96 offset:49152
    ds_read_b64_tr_b16 v[62:63], v96 offset:50176
    s_waitcnt lgkmcnt(10)
    v_mfma_f32_32x32x16_bf16 v[12:27], v[64:67], v[48:51], v[12:27]
    v_mfma_f32_32x32x16_bf16 v[28:43], v[68:71], v[48:51], v[28:43]
    v_lshlrev_b32 v104, 16, v68
    v_and_b32 v105, 0xffff0000, v68
    v_lshlrev_b32 v106, 16, v69
    v_and_b32 v107, 0xffff0000, v69
    v_lshlrev_b32 v108, 16, v70
    v_and_b32 v109, 0xffff0000, v70
    v_lshlrev_b32 v110, 16, v71
    v_and_b32 v111, 0xffff0000, v71
    v_add_f32 v118, v118, v104
    v_add_f32 v119, v119, v105
    v_add_f32 v120, v120, v106
    v_add_f32 v121, v121, v107
    v_add_f32 v118, v118, v108
    v_add_f32 v119, v119, v109
    v_add_f32 v120, v120, v110
    v_add_f32 v121, v121, v111
    ds_read_b128 v[48:51], v84 offset:32768
    ds_read_b64_tr_b16 v[64:65], v93 offset:53248
    ds_read_b64_tr_b16 v[66:67], v93 offset:54272
    ds_read_b64_tr_b16 v[68:69], v96 offset:53248
    ds_read_b64_tr_b16 v[70:71], v96 offset:54272
    s_waitcnt lgkmcnt(10)
    v_mfma_f32_32x32x16_bf16 v[12:27], v[72:75], v[52:55], v[12:27]
    v_mfma_f32_32x32x16_bf16 v[28:43], v[76:79], v[52:55], v[28:43]
    v_lshlrev_b32 v104, 16, v76
    v_and_b32 v105, 0xffff0000, v76
    v_lshlrev_b32 v106, 16, v77
    v_and_b32 v107, 0xffff0000, v77
    v_lshlrev_b32 v108, 16, v78
    v_and_b32 v109, 0xffff0000, v78
    v_lshlrev_b32 v110, 16, v79
    v_and_b32 v111, 0xffff0000, v79
    v_add_f32 v118, v118, v104
    v_add_f32 v119, v119, v105
    v_add_f32 v120, v120, v106
    v_add_f32 v121, v121, v107
    v_add_f32 v118, v118, v108
    v_add_f32 v119, v119, v109
    v_add_f32 v120, v120, v110
    v_add_f32 v121, v121, v111
    ds_read_b128 v[52:55], v87 offset:32768
    ds_read_b64_tr_b16 v[72:73], v93 offset:57344
    ds_read_b64_tr_b16 v[74:75], v93 offset:58368
    ds_read_b64_tr_b16 v[76:77], v96 offset:57344
    ds_read_b64_tr_b16 v[78:79], v96 offset:58368
    s_waitcnt lgkmcnt(10)
    v_mfma_f32_32x32x16_bf16 v[12:27], v[56:59], v[44:47], v[12:27]
    v_mfma_f32_32x32x16_bf16 v[28:43], v[60:63], v[44:47], v[28:43]
    v_lshlrev_b32 v104, 16, v60
    v_and_b32 v105, 0xffff0000, v60
    v_lshlrev_b32 v106, 16, v61
    v_and_b32 v107, 0xffff0000, v61
    v_lshlrev_b32 v108, 16, v62
    v_and_b32 v109, 0xffff0000, v62
    v_lshlrev_b32 v110, 16, v63
    v_and_b32 v111, 0xffff0000, v63
    v_add_f32 v118, v118, v104
    v_add_f32 v119, v119, v105
    v_add_f32 v120, v120, v106
    v_add_f32 v121, v121, v107
    v_add_f32 v118, v118, v108
    v_add_f32 v119, v119, v109
    v_add_f32 v120, v120, v110
    v_add_f32 v121, v121, v111
    ds_read_b128 v[44:47], v90 offset:32768
    ds_read_b64_tr_b16 v[56:57], v93 offset:61440
    ds_read_b64_tr_b16 v[58:59], v93 offset:62464
    ds_read_b64_tr_b16 v[60:61], v96 offset:61440
    ds_read_b64_tr_b16 v[62:63], v96 offset:62464
    s_waitcnt lgkmcnt(10)
    v_mfma_f32_32x32x16_bf16 v[12:27], v[64:67], v[48:51], v[12:27]
    v_mfma_f32_32x32x16_bf16 v[28:43], v[68:71], v[48:51], v[28:43]
    v_lshlrev_b32 v104, 16, v68
    v_and_b32 v105, 0xffff0000, v68
    v_lshlrev_b32 v106, 16, v69
    v_and_b32 v107, 0xffff0000, v69
    v_lshlrev_b32 v108, 16, v70
    v_and_b32 v109, 0xffff0000, v70
    v_lshlrev_b32 v110, 16, v71
    v_and_b32 v111, 0xffff0000, v71
    v_add_f32 v118, v118, v104
    v_add_f32 v119, v119, v105
    v_add_f32 v120, v120, v106
    v_add_f32 v121, v121, v107
    v_add_f32 v118, v118, v108
    v_add_f32 v119, v119, v109
    v_add_f32 v120, v120, v110
    v_add_f32 v121, v121, v111
    s_barrier
    ds_read_b128 v[48:51], v82 offset:0
    ds_read_b64_tr_b16 v[64:65], v94 offset:16384
    ds_read_b64_tr_b16 v[66:67], v94 offset:17408
    ds_read_b64_tr_b16 v[68:69], v97 offset:16384
    ds_read_b64_tr_b16 v[70:71], v97 offset:17408
    s_waitcnt lgkmcnt(10)
    v_mfma_f32_32x32x16_bf16 v[12:27], v[72:75], v[52:55], v[12:27]
    v_mfma_f32_32x32x16_bf16 v[28:43], v[76:79], v[52:55], v[28:43]
    v_lshlrev_b32 v104, 16, v76
    v_and_b32 v105, 0xffff0000, v76
    v_lshlrev_b32 v106, 16, v77
    v_and_b32 v107, 0xffff0000, v77
    v_lshlrev_b32 v108, 16, v78
    v_and_b32 v109, 0xffff0000, v78
    v_lshlrev_b32 v110, 16, v79
    v_and_b32 v111, 0xffff0000, v79
    v_add_f32 v118, v118, v104
    v_add_f32 v119, v119, v105
    v_add_f32 v120, v120, v106
    v_add_f32 v121, v121, v107
    v_add_f32 v118, v118, v108
    v_add_f32 v119, v119, v109
    v_add_f32 v120, v120, v110
    v_add_f32 v121, v121, v111
    ds_read_b128 v[52:55], v85 offset:0
    ds_read_b64_tr_b16 v[72:73], v94 offset:20480
    ds_read_b64_tr_b16 v[74:75], v94 offset:21504
    ds_read_b64_tr_b16 v[76:77], v97 offset:20480
    ds_read_b64_tr_b16 v[78:79], v97 offset:21504
    s_waitcnt lgkmcnt(10)
    v_mfma_f32_32x32x16_bf16 v[12:27], v[56:59], v[44:47], v[12:27]
    v_mfma_f32_32x32x16_bf16 v[28:43], v[60:63], v[44:47], v[28:43]
    v_lshlrev_b32 v104, 16, v60
    v_and_b32 v105, 0xffff0000, v60
    v_lshlrev_b32 v106, 16, v61
    v_and_b32 v107, 0xffff0000, v61
    v_lshlrev_b32 v108, 16, v62
    v_and_b32 v109, 0xffff0000, v62
    v_lshlrev_b32 v110, 16, v63
    v_and_b32 v111, 0xffff0000, v63
    v_add_f32 v118, v118, v104
    v_add_f32 v119, v119, v105
    v_add_f32 v120, v120, v106
    v_add_f32 v121, v121, v107
    v_add_f32 v118, v118, v108
    v_add_f32 v119, v119, v109
    v_add_f32 v120, v120, v110
    v_add_f32 v121, v121, v111
    ds_read_b128 v[44:47], v88 offset:0
    ds_read_b64_tr_b16 v[56:57], v94 offset:24576
    ds_read_b64_tr_b16 v[58:59], v94 offset:25600
    ds_read_b64_tr_b16 v[60:61], v97 offset:24576
    ds_read_b64_tr_b16 v[62:63], v97 offset:25600
    s_waitcnt lgkmcnt(10)
    v_mfma_f32_32x32x16_bf16 v[12:27], v[64:67], v[48:51], v[12:27]
    v_mfma_f32_32x32x16_bf16 v[28:43], v[68:71], v[48:51], v[28:43]
    v_lshlrev_b32 v104, 16, v68
    v_and_b32 v105, 0xffff0000, v68
    v_lshlrev_b32 v106, 16, v69
    v_and_b32 v107, 0xffff0000, v69
    v_lshlrev_b32 v108, 16, v70
    v_and_b32 v109, 0xffff0000, v70
    v_lshlrev_b32 v110, 16, v71
    v_and_b32 v111, 0xffff0000, v71
    v_add_f32 v118, v118, v104
    v_add_f32 v119, v119, v105
    v_add_f32 v120, v120, v106
    v_add_f32 v121, v121, v107
    v_add_f32 v118, v118, v108
    v_add_f32 v119, v119, v109
    v_add_f32 v120, v120, v110
    v_add_f32 v121, v121, v111
    ds_read_b128 v[48:51], v91 offset:0
    ds_read_b64_tr_b16 v[64:65], v94 offset:28672
    ds_read_b64_tr_b16 v[66:67], v94 offset:29696
    ds_read_b64_tr_b16 v[68:69], v97 offset:28672
    ds_read_b64_tr_b16 v[70:71], v97 offset:29696
    s_waitcnt lgkmcnt(10)
    v_mfma_f32_32x32x16_bf16 v[12:27], v[72:75], v[52:55], v[12:27]
    v_mfma_f32_32x32x16_bf16 v[28:43], v[76:79], v[52:55], v[28:43]
    v_lshlrev_b32 v104, 16, v76
    v_and_b32 v105, 0xffff0000, v76
    v_lshlrev_b32 v106, 16, v77
    v_and_b32 v107, 0xffff0000, v77
    v_lshlrev_b32 v108, 16, v78
    v_and_b32 v109, 0xffff0000, v78
    v_lshlrev_b32 v110, 16, v79
    v_and_b32 v111, 0xffff0000, v79
    v_add_f32 v118, v118, v104
    v_add_f32 v119, v119, v105
    v_add_f32 v120, v120, v106
    v_add_f32 v121, v121, v107
    v_add_f32 v118, v118, v108
    v_add_f32 v119, v119, v109
    v_add_f32 v120, v120, v110
    v_add_f32 v121, v121, v111
    s_barrier
    ds_read_b128 v[52:55], v80 offset:0
    ds_read_b64_tr_b16 v[72:73], v92 offset:16384
    ds_read_b64_tr_b16 v[74:75], v92 offset:17408
    ds_read_b64_tr_b16 v[76:77], v95 offset:16384
    ds_read_b64_tr_b16 v[78:79], v95 offset:17408
    s_waitcnt lgkmcnt(10)
    v_mfma_f32_32x32x16_bf16 v[12:27], v[56:59], v[44:47], v[12:27]
    v_mfma_f32_32x32x16_bf16 v[28:43], v[60:63], v[44:47], v[28:43]
    v_lshlrev_b32 v104, 16, v60
    v_and_b32 v105, 0xffff0000, v60
    v_lshlrev_b32 v106, 16, v61
    v_and_b32 v107, 0xffff0000, v61
    v_lshlrev_b32 v108, 16, v62
    v_and_b32 v109, 0xffff0000, v62
    v_lshlrev_b32 v110, 16, v63
    v_and_b32 v111, 0xffff0000, v63
    v_add_f32 v118, v118, v104
    v_add_f32 v119, v119, v105
    v_add_f32 v120, v120, v106
    v_add_f32 v121, v121, v107
    v_add_f32 v118, v118, v108
    v_add_f32 v119, v119, v109
    v_add_f32 v120, v120, v110
    v_add_f32 v121, v121, v111
    ds_read_b128 v[44:47], v83 offset:0
    ds_read_b64_tr_b16 v[56:57], v92 offset:20480
    ds_read_b64_tr_b16 v[58:59], v92 offset:21504
    ds_read_b64_tr_b16 v[60:61], v95 offset:20480
    ds_read_b64_tr_b16 v[62:63], v95 offset:21504
    s_waitcnt lgkmcnt(10)
    v_mfma_f32_32x32x16_bf16 v[12:27], v[64:67], v[48:51], v[12:27]
    v_mfma_f32_32x32x16_bf16 v[28:43], v[68:71], v[48:51], v[28:43]
    v_lshlrev_b32 v104, 16, v68
    v_and_b32 v105, 0xffff0000, v68
    v_lshlrev_b32 v106, 16, v69
    v_and_b32 v107, 0xffff0000, v69
    v_lshlrev_b32 v108, 16, v70
    v_and_b32 v109, 0xffff0000, v70
    v_lshlrev_b32 v110, 16, v71
    v_and_b32 v111, 0xffff0000, v71
    v_add_f32 v118, v118, v104
    v_add_f32 v119, v119, v105
    v_add_f32 v120, v120, v106
    v_add_f32 v121, v121, v107
    v_add_f32 v118, v118, v108
    v_add_f32 v119, v119, v109
    v_add_f32 v120, v120, v110
    v_add_f32 v121, v121, v111
    ds_read_b128 v[48:51], v86 offset:0
    ds_read_b64_tr_b16 v[64:65], v92 offset:24576
    ds_read_b64_tr_b16 v[66:67], v92 offset:25600
    ds_read_b64_tr_b16 v[68:69], v95 offset:24576
    ds_read_b64_tr_b16 v[70:71], v95 offset:25600
    s_waitcnt lgkmcnt(10)
    v_mfma_f32_32x32x16_bf16 v[12:27], v[72:75], v[52:55], v[12:27]
    v_mfma_f32_32x32x16_bf16 v[28:43], v[76:79], v[52:55], v[28:43]
    v_lshlrev_b32 v104, 16, v76
    v_and_b32 v105, 0xffff0000, v76
    v_lshlrev_b32 v106, 16, v77
    v_and_b32 v107, 0xffff0000, v77
    v_lshlrev_b32 v108, 16, v78
    v_and_b32 v109, 0xffff0000, v78
    v_lshlrev_b32 v110, 16, v79
    v_and_b32 v111, 0xffff0000, v79
    v_add_f32 v118, v118, v104
    v_add_f32 v119, v119, v105
    v_add_f32 v120, v120, v106
    v_add_f32 v121, v121, v107
    v_add_f32 v118, v118, v108
    v_add_f32 v119, v119, v109
    v_add_f32 v120, v120, v110
    v_add_f32 v121, v121, v111
    ds_read_b128 v[52:55], v89 offset:0
    ds_read_b64_tr_b16 v[72:73], v92 offset:28672
    ds_read_b64_tr_b16 v[74:75], v92 offset:29696
    ds_read_b64_tr_b16 v[76:77], v95 offset:28672
    ds_read_b64_tr_b16 v[78:79], v95 offset:29696
    s_waitcnt lgkmcnt(10)
    v_mfma_f32_32x32x16_bf16 v[12:27], v[56:59], v[44:47], v[12:27]
    v_mfma_f32_32x32x16_bf16 v[28:43], v[60:63], v[44:47], v[28:43]
    v_lshlrev_b32 v104, 16, v60
    v_and_b32 v105, 0xffff0000, v60
    v_lshlrev_b32 v106, 16, v61
    v_and_b32 v107, 0xffff0000, v61
    v_lshlrev_b32 v108, 16, v62
    v_and_b32 v109, 0xffff0000, v62
    v_lshlrev_b32 v110, 16, v63
    v_and_b32 v111, 0xffff0000, v63
    v_add_f32 v118, v118, v104
    v_add_f32 v119, v119, v105
    v_add_f32 v120, v120, v106
    v_add_f32 v121, v121, v107
    v_add_f32 v118, v118, v108
    v_add_f32 v119, v119, v109
    v_add_f32 v120, v120, v110
    v_add_f32 v121, v121, v111
    s_barrier
    ds_read_b128 v[44:47], v80 offset:32768
    ds_read_b64_tr_b16 v[56:57], v92 offset:49152
    ds_read_b64_tr_b16 v[58:59], v92 offset:50176
    ds_read_b64_tr_b16 v[60:61], v95 offset:49152
    ds_read_b64_tr_b16 v[62:63], v95 offset:50176
    s_waitcnt lgkmcnt(10)
    v_mfma_f32_32x32x16_bf16 v[12:27], v[64:67], v[48:51], v[12:27]
    v_mfma_f32_32x32x16_bf16 v[28:43], v[68:71], v[48:51], v[28:43]
    v_lshlrev_b32 v104, 16, v68
    v_and_b32 v105, 0xffff0000, v68
    v_lshlrev_b32 v106, 16, v69
    v_and_b32 v107, 0xffff0000, v69
    v_lshlrev_b32 v108, 16, v70
    v_and_b32 v109, 0xffff0000, v70
    v_lshlrev_b32 v110, 16, v71
    v_and_b32 v111, 0xffff0000, v71
    v_add_f32 v118, v118, v104
    v_add_f32 v119, v119, v105
    v_add_f32 v120, v120, v106
    v_add_f32 v121, v121, v107
    v_add_f32 v118, v118, v108
    v_add_f32 v119, v119, v109
    v_add_f32 v120, v120, v110
    v_add_f32 v121, v121, v111
    ds_read_b128 v[48:51], v83 offset:32768
    ds_read_b64_tr_b16 v[64:65], v92 offset:53248
    ds_read_b64_tr_b16 v[66:67], v92 offset:54272
    ds_read_b64_tr_b16 v[68:69], v95 offset:53248
    ds_read_b64_tr_b16 v[70:71], v95 offset:54272
    s_waitcnt lgkmcnt(10)
    v_mfma_f32_32x32x16_bf16 v[12:27], v[72:75], v[52:55], v[12:27]
    v_mfma_f32_32x32x16_bf16 v[28:43], v[76:79], v[52:55], v[28:43]
    v_lshlrev_b32 v104, 16, v76
    v_and_b32 v105, 0xffff0000, v76
    v_lshlrev_b32 v106, 16, v77
    v_and_b32 v107, 0xffff0000, v77
    v_lshlrev_b32 v108, 16, v78
    v_and_b32 v109, 0xffff0000, v78
    v_lshlrev_b32 v110, 16, v79
    v_and_b32 v111, 0xffff0000, v79
    v_add_f32 v118, v118, v104
    v_add_f32 v119, v119, v105
    v_add_f32 v120, v120, v106
    v_add_f32 v121, v121, v107
    v_add_f32 v118, v118, v108
    v_add_f32 v119, v119, v109
    v_add_f32 v120, v120, v110
    v_add_f32 v121, v121, v111
    ds_read_b128 v[52:55], v86 offset:32768
    ds_read_b64_tr_b16 v[72:73], v92 offset:57344
    ds_read_b64_tr_b16 v[74:75], v92 offset:58368
    ds_read_b64_tr_b16 v[76:77], v95 offset:57344
    ds_read_b64_tr_b16 v[78:79], v95 offset:58368
    s_waitcnt lgkmcnt(10)
    v_mfma_f32_32x32x16_bf16 v[12:27], v[56:59], v[44:47], v[12:27]
    v_mfma_f32_32x32x16_bf16 v[28:43], v[60:63], v[44:47], v[28:43]
    v_lshlrev_b32 v104, 16, v60
    v_and_b32 v105, 0xffff0000, v60
    v_lshlrev_b32 v106, 16, v61
    v_and_b32 v107, 0xffff0000, v61
    v_lshlrev_b32 v108, 16, v62
    v_and_b32 v109, 0xffff0000, v62
    v_lshlrev_b32 v110, 16, v63
    v_and_b32 v111, 0xffff0000, v63
    v_add_f32 v118, v118, v104
    v_add_f32 v119, v119, v105
    v_add_f32 v120, v120, v106
    v_add_f32 v121, v121, v107
    v_add_f32 v118, v118, v108
    v_add_f32 v119, v119, v109
    v_add_f32 v120, v120, v110
    v_add_f32 v121, v121, v111
    ds_read_b128 v[44:47], v89 offset:32768
    ds_read_b64_tr_b16 v[56:57], v92 offset:61440
    ds_read_b64_tr_b16 v[58:59], v92 offset:62464
    ds_read_b64_tr_b16 v[60:61], v95 offset:61440
    ds_read_b64_tr_b16 v[62:63], v95 offset:62464
    s_waitcnt lgkmcnt(10)
    v_mfma_f32_32x32x16_bf16 v[12:27], v[64:67], v[48:51], v[12:27]
    v_mfma_f32_32x32x16_bf16 v[28:43], v[68:71], v[48:51], v[28:43]
    v_lshlrev_b32 v104, 16, v68
    v_and_b32 v105, 0xffff0000, v68
    v_lshlrev_b32 v106, 16, v69
    v_and_b32 v107, 0xffff0000, v69
    v_lshlrev_b32 v108, 16, v70
    v_and_b32 v109, 0xffff0000, v70
    v_lshlrev_b32 v110, 16, v71
    v_and_b32 v111, 0xffff0000, v71
    v_add_f32 v118, v118, v104
    v_add_f32 v119, v119, v105
    v_add_f32 v120, v120, v106
    v_add_f32 v121, v121, v107
    v_add_f32 v118, v118, v108
    v_add_f32 v119, v119, v109
    v_add_f32 v120, v120, v110
    v_add_f32 v121, v121, v111
    s_barrier
    ds_read_b128 v[48:51], v81 offset:0
    ds_read_b64_tr_b16 v[64:65], v93 offset:16384
    ds_read_b64_tr_b16 v[66:67], v93 offset:17408
    ds_read_b64_tr_b16 v[68:69], v96 offset:16384
    ds_read_b64_tr_b16 v[70:71], v96 offset:17408
    s_waitcnt lgkmcnt(10)
    v_mfma_f32_32x32x16_bf16 v[12:27], v[72:75], v[52:55], v[12:27]
    v_mfma_f32_32x32x16_bf16 v[28:43], v[76:79], v[52:55], v[28:43]
    v_lshlrev_b32 v104, 16, v76
    v_and_b32 v105, 0xffff0000, v76
    v_lshlrev_b32 v106, 16, v77
    v_and_b32 v107, 0xffff0000, v77
    v_lshlrev_b32 v108, 16, v78
    v_and_b32 v109, 0xffff0000, v78
    v_lshlrev_b32 v110, 16, v79
    v_and_b32 v111, 0xffff0000, v79
    v_add_f32 v118, v118, v104
    v_add_f32 v119, v119, v105
    v_add_f32 v120, v120, v106
    v_add_f32 v121, v121, v107
    v_add_f32 v118, v118, v108
    v_add_f32 v119, v119, v109
    v_add_f32 v120, v120, v110
    v_add_f32 v121, v121, v111
    ds_read_b128 v[52:55], v84 offset:0
    ds_read_b64_tr_b16 v[72:73], v93 offset:20480
    ds_read_b64_tr_b16 v[74:75], v93 offset:21504
    ds_read_b64_tr_b16 v[76:77], v96 offset:20480
    ds_read_b64_tr_b16 v[78:79], v96 offset:21504
    s_waitcnt lgkmcnt(10)
    v_mfma_f32_32x32x16_bf16 v[12:27], v[56:59], v[44:47], v[12:27]
    v_mfma_f32_32x32x16_bf16 v[28:43], v[60:63], v[44:47], v[28:43]
    v_lshlrev_b32 v104, 16, v60
    v_and_b32 v105, 0xffff0000, v60
    v_lshlrev_b32 v106, 16, v61
    v_and_b32 v107, 0xffff0000, v61
    v_lshlrev_b32 v108, 16, v62
    v_and_b32 v109, 0xffff0000, v62
    v_lshlrev_b32 v110, 16, v63
    v_and_b32 v111, 0xffff0000, v63
    v_add_f32 v118, v118, v104
    v_add_f32 v119, v119, v105
    v_add_f32 v120, v120, v106
    v_add_f32 v121, v121, v107
    v_add_f32 v118, v118, v108
    v_add_f32 v119, v119, v109
    v_add_f32 v120, v120, v110
    v_add_f32 v121, v121, v111
    ds_read_b128 v[44:47], v87 offset:0
    ds_read_b64_tr_b16 v[56:57], v93 offset:24576
    ds_read_b64_tr_b16 v[58:59], v93 offset:25600
    ds_read_b64_tr_b16 v[60:61], v96 offset:24576
    ds_read_b64_tr_b16 v[62:63], v96 offset:25600
    s_waitcnt lgkmcnt(10)
    v_mfma_f32_32x32x16_bf16 v[12:27], v[64:67], v[48:51], v[12:27]
    v_mfma_f32_32x32x16_bf16 v[28:43], v[68:71], v[48:51], v[28:43]
    v_lshlrev_b32 v104, 16, v68
    v_and_b32 v105, 0xffff0000, v68
    v_lshlrev_b32 v106, 16, v69
    v_and_b32 v107, 0xffff0000, v69
    v_lshlrev_b32 v108, 16, v70
    v_and_b32 v109, 0xffff0000, v70
    v_lshlrev_b32 v110, 16, v71
    v_and_b32 v111, 0xffff0000, v71
    v_add_f32 v118, v118, v104
    v_add_f32 v119, v119, v105
    v_add_f32 v120, v120, v106
    v_add_f32 v121, v121, v107
    v_add_f32 v118, v118, v108
    v_add_f32 v119, v119, v109
    v_add_f32 v120, v120, v110
    v_add_f32 v121, v121, v111
    ds_read_b128 v[48:51], v90 offset:0
    ds_read_b64_tr_b16 v[64:65], v93 offset:28672
    ds_read_b64_tr_b16 v[66:67], v93 offset:29696
    ds_read_b64_tr_b16 v[68:69], v96 offset:28672
    ds_read_b64_tr_b16 v[70:71], v96 offset:29696
    s_waitcnt lgkmcnt(10)
    v_mfma_f32_32x32x16_bf16 v[12:27], v[72:75], v[52:55], v[12:27]
    v_mfma_f32_32x32x16_bf16 v[28:43], v[76:79], v[52:55], v[28:43]
    v_lshlrev_b32 v104, 16, v76
    v_and_b32 v105, 0xffff0000, v76
    v_lshlrev_b32 v106, 16, v77
    v_and_b32 v107, 0xffff0000, v77
    v_lshlrev_b32 v108, 16, v78
    v_and_b32 v109, 0xffff0000, v78
    v_lshlrev_b32 v110, 16, v79
    v_and_b32 v111, 0xffff0000, v79
    v_add_f32 v118, v118, v104
    v_add_f32 v119, v119, v105
    v_add_f32 v120, v120, v106
    v_add_f32 v121, v121, v107
    v_add_f32 v118, v118, v108
    v_add_f32 v119, v119, v109
    v_add_f32 v120, v120, v110
    v_add_f32 v121, v121, v111
    s_waitcnt lgkmcnt(5)
    v_mfma_f32_32x32x16_bf16 v[12:27], v[56:59], v[44:47], v[12:27]
    v_mfma_f32_32x32x16_bf16 v[28:43], v[60:63], v[44:47], v[28:43]
    v_lshlrev_b32 v104, 16, v60
    v_and_b32 v105, 0xffff0000, v60
    v_lshlrev_b32 v106, 16, v61
    v_and_b32 v107, 0xffff0000, v61
    v_lshlrev_b32 v108, 16, v62
    v_and_b32 v109, 0xffff0000, v62
    v_lshlrev_b32 v110, 16, v63
    v_and_b32 v111, 0xffff0000, v63
    v_add_f32 v118, v118, v104
    v_add_f32 v119, v119, v105
    v_add_f32 v120, v120, v106
    v_add_f32 v121, v121, v107
    v_add_f32 v118, v118, v108
    v_add_f32 v119, v119, v109
    v_add_f32 v120, v120, v110
    v_add_f32 v121, v121, v111
    s_waitcnt lgkmcnt(0)
    v_mfma_f32_32x32x16_bf16 v[12:27], v[64:67], v[48:51], v[12:27]
    v_mfma_f32_32x32x16_bf16 v[28:43], v[68:71], v[48:51], v[28:43]
    v_lshlrev_b32 v104, 16, v68
    v_and_b32 v105, 0xffff0000, v68
    v_lshlrev_b32 v106, 16, v69
    v_and_b32 v107, 0xffff0000, v69
    v_lshlrev_b32 v108, 16, v70
    v_and_b32 v109, 0xffff0000, v70
    v_lshlrev_b32 v110, 16, v71
    v_and_b32 v111, 0xffff0000, v71
    v_add_f32 v118, v118, v104
    v_add_f32 v119, v119, v105
    v_add_f32 v120, v120, v106
    v_add_f32 v121, v121, v107
    v_add_f32 v118, v118, v108
    v_add_f32 v119, v119, v109
    v_add_f32 v120, v120, v110
    v_add_f32 v121, v121, v111
k1_e1_11:
    v_add_f32 v118, v118, v119
    v_add_f32 v120, v120, v121
    v_add_f32 v98, v118, v120
    v_mov_b32 v4, v98
    s_nop 1
    v_permlane32_swap_b32 v4, v98
    v_add_f32 v98, v98, v4
    s_lshl_b32 s35, s30, 7
    v_lshlrev_b32 v2, 2, v101
    v_add_u32 v2, s35, v2
    ds_write_b32 v2, v98 offset:2048
    v_lshlrev_b32 v3, 4, v100
    v_add_u32 v3, s35, v3
    s_waitcnt lgkmcnt(0)
    ds_read_b128 v[44:47], v3 offset:2048
    ds_read_b128 v[48:51], v3 offset:2080
    ds_read_b128 v[52:55], v3 offset:2112
    ds_read_b128 v[56:59], v3 offset:2144
    s_barrier
    s_lshl_b32 s35, s30, 8
    v_lshlrev_b32 v2, 3, v101
    v_add_u32 v2, s35, v2
    ds_read_b64 v[98:99], v2
    s_add_u32 s39, s42, 0
    s_and_b32 s35, s39, 15
    s_lshl_b32 s35, s35, 7
    s_add_u32 s35, s35, s45
    s_lshl_b32 s35, s35, 10
    s_lshr_b32 s36, s39, 4
    s_lshl_b32 s36, s36, 21
    s_add_u32 s35, s35, s36
    s_cmp_ge_u32 s39, 32
    s_cbranch_scc1 k1_ev_18
    s_cmp_lt_u32 s39, 16
    s_cselect_b32 s37, 0x3eb8aa3b, 1.0
    v_mul_f32 v12, s37, v12
    v_mul_f32 v13, s37, v13
    v_mul_f32 v14, s37, v14
    v_mul_f32 v15, s37, v15
    v_mul_f32 v16, s37, v16
    v_mul_f32 v17, s37, v17
    v_mul_f32 v18, s37, v18
    v_mul_f32 v19, s37, v19
    v_cvt_pk_bf16_f32 v104, v12, v13
    v_cvt_pk_bf16_f32 v105, v14, v15
    v_cvt_pk_bf16_f32 v106, v16, v17
    v_cvt_pk_bf16_f32 v107, v18, v19
    s_add_u32 s38, s35, 0
    buffer_store_dwordx4 v[104:107], v112, s[16:19], s38 offen
    v_mul_f32 v20, s37, v20
    v_mul_f32 v21, s37, v21
    v_mul_f32 v22, s37, v22
    v_mul_f32 v23, s37, v23
    v_mul_f32 v24, s37, v24
    v_mul_f32 v25, s37, v25
    v_mul_f32 v26, s37, v26
    v_mul_f32 v27, s37, v27
    v_cvt_pk_bf16_f32 v108, v20, v21
    v_cvt_pk_bf16_f32 v109, v22, v23
    v_cvt_pk_bf16_f32 v110, v24, v25
    v_cvt_pk_bf16_f32 v111, v26, v27
    s_add_u32 s38, s35, 65536
    buffer_store_dwordx4 v[108:111], v112, s[16:19], s38 offen
    s_branch k1_ed_19
k1_ev_18:
    v_cvt_pk_bf16_f32 v104, v12, v13
    v_cvt_pk_bf16_f32 v105, v14, v15
    v_cvt_pk_bf16_f32 v106, v16, v17
    v_cvt_pk_bf16_f32 v107, v18, v19
    buffer_store_dwordx4 v[104:107], v113, s[16:19], s35 offen offset:0
    v_cvt_pk_bf16_f32 v108, v20, v21
    v_cvt_pk_bf16_f32 v109, v22, v23
    v_cvt_pk_bf16_f32 v110, v24, v25
    v_cvt_pk_bf16_f32 v111, v26, v27
    buffer_store_dwordx4 v[108:111], v113, s[16:19], s35 offen offset:512
k1_ed_19:
    s_nop 1
    s_waitcnt lgkmcnt(0)
    v_mul_f32 v114, 0x3b000000, v98
    v_mul_f32 v99, 0x3b000000, v99
    v_fma_f32 v99, -v114, v114, v99
    v_max_f32 v99, 0, v99
    v_add_f32 v99, 0x3727c5ac, v99
    v_rsq_f32 v115, v99
    s_lshl_b32 s35, s33, 1
    s_lshl_b32 s36, s45, 5
    s_add_u32 s35, s35, s36
    s_lshl_b32 s35, s35, 10
    s_add_u32 s35, s35, 6291456
    v_fma_f32 v28, -v114, v44, v28
    v_fma_f32 v29, -v114, v45, v29
    v_fma_f32 v30, -v114, v46, v30
    v_fma_f32 v31, -v114, v47, v31
    v_fma_f32 v32, -v114, v48, v32
    v_fma_f32 v33, -v114, v49, v33
    v_fma_f32 v34, -v114, v50, v34
    v_fma_f32 v35, -v114, v51, v35
    v_fma_f32 v36, -v114, v52, v36
    v_fma_f32 v37, -v114, v53, v37
    v_fma_f32 v38, -v114, v54, v38
    v_fma_f32 v39, -v114, v55, v39
    v_fma_f32 v40, -v114, v56, v40
    v_fma_f32 v41, -v114, v57, v41
    v_fma_f32 v42, -v114, v58, v42
    v_fma_f32 v43, -v114, v59, v43
    v_mul_f32 v28, v28, v115
    v_mul_f32 v29, v29, v115
    v_mul_f32 v30, v30, v115
    v_mul_f32 v31, v31, v115
    v_mul_f32 v32, v32, v115
    v_mul_f32 v33, v33, v115
    v_mul_f32 v34, v34, v115
    v_mul_f32 v35, v35, v115
    v_mul_f32 v36, v36, v115
    v_mul_f32 v37, v37, v115
    v_mul_f32 v38, v38, v115
    v_mul_f32 v39, v39, v115
    v_mul_f32 v40, v40, v115
    v_mul_f32 v41, v41, v115
    v_mul_f32 v42, v42, v115
    v_mul_f32 v43, v43, v115
    v_mul_f32 v60, v28, v28
    v_mul_f32 v61, v29, v29
    v_mul_f32 v62, v30, v30
    v_mul_f32 v63, v31, v31
    v_mul_f32 v64, v32, v32
    v_mul_f32 v65, v33, v33
    v_mul_f32 v66, v34, v34
    v_mul_f32 v67, v35, v35
    v_mul_f32 v68, v36, v36
    v_mul_f32 v69, v37, v37
    v_mul_f32 v70, v38, v38
    v_mul_f32 v71, v39, v39
    v_mul_f32 v72, v40, v40
    v_mul_f32 v73, v41, v41
    v_mul_f32 v74, v42, v42
    v_mul_f32 v75, v43, v43
    v_fma_f32 v60, v60, s46, v116
    v_fma_f32 v61, v61, s46, v116
    v_fma_f32 v62, v62, s46, v116
    v_fma_f32 v63, v63, s46, v116
    v_fma_f32 v64, v64, s46, v116
    v_fma_f32 v65, v65, s46, v116
    v_fma_f32 v66, v66, s46, v116
    v_fma_f32 v67, v67, s46, v116
    v_fma_f32 v68, v68, s46, v116
    v_fma_f32 v69, v69, s46, v116
    v_fma_f32 v70, v70, s46, v116
    v_fma_f32 v71, v71, s46, v116
    v_fma_f32 v72, v72, s46, v116
    v_fma_f32 v73, v73, s46, v116
    v_fma_f32 v74, v74, s46, v116
    v_fma_f32 v75, v75, s46, v116
    v_mul_f32 v60, v60, v28
    v_mul_f32 v61, v61, v29
    v_mul_f32 v62, v62, v30
    v_mul_f32 v63, v63, v31
    v_mul_f32 v64, v64, v32
    v_mul_f32 v65, v65, v33
    v_mul_f32 v66, v66, v34
    v_mul_f32 v67, v67, v35
    v_mul_f32 v68, v68, v36
    v_mul_f32 v69, v69, v37
    v_mul_f32 v70, v70, v38
    v_mul_f32 v71, v71, v39
    v_mul_f32 v72, v72, v40
    v_mul_f32 v73, v73, v41
    v_mul_f32 v74, v74, v42
    v_mul_f32 v75, v75, v43
    v_exp_f32 v60, v60
    v_exp_f32 v61, v61
    v_exp_f32 v62, v62
    v_exp_f32 v63, v63
    v_exp_f32 v64, v64
    v_exp_f32 v65, v65
    v_exp_f32 v66, v66
    v_exp_f32 v67, v67
    v_exp_f32 v68, v68
    v_exp_f32 v69, v69
    v_exp_f32 v70, v70
    v_exp_f32 v71, v71
    v_exp_f32 v72, v72
    v_exp_f32 v73, v73
    v_exp_f32 v74, v74
    v_exp_f32 v75, v75
    v_add_f32 v60, 1.0, v60
    v_add_f32 v61, 1.0, v61
    v_add_f32 v62, 1.0, v62
    v_add_f32 v63, 1.0, v63
    v_add_f32 v64, 1.0, v64
    v_add_f32 v65, 1.0, v65
    v_add_f32 v66, 1.0, v66
    v_add_f32 v67, 1.0, v67
    v_add_f32 v68, 1.0, v68
    v_add_f32 v69, 1.0, v69
    v_add_f32 v70, 1.0, v70
    v_add_f32 v71, 1.0, v71
    v_add_f32 v72, 1.0, v72
    v_add_f32 v73, 1.0, v73
    v_add_f32 v74, 1.0, v74
    v_add_f32 v75, 1.0, v75
    v_rcp_f32 v60, v60
    v_rcp_f32 v61, v61
    v_rcp_f32 v62, v62
    v_rcp_f32 v63, v63
    v_rcp_f32 v64, v64
    v_rcp_f32 v65, v65
    v_rcp_f32 v66, v66
    v_rcp_f32 v67, v67
    v_rcp_f32 v68, v68
    v_rcp_f32 v69, v69
    v_rcp_f32 v70, v70
    v_rcp_f32 v71, v71
    v_rcp_f32 v72, v72
    v_rcp_f32 v73, v73
    v_rcp_f32 v74, v74
    v_rcp_f32 v75, v75
    v_mul_f32 v28, v28, v60
    v_mul_f32 v29, v29, v61
    v_mul_f32 v30, v30, v62
    v_mul_f32 v31, v31, v63
    v_mul_f32 v32, v32, v64
    v_mul_f32 v33, v33, v65
    v_mul_f32 v34, v34, v66
    v_mul_f32 v35, v35, v67
    v_mul_f32 v36, v36, v68
    v_mul_f32 v37, v37, v69
    v_mul_f32 v38, v38, v70
    v_mul_f32 v39, v39, v71
    v_mul_f32 v40, v40, v72
    v_mul_f32 v41, v41, v73
    v_mul_f32 v42, v42, v74
    v_mul_f32 v43, v43, v75
    v_cvt_pk_bf16_f32 v104, v28, v29
    v_cvt_pk_bf16_f32 v105, v30, v31
    v_cvt_pk_bf16_f32 v106, v32, v33
    v_cvt_pk_bf16_f32 v107, v34, v35
    buffer_store_dwordx4 v[104:107], v112, s[16:19], s35 offen offset:0
    v_cvt_pk_bf16_f32 v108, v36, v37
    v_cvt_pk_bf16_f32 v109, v38, v39
    v_cvt_pk_bf16_f32 v110, v40, v41
    v_cvt_pk_bf16_f32 v111, v42, v43
    buffer_store_dwordx4 v[108:111], v112, s[16:19], s35 offen offset:1024
k1_done_17:
k1_end_1:
    s_endpgm
.globl k2_kernel
.p2align 8
.type k2_kernel,@function
k2_kernel:
    s_cmp_ge_u32 s2, 512
    s_cbranch_scc1 k2_kernel_end_20
    s_load_dwordx2 s[84:85], s[0:1], 0
    s_load_dwordx2 s[86:87], s[0:1], 16
    s_load_dwordx4 s[88:91], s[0:1], 40
    s_load_dwordx4 s[92:95], s[0:1], 56
    s_load_dwordx2 s[96:97], s[0:1], 72
    s_load_dwordx2 s[98:99], s[0:1], 88
    v_and_b32 v1, 63, v0
    v_lshrrev_b32 v2, 6, v0
    s_nop 0
    v_readfirstlane_b32 s36, v2
    s_waitcnt lgkmcnt(0)
    s_mov_b32 s32, s98
    s_and_b32 s33, s99, 0xffff
    s_mov_b32 s34, 0x10000000
    s_mov_b32 s35, 0x00020000
    s_mov_b32 s4, s84
    s_and_b32 s5, s85, 0xffff
    s_mov_b32 s6, 0x200000
    s_mov_b32 s7, 0x00020000
    s_mov_b32 s8, s86
    s_and_b32 s9, s87, 0xffff
    s_mov_b32 s10, 0x80000
    s_mov_b32 s11, 0x00020000
    s_mov_b32 s12, s88
    s_and_b32 s13, s89, 0xffff
    s_mov_b32 s14, 0x80000
    s_mov_b32 s15, 0x00020000
    s_mov_b32 s16, s90
    s_and_b32 s17, s91, 0xffff
    s_mov_b32 s18, 0x1c0000
    s_mov_b32 s19, 0x00020000
    s_mov_b32 s20, s92
    s_and_b32 s21, s93, 0xffff
    s_mov_b32 s22, 0x1c0000
    s_mov_b32 s23, 0x00020000
    s_mov_b32 s24, s94
    s_and_b32 s25, s95, 0xffff
    s_mov_b32 s26, 0x400
    s_mov_b32 s27, 0x00020000
    s_mov_b32 s28, s96
    s_and_b32 s29, s97, 0xffff
    s_mov_b32 s30, 0x200000
    s_mov_b32 s31, 0x00020000
    s_cmp_ge_u32 s2, 256
    s_cbranch_scc1 k2_b_21
    s_setprio 3
    s_and_b32 s37, s2, 7
    s_lshr_b32 s38, s2, 3
    s_lshl_b32 s43, s37, 2
    s_lshr_b32 s39, s38, 3
    s_add_u32 s43, s43, s39
    s_and_b32 s44, s38, 7
    s_lshl_b32 s44, s44, 3
    s_add_u32 s44, s44, s36
    v_lshlrev_b32 v111, 4, v1
    s_lshl_b32 s45, s43, 16
    s_lshl_b32 s46, s36, 10
    s_add_u32 s45, s45, s46
    s_add_u32 s45, s45, 2097152
    s_add_u32 m0, s46, 0
    s_add_u32 s42, s45, 2097152
    buffer_load_dwordx4 v111, s[32:35], s45 offen lds
    s_add_u32 m0, m0, 8192
    s_add_u32 s45, s45, 8192
    buffer_load_dwordx4 v111, s[32:35], s42 offen lds
    s_lshl_b32 s37, s43, 6
    s_add_u32 s37, s37, s44
    s_lshl_b32 s37, s37, 10
    buffer_load_dwordx4 v[8:11], v111, s[32:35], s37 offen
    s_add_u32 m0, s46, 16384
    s_add_u32 s42, s45, 2097152
    buffer_load_dwordx4 v111, s[32:35], s45 offen lds
    s_add_u32 m0, m0, 8192
    s_add_u32 s45, s45, 8192
    buffer_load_dwordx4 v111, s[32:35], s42 offen lds
    s_add_u32 m0, s46, 32768
    s_add_u32 s42, s45, 2097152
    buffer_load_dwordx4 v111, s[32:35], s45 offen lds
    s_add_u32 m0, m0, 8192
    s_add_u32 s45, s45, 8192
    buffer_load_dwordx4 v111, s[32:35], s42 offen lds
    v_and_b32 v2, 1, v1
    v_cmp_eq_u32 vcc, 0, v2
    v_mov_b32 v3, 0x3f803f80
    s_add_u32 s37, s46, 65536
    v_cndmask_b32 v92, 0, v3, vcc
    v_mov_b32 v93, v92
    v_mov_b32 v94, v92
    v_mov_b32 v95, v92
    v_add_u32 v2, s37, v111
    ds_write_b128 v2, v[92:95]
    v_and_b32 v2, 31, v1
    v_lshrrev_b32 v3, 5, v1
    v_lshlrev_b32 v112, 8, v3
    v_lshl_add_u32 v112, v2, 4, v112
    v_cmp_gt_u32 vcc, 16, v2
    v_add_u32 v109, 8192, v112
    v_and_b32 v4, 27, v2
    v_cmp_eq_u32 s[48:49], 16, v4
    v_mov_b32 v4, 65552
    v_mov_b32 v5, 65536
    v_cndmask_b32 v4, v4, v5, s[48:49]
    v_cndmask_b32 v109, v4, v109, vcc
    v_mov_b32 v4, 16384
    v_cndmask_b32 v113, 0, v4, vcc
    v_mov_b32 v4, 0xffff
    v_cndmask_b32 v114, -1, v4, vcc
    v_mov_b32 v108, v111
    s_mov_b32 s48, 0x0000ffff
    s_mov_b32 s49, 0x0000ffff
    v_mov_b32 v68, 0
    v_mov_b32 v69, 0
    v_mov_b32 v70, 0
    v_mov_b32 v71, 0
    v_mov_b32 v72, 0
    v_mov_b32 v73, 0
    v_mov_b32 v74, 0
    v_mov_b32 v75, 0
    v_mov_b32 v76, 0
    v_mov_b32 v77, 0
    v_mov_b32 v78, 0
    v_mov_b32 v79, 0
    v_mov_b32 v80, 0
    v_mov_b32 v81, 0
    v_mov_b32 v82, 0
    v_mov_b32 v83, 0
    s_waitcnt vmcnt(4) lgkmcnt(0)
    s_barrier
    ds_read_b128 v[84:87], v108 offset:0
    ds_read_b128 v[88:91], v108 offset:1024
    ds_read_b128 v[92:95], v109 offset:0
    ds_read_b128 v[96:99], v109 offset:512
    s_waitcnt lgkmcnt(3)
    v_mfma_f32_32x32x16_bf16 v[28:43], v[84:87], v[8:11], 0
    s_nop 15
    v_max3_f32 v2, v28, v29, v30
    v_max3_f32 v2, v2, v31, v32
    v_max3_f32 v2, v2, v33, v34
    v_max3_f32 v2, v2, v35, v36
    v_max3_f32 v2, v2, v37, v38
    v_max3_f32 v2, v2, v39, v40
    v_max3_f32 v2, v2, v41, v42
    v_max_f32 v2, v2, v43
    v_mov_b32 v3, v2
    s_nop 1
    v_permlane32_swap_b32 v3, v2
    v_max_f32 v2, v2, v3
    v_sub_f32 v12, 0, v2
    v_sub_f32 v13, 0, v2
    v_sub_f32 v14, 0, v2
    v_sub_f32 v15, 0, v2
    v_sub_f32 v16, 0, v2
    v_sub_f32 v17, 0, v2
    v_sub_f32 v18, 0, v2
    v_sub_f32 v19, 0, v2
    v_sub_f32 v20, 0, v2
    v_sub_f32 v21, 0, v2
    v_sub_f32 v22, 0, v2
    v_sub_f32 v23, 0, v2
    v_sub_f32 v24, 0, v2
    v_sub_f32 v25, 0, v2
    v_sub_f32 v26, 0, v2
    v_sub_f32 v27, 0, v2
    s_nop 1
    v_mfma_f32_32x32x16_bf16 v[28:43], v[84:87], v[8:11], v[12:27]
    s_nop 7
    s_nop 3
    s_setprio 0
    v_exp_f32 v28, v28
    v_exp_f32 v29, v29
    v_exp_f32 v30, v30
    v_exp_f32 v31, v31
    v_exp_f32 v32, v32
    v_exp_f32 v33, v33
    s_waitcnt lgkmcnt(0)
    v_mfma_f32_32x32x16_bf16 v[44:59], v[88:91], v[8:11], v[12:27]
    v_exp_f32 v34, v34
    v_exp_f32 v35, v35
    v_cvt_pk_bf16_f32 v60, v28, v29
    v_exp_f32 v36, v36
    ds_read_b128 v[100:103], v109 offset:1024
    ds_read_b128 v[104:107], v109 offset:1536
    ds_read_b128 v[84:87], v108 offset:2048
    v_exp_f32 v37, v37
    v_cvt_pk_bf16_f32 v61, v30, v31
    v_exp_f32 v38, v38
    v_exp_f32 v39, v39
    v_cvt_pk_bf16_f32 v62, v32, v33
    v_exp_f32 v40, v40
    v_exp_f32 v41, v41
    v_cvt_pk_bf16_f32 v63, v34, v35
    v_exp_f32 v42, v42
    v_exp_f32 v43, v43
    v_cvt_pk_bf16_f32 v64, v36, v37
    v_mfma_f32_32x32x16_bf16 v[68:83], v[92:95], v[60:63], v[68:83]
    v_exp_f32 v44, v44
    v_exp_f32 v45, v45
    v_cvt_pk_bf16_f32 v65, v38, v39
    v_exp_f32 v46, v46
    v_exp_f32 v47, v47
    v_cvt_pk_bf16_f32 v66, v40, v41
    v_exp_f32 v48, v48
    v_exp_f32 v49, v49
    v_cvt_pk_bf16_f32 v67, v42, v43
    s_waitcnt lgkmcnt(0)
    v_mfma_f32_32x32x16_bf16 v[28:43], v[84:87], v[8:11], v[12:27]
    v_exp_f32 v50, v50
    v_exp_f32 v51, v51
    v_cvt_pk_bf16_f32 v60, v44, v45
    v_exp_f32 v52, v52
    v_mfma_f32_32x32x16_bf16 v[68:83], v[96:99], v[64:67], v[68:83]
    ds_read_b128 v[92:95], v109 offset:2048
    ds_read_b128 v[96:99], v109 offset:2560
    ds_read_b128 v[88:91], v108 offset:3072
    v_exp_f32 v53, v53
    v_cvt_pk_bf16_f32 v61, v46, v47
    v_exp_f32 v54, v54
    v_exp_f32 v55, v55
    v_cvt_pk_bf16_f32 v62, v48, v49
    v_exp_f32 v56, v56
    v_exp_f32 v57, v57
    v_cvt_pk_bf16_f32 v63, v50, v51
    v_exp_f32 v58, v58
    v_exp_f32 v59, v59
    v_cvt_pk_bf16_f32 v64, v52, v53
    v_mfma_f32_32x32x16_bf16 v[68:83], v[100:103], v[60:63], v[68:83]
    s_setprio 2
    v_exp_f32 v28, v28
    v_exp_f32 v29, v29
    v_cvt_pk_bf16_f32 v65, v54, v55
    v_exp_f32 v30, v30
    v_exp_f32 v31, v31
    v_cvt_pk_bf16_f32 v66, v56, v57
    v_exp_f32 v32, v32
    v_exp_f32 v33, v33
    v_cvt_pk_bf16_f32 v67, v58, v59
    s_waitcnt lgkmcnt(0)
    v_mfma_f32_32x32x16_bf16 v[44:59], v[88:91], v[8:11], v[12:27]
    v_exp_f32 v34, v34
    v_exp_f32 v35, v35
    v_cvt_pk_bf16_f32 v60, v28, v29
    v_exp_f32 v36, v36
    v_mfma_f32_32x32x16_bf16 v[68:83], v[104:107], v[64:67], v[68:83]
    ds_read_b128 v[100:103], v109 offset:3072
    ds_read_b128 v[104:107], v109 offset:3584
    ds_read_b128 v[84:87], v108 offset:4096
    v_exp_f32 v37, v37
    v_cvt_pk_bf16_f32 v61, v30, v31
    v_exp_f32 v38, v38
    v_exp_f32 v39, v39
    v_cvt_pk_bf16_f32 v62, v32, v33
    v_exp_f32 v40, v40
    v_exp_f32 v41, v41
    v_cvt_pk_bf16_f32 v63, v34, v35
    v_exp_f32 v42, v42
    v_exp_f32 v43, v43
    v_cvt_pk_bf16_f32 v64, v36, v37
    v_mfma_f32_32x32x16_bf16 v[68:83], v[92:95], v[60:63], v[68:83]
    s_setprio 1
    v_exp_f32 v44, v44
    v_exp_f32 v45, v45
    v_cvt_pk_bf16_f32 v65, v38, v39
    v_exp_f32 v46, v46
    v_exp_f32 v47, v47
    v_cvt_pk_bf16_f32 v66, v40, v41
    v_exp_f32 v48, v48
    v_exp_f32 v49, v49
    v_cvt_pk_bf16_f32 v67, v42, v43
    s_waitcnt lgkmcnt(0)
    v_mfma_f32_32x32x16_bf16 v[28:43], v[84:87], v[8:11], v[12:27]
    v_exp_f32 v50, v50
    v_exp_f32 v51, v51
    v_cvt_pk_bf16_f32 v60, v44, v45
    v_exp_f32 v52, v52
    v_mfma_f32_32x32x16_bf16 v[68:83], v[96:99], v[64:67], v[68:83]
    ds_read_b128 v[92:95], v109 offset:4096
    ds_read_b128 v[96:99], v109 offset:4608
    ds_read_b128 v[88:91], v108 offset:5120
    v_exp_f32 v53, v53
    v_cvt_pk_bf16_f32 v61, v46, v47
    v_exp_f32 v54, v54
    v_exp_f32 v55, v55
    v_cvt_pk_bf16_f32 v62, v48, v49
    v_exp_f32 v56, v56
    v_exp_f32 v57, v57
    v_cvt_pk_bf16_f32 v63, v50, v51
    v_exp_f32 v58, v58
    v_exp_f32 v59, v59
    v_cvt_pk_bf16_f32 v64, v52, v53
    v_mfma_f32_32x32x16_bf16 v[68:83], v[100:103], v[60:63], v[68:83]
    s_setprio 0
    v_exp_f32 v28, v28
    v_exp_f32 v29, v29
    v_cvt_pk_bf16_f32 v65, v54, v55
    v_exp_f32 v30, v30
    v_exp_f32 v31, v31
    v_cvt_pk_bf16_f32 v66, v56, v57
    v_exp_f32 v32, v32
    v_exp_f32 v33, v33
    v_cvt_pk_bf16_f32 v67, v58, v59
    s_waitcnt lgkmcnt(0)
    v_mfma_f32_32x32x16_bf16 v[44:59], v[88:91], v[8:11], v[12:27]
    v_exp_f32 v34, v34
    v_exp_f32 v35, v35
    v_cvt_pk_bf16_f32 v60, v28, v29
    v_exp_f32 v36, v36
    v_mfma_f32_32x32x16_bf16 v[68:83], v[104:107], v[64:67], v[68:83]
    ds_read_b128 v[100:103], v109 offset:5120
    ds_read_b128 v[104:107], v109 offset:5632
    ds_read_b128 v[84:87], v108 offset:6144
    v_exp_f32 v37, v37
    v_cvt_pk_bf16_f32 v61, v30, v31
    v_exp_f32 v38, v38
    v_exp_f32 v39, v39
    v_cvt_pk_bf16_f32 v62, v32, v33
    v_exp_f32 v40, v40
    v_exp_f32 v41, v41
    v_cvt_pk_bf16_f32 v63, v34, v35
    v_exp_f32 v42, v42
    v_exp_f32 v43, v43
    v_cvt_pk_bf16_f32 v64, v36, v37
    v_mfma_f32_32x32x16_bf16 v[68:83], v[92:95], v[60:63], v[68:83]
    v_exp_f32 v44, v44
    v_exp_f32 v45, v45
    v_cvt_pk_bf16_f32 v65, v38, v39
    v_exp_f32 v46, v46
    v_exp_f32 v47, v47
    v_cvt_pk_bf16_f32 v66, v40, v41
    v_exp_f32 v48, v48
    v_exp_f32 v49, v49
    v_cvt_pk_bf16_f32 v67, v42, v43
    s_waitcnt lgkmcnt(0)
    v_mfma_f32_32x32x16_bf16 v[28:43], v[84:87], v[8:11], v[12:27]
    v_exp_f32 v50, v50
    v_exp_f32 v51, v51
    v_cvt_pk_bf16_f32 v60, v44, v45
    v_exp_f32 v52, v52
    v_mfma_f32_32x32x16_bf16 v[68:83], v[96:99], v[64:67], v[68:83]
    ds_read_b128 v[92:95], v109 offset:6144
    ds_read_b128 v[96:99], v109 offset:6656
    ds_read_b128 v[88:91], v108 offset:7168
    v_exp_f32 v53, v53
    v_cvt_pk_bf16_f32 v61, v46, v47
    v_exp_f32 v54, v54
    v_exp_f32 v55, v55
    v_cvt_pk_bf16_f32 v62, v48, v49
    v_exp_f32 v56, v56
    v_exp_f32 v57, v57
    v_cvt_pk_bf16_f32 v63, v50, v51
    v_exp_f32 v58, v58
    v_exp_f32 v59, v59
    v_cvt_pk_bf16_f32 v64, v52, v53
    v_mfma_f32_32x32x16_bf16 v[68:83], v[100:103], v[60:63], v[68:83]
    s_mov_b32 s47, 7
    s_mov_b32 s41, 49152
attn_loop_22:
    s_waitcnt vmcnt(2)
    s_barrier
    v_mov_b32 v110, v109
    v_add_u32 v108, 16384, v108
    v_add_u32 v109, v113, v109
    v_and_b32 v108, 0xffff, v108
    v_and_b32 v109, v114, v109
    s_setprio 2
    v_exp_f32 v28, v28
    v_exp_f32 v29, v29
    v_cvt_pk_bf16_f32 v65, v54, v55
    v_exp_f32 v30, v30
    v_exp_f32 v31, v31
    v_cvt_pk_bf16_f32 v66, v56, v57
    v_exp_f32 v32, v32
    v_exp_f32 v33, v33
    v_cvt_pk_bf16_f32 v67, v58, v59
    s_waitcnt lgkmcnt(0)
    v_mfma_f32_32x32x16_bf16 v[44:59], v[88:91], v[8:11], v[12:27]
    v_exp_f32 v34, v34
    v_exp_f32 v35, v35
    v_cvt_pk_bf16_f32 v60, v28, v29
    v_exp_f32 v36, v36
    v_mfma_f32_32x32x16_bf16 v[68:83], v[104:107], v[64:67], v[68:83]
    ds_read_b128 v[100:103], v110 offset:7168
    ds_read_b128 v[104:107], v110 offset:7680
    ds_read_b128 v[84:87], v108 offset:0
    v_exp_f32 v37, v37
    v_cvt_pk_bf16_f32 v61, v30, v31
    v_exp_f32 v38, v38
    v_exp_f32 v39, v39
    v_cvt_pk_bf16_f32 v62, v32, v33
    v_exp_f32 v40, v40
    v_exp_f32 v41, v41
    v_cvt_pk_bf16_f32 v63, v34, v35
    v_exp_f32 v42, v42
    v_exp_f32 v43, v43
    v_cvt_pk_bf16_f32 v64, v36, v37
    v_mfma_f32_32x32x16_bf16 v[68:83], v[92:95], v[60:63], v[68:83]
    s_setprio 1
    v_exp_f32 v44, v44
    v_exp_f32 v45, v45
    v_cvt_pk_bf16_f32 v65, v38, v39
    v_exp_f32 v46, v46
    v_exp_f32 v47, v47
    v_cvt_pk_bf16_f32 v66, v40, v41
    v_exp_f32 v48, v48
    v_exp_f32 v49, v49
    v_cvt_pk_bf16_f32 v67, v42, v43
    s_waitcnt lgkmcnt(0)
    v_mfma_f32_32x32x16_bf16 v[28:43], v[84:87], v[8:11], v[12:27]
    v_exp_f32 v50, v50
    v_exp_f32 v51, v51
    v_cvt_pk_bf16_f32 v60, v44, v45
    v_exp_f32 v52, v52
    v_mfma_f32_32x32x16_bf16 v[68:83], v[96:99], v[64:67], v[68:83]
    ds_read_b128 v[92:95], v109 offset:0
    ds_read_b128 v[96:99], v109 offset:512
    ds_read_b128 v[88:91], v108 offset:1024
    v_exp_f32 v53, v53
    v_cvt_pk_bf16_f32 v61, v46, v47
    v_exp_f32 v54, v54
    v_exp_f32 v55, v55
    v_cvt_pk_bf16_f32 v62, v48, v49
    s_cmp_lt_u32 s47, 3
    s_cselect_b32 s45, 0x7f000000, s45
    s_add_u32 m0, s46, s41
    s_add_u32 s42, s45, 2097152
    buffer_load_dwordx4 v111, s[32:35], s45 offen lds
    v_exp_f32 v56, v56
    v_exp_f32 v57, v57
    v_cvt_pk_bf16_f32 v63, v50, v51
    v_exp_f32 v58, v58
    v_exp_f32 v59, v59
    v_cvt_pk_bf16_f32 v64, v52, v53
    v_mfma_f32_32x32x16_bf16 v[68:83], v[100:103], v[60:63], v[68:83]
    s_setprio 0
    v_exp_f32 v28, v28
    v_exp_f32 v29, v29
    v_cvt_pk_bf16_f32 v65, v54, v55
    v_exp_f32 v30, v30
    v_exp_f32 v31, v31
    v_cvt_pk_bf16_f32 v66, v56, v57
    v_exp_f32 v32, v32
    v_exp_f32 v33, v33
    v_cvt_pk_bf16_f32 v67, v58, v59
    s_waitcnt lgkmcnt(0)
    v_mfma_f32_32x32x16_bf16 v[44:59], v[88:91], v[8:11], v[12:27]
    v_exp_f32 v34, v34
    v_exp_f32 v35, v35
    v_cvt_pk_bf16_f32 v60, v28, v29
    v_exp_f32 v36, v36
    v_mfma_f32_32x32x16_bf16 v[68:83], v[104:107], v[64:67], v[68:83]
    ds_read_b128 v[100:103], v109 offset:1024
    ds_read_b128 v[104:107], v109 offset:1536
    ds_read_b128 v[84:87], v108 offset:2048
    v_exp_f32 v37, v37
    v_cvt_pk_bf16_f32 v61, v30, v31
    v_exp_f32 v38, v38
    v_exp_f32 v39, v39
    v_cvt_pk_bf16_f32 v62, v32, v33
    v_exp_f32 v40, v40
    v_exp_f32 v41, v41
    v_cvt_pk_bf16_f32 v63, v34, v35
    v_exp_f32 v42, v42
    v_exp_f32 v43, v43
    v_cvt_pk_bf16_f32 v64, v36, v37
    v_mfma_f32_32x32x16_bf16 v[68:83], v[92:95], v[60:63], v[68:83]
    v_exp_f32 v44, v44
    v_exp_f32 v45, v45
    v_cvt_pk_bf16_f32 v65, v38, v39
    v_exp_f32 v46, v46
    v_exp_f32 v47, v47
    v_cvt_pk_bf16_f32 v66, v40, v41
    v_exp_f32 v48, v48
    v_exp_f32 v49, v49
    v_cvt_pk_bf16_f32 v67, v42, v43
    s_waitcnt lgkmcnt(0)
    v_mfma_f32_32x32x16_bf16 v[28:43], v[84:87], v[8:11], v[12:27]
    v_exp_f32 v50, v50
    v_exp_f32 v51, v51
    v_cvt_pk_bf16_f32 v60, v44, v45
    v_exp_f32 v52, v52
    v_mfma_f32_32x32x16_bf16 v[68:83], v[96:99], v[64:67], v[68:83]
    ds_read_b128 v[92:95], v109 offset:2048
    ds_read_b128 v[96:99], v109 offset:2560
    ds_read_b128 v[88:91], v108 offset:3072
    v_exp_f32 v53, v53
    v_cvt_pk_bf16_f32 v61, v46, v47
    v_exp_f32 v54, v54
    v_exp_f32 v55, v55
    v_cvt_pk_bf16_f32 v62, v48, v49
    s_add_u32 m0, m0, 8192
    s_add_u32 s45, s45, 8192
    buffer_load_dwordx4 v111, s[32:35], s42 offen lds
    s_add_u32 s41, s41, 16384
    s_and_b32 s41, s41, 0xffff
    v_exp_f32 v56, v56
    v_exp_f32 v57, v57
    v_cvt_pk_bf16_f32 v63, v50, v51
    v_exp_f32 v58, v58
    v_exp_f32 v59, v59
    v_cvt_pk_bf16_f32 v64, v52, v53
    v_mfma_f32_32x32x16_bf16 v[68:83], v[100:103], v[60:63], v[68:83]
    s_setprio 2
    v_exp_f32 v28, v28
    v_exp_f32 v29, v29
    v_cvt_pk_bf16_f32 v65, v54, v55
    v_exp_f32 v30, v30
    v_exp_f32 v31, v31
    v_cvt_pk_bf16_f32 v66, v56, v57
    v_exp_f32 v32, v32
    v_exp_f32 v33, v33
    v_cvt_pk_bf16_f32 v67, v58, v59
    s_waitcnt lgkmcnt(0)
    v_mfma_f32_32x32x16_bf16 v[44:59], v[88:91], v[8:11], v[12:27]
    v_exp_f32 v34, v34
    v_exp_f32 v35, v35
    v_cvt_pk_bf16_f32 v60, v28, v29
    v_exp_f32 v36, v36
    v_mfma_f32_32x32x16_bf16 v[68:83], v[104:107], v[64:67], v[68:83]
    ds_read_b128 v[100:103], v109 offset:3072
    ds_read_b128 v[104:107], v109 offset:3584
    ds_read_b128 v[84:87], v108 offset:4096
    v_exp_f32 v37, v37
    v_cvt_pk_bf16_f32 v61, v30, v31
    v_exp_f32 v38, v38
    v_exp_f32 v39, v39
    v_cvt_pk_bf16_f32 v62, v32, v33
    v_exp_f32 v40, v40
    v_exp_f32 v41, v41
    v_cvt_pk_bf16_f32 v63, v34, v35
    v_exp_f32 v42, v42
    v_exp_f32 v43, v43
    v_cvt_pk_bf16_f32 v64, v36, v37
    v_mfma_f32_32x32x16_bf16 v[68:83], v[92:95], v[60:63], v[68:83]
    s_setprio 1
    v_exp_f32 v44, v44
    v_exp_f32 v45, v45
    v_cvt_pk_bf16_f32 v65, v38, v39
    v_exp_f32 v46, v46
    v_exp_f32 v47, v47
    v_cvt_pk_bf16_f32 v66, v40, v41
    v_exp_f32 v48, v48
    v_exp_f32 v49, v49
    v_cvt_pk_bf16_f32 v67, v42, v43
    s_waitcnt lgkmcnt(0)
    v_mfma_f32_32x32x16_bf16 v[28:43], v[84:87], v[8:11], v[12:27]
    v_exp_f32 v50, v50
    v_exp_f32 v51, v51
    v_cvt_pk_bf16_f32 v60, v44, v45
    v_exp_f32 v52, v52
    v_mfma_f32_32x32x16_bf16 v[68:83], v[96:99], v[64:67], v[68:83]
    ds_read_b128 v[92:95], v109 offset:4096
    ds_read_b128 v[96:99], v109 offset:4608
    ds_read_b128 v[88:91], v108 offset:5120
    v_exp_f32 v53, v53
    v_cvt_pk_bf16_f32 v61, v46, v47
    v_exp_f32 v54, v54
    v_exp_f32 v55, v55
    v_cvt_pk_bf16_f32 v62, v48, v49
    v_exp_f32 v56, v56
    v_exp_f32 v57, v57
    v_cvt_pk_bf16_f32 v63, v50, v51
    v_exp_f32 v58, v58
    v_exp_f32 v59, v59
    v_cvt_pk_bf16_f32 v64, v52, v53
    v_mfma_f32_32x32x16_bf16 v[68:83], v[100:103], v[60:63], v[68:83]
    s_setprio 0
    v_exp_f32 v28, v28
    v_exp_f32 v29, v29
    v_cvt_pk_bf16_f32 v65, v54, v55
    v_exp_f32 v30, v30
    v_exp_f32 v31, v31
    v_cvt_pk_bf16_f32 v66, v56, v57
    v_exp_f32 v32, v32
    v_exp_f32 v33, v33
    v_cvt_pk_bf16_f32 v67, v58, v59
    s_waitcnt lgkmcnt(0)
    v_mfma_f32_32x32x16_bf16 v[44:59], v[88:91], v[8:11], v[12:27]
    v_exp_f32 v34, v34
    v_exp_f32 v35, v35
    v_cvt_pk_bf16_f32 v60, v28, v29
    v_exp_f32 v36, v36
    v_mfma_f32_32x32x16_bf16 v[68:83], v[104:107], v[64:67], v[68:83]
    ds_read_b128 v[100:103], v109 offset:5120
    ds_read_b128 v[104:107], v109 offset:5632
    ds_read_b128 v[84:87], v108 offset:6144
    v_exp_f32 v37, v37
    v_cvt_pk_bf16_f32 v61, v30, v31
    v_exp_f32 v38, v38
    v_exp_f32 v39, v39
    v_cvt_pk_bf16_f32 v62, v32, v33
    v_exp_f32 v40, v40
    v_exp_f32 v41, v41
    v_cvt_pk_bf16_f32 v63, v34, v35
    v_exp_f32 v42, v42
    v_exp_f32 v43, v43
    v_cvt_pk_bf16_f32 v64, v36, v37
    v_mfma_f32_32x32x16_bf16 v[68:83], v[92:95], v[60:63], v[68:83]
    v_exp_f32 v44, v44
    v_exp_f32 v45, v45
    v_cvt_pk_bf16_f32 v65, v38, v39
    v_exp_f32 v46, v46
    v_exp_f32 v47, v47
    v_cvt_pk_bf16_f32 v66, v40, v41
    v_exp_f32 v48, v48
    v_exp_f32 v49, v49
    v_cvt_pk_bf16_f32 v67, v42, v43
    s_waitcnt lgkmcnt(0)
    v_mfma_f32_32x32x16_bf16 v[28:43], v[84:87], v[8:11], v[12:27]
    v_exp_f32 v50, v50
    v_exp_f32 v51, v51
    v_cvt_pk_bf16_f32 v60, v44, v45
    v_exp_f32 v52, v52
    v_mfma_f32_32x32x16_bf16 v[68:83], v[96:99], v[64:67], v[68:83]
    ds_read_b128 v[92:95], v109 offset:6144
    ds_read_b128 v[96:99], v109 offset:6656
    ds_read_b128 v[88:91], v108 offset:7168
    v_exp_f32 v53, v53
    v_cvt_pk_bf16_f32 v61, v46, v47
    v_exp_f32 v54, v54
    v_exp_f32 v55, v55
    v_cvt_pk_bf16_f32 v62, v48, v49
    v_exp_f32 v56, v56
    v_exp_f32 v57, v57
    v_cvt_pk_bf16_f32 v63, v50, v51
    v_exp_f32 v58, v58
    v_exp_f32 v59, v59
    v_cvt_pk_bf16_f32 v64, v52, v53
    v_mfma_f32_32x32x16_bf16 v[68:83], v[100:103], v[60:63], v[68:83]
    s_sub_u32 s47, s47, 1
    s_cmp_lg_u32 s47, 0
    s_cbranch_scc1 attn_loop_22
    s_setprio 2
    v_exp_f32 v28, v28
    v_exp_f32 v29, v29
    v_cvt_pk_bf16_f32 v65, v54, v55
    v_exp_f32 v30, v30
    v_exp_f32 v31, v31
    v_cvt_pk_bf16_f32 v66, v56, v57
    v_exp_f32 v32, v32
    v_exp_f32 v33, v33
    v_cvt_pk_bf16_f32 v67, v58, v59
    s_waitcnt lgkmcnt(0)
    v_mfma_f32_32x32x16_bf16 v[44:59], v[88:91], v[8:11], v[12:27]
    v_exp_f32 v34, v34
    v_exp_f32 v35, v35
    v_cvt_pk_bf16_f32 v60, v28, v29
    v_exp_f32 v36, v36
    v_mfma_f32_32x32x16_bf16 v[68:83], v[104:107], v[64:67], v[68:83]
    ds_read_b128 v[100:103], v109 offset:7168
    ds_read_b128 v[104:107], v109 offset:7680
    v_exp_f32 v37, v37
    v_cvt_pk_bf16_f32 v61, v30, v31
    v_exp_f32 v38, v38
    v_exp_f32 v39, v39
    v_cvt_pk_bf16_f32 v62, v32, v33
    v_exp_f32 v40, v40
    v_exp_f32 v41, v41
    v_cvt_pk_bf16_f32 v63, v34, v35
    v_exp_f32 v42, v42
    v_exp_f32 v43, v43
    v_cvt_pk_bf16_f32 v64, v36, v37
    v_mfma_f32_32x32x16_bf16 v[68:83], v[92:95], v[60:63], v[68:83]
    s_setprio 1
    v_exp_f32 v44, v44
    v_exp_f32 v45, v45
    v_cvt_pk_bf16_f32 v65, v38, v39
    v_exp_f32 v46, v46
    v_exp_f32 v47, v47
    v_cvt_pk_bf16_f32 v66, v40, v41
    v_exp_f32 v48, v48
    v_exp_f32 v49, v49
    v_cvt_pk_bf16_f32 v67, v42, v43
    s_waitcnt lgkmcnt(0)
    v_exp_f32 v50, v50
    v_exp_f32 v51, v51
    v_cvt_pk_bf16_f32 v60, v44, v45
    v_exp_f32 v52, v52
    v_mfma_f32_32x32x16_bf16 v[68:83], v[96:99], v[64:67], v[68:83]
    v_exp_f32 v53, v53
    v_cvt_pk_bf16_f32 v61, v46, v47
    v_exp_f32 v54, v54
    v_exp_f32 v55, v55
    v_cvt_pk_bf16_f32 v62, v48, v49
    v_exp_f32 v56, v56
    v_exp_f32 v57, v57
    v_cvt_pk_bf16_f32 v63, v50, v51
    v_exp_f32 v58, v58
    v_exp_f32 v59, v59
    v_cvt_pk_bf16_f32 v64, v52, v53
    v_mfma_f32_32x32x16_bf16 v[68:83], v[100:103], v[60:63], v[68:83]
    s_nop 0
    v_cvt_pk_bf16_f32 v65, v54, v55
    v_cvt_pk_bf16_f32 v66, v56, v57
    v_cvt_pk_bf16_f32 v67, v58, v59
    s_nop 1
    v_mfma_f32_32x32x16_bf16 v[68:83], v[104:107], v[64:67], v[68:83]
    s_setprio 0
    s_nop 15
    v_mov_b32 v3, 0x5d800000
    v_cmp_nlt_f32 vcc, v76, v3
    s_nop 1
    s_cmp_eq_u64 vcc, 0
    s_cbranch_scc1 attn_ok_23
    s_lshl_b32 s37, s43, 16
    s_add_u32 s37, s37, 2097152
    s_mov_b32 s47, 64
    v_mov_b32 v2, 0xff800000
attn_fbmax_24:
    buffer_load_dwordx4 v[84:87], v111, s[32:35], s37 offen
    s_add_u32 s37, s37, 1024
    s_waitcnt vmcnt(0)
    v_mfma_f32_32x32x16_bf16 v[28:43], v[84:87], v[8:11], 0
    s_nop 15
    v_max3_f32 v4, v28, v29, v30
    v_max3_f32 v4, v4, v31, v32
    v_max3_f32 v4, v4, v33, v34
    v_max3_f32 v4, v4, v35, v36
    v_max3_f32 v4, v4, v37, v38
    v_max3_f32 v4, v4, v39, v40
    v_max3_f32 v4, v4, v41, v42
    v_max_f32 v4, v4, v43
    v_max_f32 v2, v2, v4
    s_sub_u32 s47, s47, 1
    s_cmp_lg_u32 s47, 0
    s_cbranch_scc1 attn_fbmax_24
    v_mov_b32 v3, v2
    s_nop 1
    v_permlane32_swap_b32 v3, v2
    v_max_f32 v2, v2, v3
    v_sub_f32 v12, 0, v2
    v_sub_f32 v13, 0, v2
    v_sub_f32 v14, 0, v2
    v_sub_f32 v15, 0, v2
    v_sub_f32 v16, 0, v2
    v_sub_f32 v17, 0, v2
    v_sub_f32 v18, 0, v2
    v_sub_f32 v19, 0, v2
    v_sub_f32 v20, 0, v2
    v_sub_f32 v21, 0, v2
    v_sub_f32 v22, 0, v2
    v_sub_f32 v23, 0, v2
    v_sub_f32 v24, 0, v2
    v_sub_f32 v25, 0, v2
    v_sub_f32 v26, 0, v2
    v_sub_f32 v27, 0, v2
    v_mov_b32 v68, 0
    v_mov_b32 v69, 0
    v_mov_b32 v70, 0
    v_mov_b32 v71, 0
    v_mov_b32 v72, 0
    v_mov_b32 v73, 0
    v_mov_b32 v74, 0
    v_mov_b32 v75, 0
    v_mov_b32 v76, 0
    v_mov_b32 v77, 0
    v_mov_b32 v78, 0
    v_mov_b32 v79, 0
    v_mov_b32 v80, 0
    v_mov_b32 v81, 0
    v_mov_b32 v82, 0
    v_mov_b32 v83, 0
    s_lshl_b32 s37, s43, 16
    s_add_u32 s37, s37, 2097152
    s_mov_b32 s47, 64
attn_fb_25:
    s_add_u32 s38, s37, 2097152
    buffer_load_dwordx4 v[84:87], v111, s[32:35], s37 offen
    s_mov_b64 exec, s[48:49]
    buffer_load_dwordx4 v[92:95], v112, s[32:35], s38 offen
    buffer_load_dwordx4 v[96:99], v112, s[32:35], s38 offen offset:512
    s_mov_b64 exec, -1
    s_add_u32 s37, s37, 1024
    s_waitcnt vmcnt(0)
    v_mfma_f32_32x32x16_bf16 v[28:43], v[84:87], v[8:11], v[12:27]
    s_nop 15
    v_exp_f32 v28, v28
    v_exp_f32 v29, v29
    v_exp_f32 v30, v30
    v_cvt_pk_bf16_f32 v60, v28, v29
    v_exp_f32 v31, v31
    v_exp_f32 v32, v32
    v_cvt_pk_bf16_f32 v61, v30, v31
    v_exp_f32 v33, v33
    v_exp_f32 v34, v34
    v_cvt_pk_bf16_f32 v62, v32, v33
    v_exp_f32 v35, v35
    v_exp_f32 v36, v36
    v_cvt_pk_bf16_f32 v63, v34, v35
    v_exp_f32 v37, v37
    v_exp_f32 v38, v38
    v_mfma_f32_32x32x16_bf16 v[68:83], v[92:95], v[60:63], v[68:83]
    v_cvt_pk_bf16_f32 v64, v36, v37
    v_exp_f32 v39, v39
    v_exp_f32 v40, v40
    v_cvt_pk_bf16_f32 v65, v38, v39
    v_exp_f32 v41, v41
    v_exp_f32 v42, v42
    v_cvt_pk_bf16_f32 v66, v40, v41
    v_exp_f32 v43, v43
    s_nop 0
    v_cvt_pk_bf16_f32 v67, v42, v43
    s_nop 1
    v_mfma_f32_32x32x16_bf16 v[68:83], v[96:99], v[64:67], v[68:83]
    s_nop 7
    s_sub_u32 s47, s47, 1
    s_cmp_lg_u32 s47, 0
    s_cbranch_scc1 attn_fb_25
    s_nop 15
attn_ok_23:
    v_rcp_f32 v2, v76
    s_lshl_b32 s37, s44, 5
    s_add_u32 s37, s37, s43
    s_lshl_b32 s37, s37, 10
    s_add_u32 s37, s37, 10485760
    v_mul_f32 v68, v68, v2
    v_mul_f32 v69, v69, v2
    v_mul_f32 v70, v70, v2
    v_mul_f32 v71, v71, v2
    v_mul_f32 v72, v72, v2
    v_mul_f32 v73, v73, v2
    v_mul_f32 v74, v74, v2
    v_mul_f32 v75, v75, v2
    v_cvt_pk_bf16_f32 v60, v68, v69
    v_cvt_pk_bf16_f32 v61, v70, v71
    v_cvt_pk_bf16_f32 v62, v72, v73
    v_cvt_pk_bf16_f32 v63, v74, v75
    buffer_store_dwordx4 v[60:63], v111, s[32:35], s37 offen sc1
    s_lshr_b32 s37, s44, 3
    s_lshl_b32 s37, s37, 5
    s_add_u32 s37, s37, s43
    s_lshl_b32 s37, s37, 2
    s_add_u32 s37, s37, 25174016
    s_waitcnt vmcnt(0)
    s_barrier
    s_cmp_lg_u32 s36, 0
    s_cbranch_scc1 pub_26
    v_mov_b32 v2, 1
    v_mov_b32 v3, 0
    s_mov_b64 exec, 1
    buffer_store_dword v2, v3, s[32:35], s37 offen sc1
    s_mov_b64 exec, -1
pub_26:
    s_branch k2_kernel_end_20
k2_b_21:
    s_setprio 3
    s_sub_u32 s37, s2, 256
    s_and_b32 s39, s36, 3
    v_lshlrev_b32 v10, 4, v1
    v_bfe_u32 v2, v1, 4, 1
    v_lshlrev_b32 v2, 2, v2
    v_and_b32 v3, 7, v1
    v_xor_b32 v2, v2, v3
    v_lshrrev_b32 v3, 3, v1
    v_lshlrev_b32 v3, 10, v3
    v_lshl_add_u32 v13, v2, 4, v3
    v_add_u32 v14, 7168, v13
    s_lshl_b32 s53, s39, 11
    s_lshr_b32 s46, s39, 1
    s_and_b32 s47, s39, 1
    s_and_b32 s40, s37, 7
    s_lshr_b32 s41, s37, 3
    s_and_b32 s50, s41, 3
    s_lshl_b32 s48, s40, 2
    s_add_u32 s48, s48, s50
    s_lshr_b32 s49, s41, 2
    s_lshl_b32 s51, s48, 1
    s_add_u32 s51, s51, s47
    s_lshl_b32 s52, s49, 2
    s_lshl_b32 s40, s46, 1
    s_add_u32 s52, s52, s40
    v_lshrrev_b32 v11, 5, v1
    v_and_b32 v12, 31, v1
    s_lshr_b32 s63, s37, 3
    s_sub_u32 s41, s63, 4
    s_add_u32 s42, s63, 16
    s_cmp_ge_u32 s63, 16
    s_cselect_b32 s42, s41, s42
    s_cmp_ge_u32 s63, 12
    s_cselect_b32 s63, s42, s63
    s_and_b32 s40, s37, 7
    s_lshl_b32 s61, s40, 1
    s_and_b32 s42, s63, 1
    s_add_u32 s61, s61, s42
    s_lshr_b32 s62, s63, 1
    s_cmp_ge_u32 s36, 4
    s_cbranch_scc1 k2_prod_27
    s_lshl_b32 s40, s47, 12
    v_add_u32 v17, s40, v10
    v_add_u32 v18, 0x10000, v17
    v_bfe_u32 v16, v1, 2, 2
    v_and_b32 v2, 3, v1
    v_lshlrev_b32 v2, 3, v2
    v_bfe_u32 v3, v1, 4, 1
    v_lshl_add_u32 v15, v3, 5, v2
    v_lshl_add_u32 v3, v11, 2, v16
    v_lshl_add_u32 v4, v3, 7, v15
    v_lshrrev_b32 v2, 1, v16
    v_xor_b32 v2, s46, v2
    v_lshl_add_u32 v19, v2, 6, v4
    v_add_u32 v20, 0x10000, v19
    s_lshl_b32 s44, s52, 5
    s_lshl_b32 s45, s51, 15
    s_add_u32 s45, s45, s44
    v_lshlrev_b32 v8, 3, v11
    v_lshl_add_u32 v9, v12, 10, v8
    buffer_load_dwordx2 v[72:73], v9, s[4:7], s45 offen offset:0
    buffer_load_dwordx2 v[74:75], v9, s[4:7], s45 offen offset:16
    buffer_load_dwordx2 v[76:77], v9, s[4:7], s45 offen offset:32
    buffer_load_dwordx2 v[78:79], v9, s[4:7], s45 offen offset:48
    buffer_load_dwordx2 v[80:81], v8, s[24:27], s44 offen offset:0
    buffer_load_dwordx2 v[82:83], v8, s[24:27], s44 offen offset:16
    buffer_load_dwordx2 v[84:85], v8, s[24:27], s44 offen offset:32
    buffer_load_dwordx2 v[86:87], v8, s[24:27], s44 offen offset:48
    s_waitcnt vmcnt(0)
    v_lshlrev_b32 v40, 16, v72
    v_and_b32 v41, 0xffff0000, v72
    v_lshlrev_b32 v42, 16, v73
    v_and_b32 v43, 0xffff0000, v73
    v_lshlrev_b32 v44, 16, v74
    v_and_b32 v45, 0xffff0000, v74
    v_lshlrev_b32 v46, 16, v75
    v_and_b32 v47, 0xffff0000, v75
    v_lshlrev_b32 v48, 16, v76
    v_and_b32 v49, 0xffff0000, v76
    v_lshlrev_b32 v50, 16, v77
    v_and_b32 v51, 0xffff0000, v77
    v_lshlrev_b32 v52, 16, v78
    v_and_b32 v53, 0xffff0000, v78
    v_lshlrev_b32 v54, 16, v79
    v_and_b32 v55, 0xffff0000, v79
    v_lshlrev_b32 v56, 16, v80
    v_and_b32 v57, 0xffff0000, v80
    v_lshlrev_b32 v58, 16, v81
    v_and_b32 v59, 0xffff0000, v81
    v_lshlrev_b32 v60, 16, v82
    v_and_b32 v61, 0xffff0000, v82
    v_lshlrev_b32 v62, 16, v83
    v_and_b32 v63, 0xffff0000, v83
    v_lshlrev_b32 v64, 16, v84
    v_and_b32 v65, 0xffff0000, v84
    v_lshlrev_b32 v66, 16, v85
    v_and_b32 v67, 0xffff0000, v85
    v_lshlrev_b32 v68, 16, v86
    v_and_b32 v69, 0xffff0000, v86
    v_lshlrev_b32 v70, 16, v87
    v_and_b32 v71, 0xffff0000, v87
    v_pk_mul_f32 v[124:125], v[40:41], v[56:57]
    v_pk_fma_f32 v[124:125], v[42:43], v[58:59], v[124:125]
    v_pk_fma_f32 v[124:125], v[44:45], v[60:61], v[124:125]
    v_pk_fma_f32 v[124:125], v[46:47], v[62:63], v[124:125]
    v_pk_fma_f32 v[124:125], v[48:49], v[64:65], v[124:125]
    v_pk_fma_f32 v[124:125], v[50:51], v[66:67], v[124:125]
    v_pk_fma_f32 v[124:125], v[52:53], v[68:69], v[124:125]
    v_pk_fma_f32 v[124:125], v[54:55], v[70:71], v[124:125]
    s_lshl_b32 s40, s51, 5
    s_add_u32 s40, s40, s52
    s_lshl_b32 s40, s40, 10
    s_add_u32 s40, s40, 8388608
    s_lshl_b32 s41, s51, 13
    s_lshl_b32 s42, s52, 3
    s_add_u32 s41, s41, s42
    s_add_u32 s41, s41, 24117248
    s_barrier
    ds_read_b128 v[88:91], v17 offset:0
    ds_read_b64_tr_b16 v[104:105], v19 offset:8192
    ds_read_b64_tr_b16 v[106:107], v19 offset:9216
    ds_read_b128 v[92:95], v17 offset:1024
    ds_read_b64_tr_b16 v[108:109], v19 offset:10240
    ds_read_b64_tr_b16 v[110:111], v19 offset:11264
    ds_read_b128 v[96:99], v17 offset:2048
    ds_read_b64_tr_b16 v[112:113], v19 offset:12288
    ds_read_b64_tr_b16 v[114:115], v19 offset:13312
    ds_read_b128 v[100:103], v17 offset:3072
    ds_read_b64_tr_b16 v[116:117], v19 offset:14336
    ds_read_b64_tr_b16 v[118:119], v19 offset:15360
    s_waitcnt lgkmcnt(9)
    v_mfma_f32_32x32x16_bf16 v[24:39], v[104:107], v[88:91], 0
    s_barrier
    ds_read_b128 v[88:91], v17 offset:16384
    ds_read_b64_tr_b16 v[104:105], v19 offset:24576
    ds_read_b64_tr_b16 v[106:107], v19 offset:25600
    s_waitcnt lgkmcnt(9)
    v_mfma_f32_32x32x16_bf16 v[24:39], v[108:111], v[92:95], v[24:39]
    ds_read_b128 v[92:95], v17 offset:17408
    ds_read_b64_tr_b16 v[108:109], v19 offset:26624
    ds_read_b64_tr_b16 v[110:111], v19 offset:27648
    s_waitcnt lgkmcnt(9)
    v_mfma_f32_32x32x16_bf16 v[24:39], v[112:115], v[96:99], v[24:39]
    ds_read_b128 v[96:99], v17 offset:18432
    ds_read_b64_tr_b16 v[112:113], v19 offset:28672
    ds_read_b64_tr_b16 v[114:115], v19 offset:29696
    s_waitcnt lgkmcnt(9)
    v_mfma_f32_32x32x16_bf16 v[24:39], v[116:119], v[100:103], v[24:39]
    ds_read_b128 v[100:103], v17 offset:19456
    ds_read_b64_tr_b16 v[116:117], v19 offset:30720
    ds_read_b64_tr_b16 v[118:119], v19 offset:31744
    s_waitcnt lgkmcnt(9)
    v_mfma_f32_32x32x16_bf16 v[24:39], v[104:107], v[88:91], v[24:39]
    s_barrier
    ds_read_b128 v[88:91], v17 offset:32768
    ds_read_b64_tr_b16 v[104:105], v19 offset:40960
    ds_read_b64_tr_b16 v[106:107], v19 offset:41984
    s_waitcnt lgkmcnt(9)
    v_mfma_f32_32x32x16_bf16 v[24:39], v[108:111], v[92:95], v[24:39]
    ds_read_b128 v[92:95], v17 offset:33792
    ds_read_b64_tr_b16 v[108:109], v19 offset:43008
    ds_read_b64_tr_b16 v[110:111], v19 offset:44032
    s_waitcnt lgkmcnt(9)
    v_mfma_f32_32x32x16_bf16 v[24:39], v[112:115], v[96:99], v[24:39]
    ds_read_b128 v[96:99], v17 offset:34816
    ds_read_b64_tr_b16 v[112:113], v19 offset:45056
    ds_read_b64_tr_b16 v[114:115], v19 offset:46080
    s_waitcnt lgkmcnt(9)
    v_mfma_f32_32x32x16_bf16 v[24:39], v[116:119], v[100:103], v[24:39]
    ds_read_b128 v[100:103], v17 offset:35840
    ds_read_b64_tr_b16 v[116:117], v19 offset:47104
    ds_read_b64_tr_b16 v[118:119], v19 offset:48128
    s_waitcnt lgkmcnt(9)
    v_mfma_f32_32x32x16_bf16 v[24:39], v[104:107], v[88:91], v[24:39]
    s_barrier
    ds_read_b128 v[88:91], v17 offset:49152
    ds_read_b64_tr_b16 v[104:105], v19 offset:57344
    ds_read_b64_tr_b16 v[106:107], v19 offset:58368
    s_waitcnt lgkmcnt(9)
    v_mfma_f32_32x32x16_bf16 v[24:39], v[108:111], v[92:95], v[24:39]
    ds_read_b128 v[92:95], v17 offset:50176
    ds_read_b64_tr_b16 v[108:109], v19 offset:59392
    ds_read_b64_tr_b16 v[110:111], v19 offset:60416
    s_waitcnt lgkmcnt(9)
    v_mfma_f32_32x32x16_bf16 v[24:39], v[112:115], v[96:99], v[24:39]
    ds_read_b128 v[96:99], v17 offset:51200
    ds_read_b64_tr_b16 v[112:113], v19 offset:61440
    ds_read_b64_tr_b16 v[114:115], v19 offset:62464
    s_waitcnt lgkmcnt(9)
    v_mfma_f32_32x32x16_bf16 v[24:39], v[116:119], v[100:103], v[24:39]
    ds_read_b128 v[100:103], v17 offset:52224
    ds_read_b64_tr_b16 v[116:117], v19 offset:63488
    ds_read_b64_tr_b16 v[118:119], v19 offset:64512
    s_waitcnt lgkmcnt(9)
    v_mfma_f32_32x32x16_bf16 v[24:39], v[104:107], v[88:91], v[24:39]
    s_barrier
    ds_read_b128 v[88:91], v18 offset:0
    ds_read_b64_tr_b16 v[104:105], v20 offset:8192
    ds_read_b64_tr_b16 v[106:107], v20 offset:9216
    s_waitcnt lgkmcnt(9)
    v_mfma_f32_32x32x16_bf16 v[24:39], v[108:111], v[92:95], v[24:39]
    ds_read_b128 v[92:95], v18 offset:1024
    ds_read_b64_tr_b16 v[108:109], v20 offset:10240
    ds_read_b64_tr_b16 v[110:111], v20 offset:11264
    s_waitcnt lgkmcnt(9)
    v_mfma_f32_32x32x16_bf16 v[24:39], v[112:115], v[96:99], v[24:39]
    ds_read_b128 v[96:99], v18 offset:2048
    ds_read_b64_tr_b16 v[112:113], v20 offset:12288
    ds_read_b64_tr_b16 v[114:115], v20 offset:13312
    s_waitcnt lgkmcnt(9)
    v_mfma_f32_32x32x16_bf16 v[24:39], v[116:119], v[100:103], v[24:39]
    ds_read_b128 v[100:103], v18 offset:3072
    ds_read_b64_tr_b16 v[116:117], v20 offset:14336
    ds_read_b64_tr_b16 v[118:119], v20 offset:15360
    s_waitcnt lgkmcnt(9)
    v_mfma_f32_32x32x16_bf16 v[24:39], v[104:107], v[88:91], v[24:39]
    s_barrier
    ds_read_b128 v[88:91], v17 offset:0
    ds_read_b64_tr_b16 v[104:105], v19 offset:8192
    ds_read_b64_tr_b16 v[106:107], v19 offset:9216
    s_waitcnt lgkmcnt(9)
    v_mfma_f32_32x32x16_bf16 v[24:39], v[108:111], v[92:95], v[24:39]
    ds_read_b128 v[92:95], v17 offset:1024
    ds_read_b64_tr_b16 v[108:109], v19 offset:10240
    ds_read_b64_tr_b16 v[110:111], v19 offset:11264
    s_waitcnt lgkmcnt(9)
    v_mfma_f32_32x32x16_bf16 v[24:39], v[112:115], v[96:99], v[24:39]
    ds_read_b128 v[96:99], v17 offset:2048
    ds_read_b64_tr_b16 v[112:113], v19 offset:12288
    ds_read_b64_tr_b16 v[114:115], v19 offset:13312
    s_waitcnt lgkmcnt(9)
    v_mfma_f32_32x32x16_bf16 v[24:39], v[116:119], v[100:103], v[24:39]
    ds_read_b128 v[100:103], v17 offset:3072
    ds_read_b64_tr_b16 v[116:117], v19 offset:14336
    ds_read_b64_tr_b16 v[118:119], v19 offset:15360
    s_waitcnt lgkmcnt(9)
    v_mfma_f32_32x32x16_bf16 v[24:39], v[104:107], v[88:91], v[24:39]
    s_barrier
    ds_read_b128 v[88:91], v17 offset:16384
    ds_read_b64_tr_b16 v[104:105], v19 offset:24576
    ds_read_b64_tr_b16 v[106:107], v19 offset:25600
    s_waitcnt lgkmcnt(9)
    v_mfma_f32_32x32x16_bf16 v[24:39], v[108:111], v[92:95], v[24:39]
    ds_read_b128 v[92:95], v17 offset:17408
    ds_read_b64_tr_b16 v[108:109], v19 offset:26624
    ds_read_b64_tr_b16 v[110:111], v19 offset:27648
    s_waitcnt lgkmcnt(9)
    v_mfma_f32_32x32x16_bf16 v[24:39], v[112:115], v[96:99], v[24:39]
    ds_read_b128 v[96:99], v17 offset:18432
    ds_read_b64_tr_b16 v[112:113], v19 offset:28672
    ds_read_b64_tr_b16 v[114:115], v19 offset:29696
    s_waitcnt lgkmcnt(9)
    v_mfma_f32_32x32x16_bf16 v[24:39], v[116:119], v[100:103], v[24:39]
    ds_read_b128 v[100:103], v17 offset:19456
    ds_read_b64_tr_b16 v[116:117], v19 offset:30720
    ds_read_b64_tr_b16 v[118:119], v19 offset:31744
    s_waitcnt lgkmcnt(9)
    v_mfma_f32_32x32x16_bf16 v[24:39], v[104:107], v[88:91], v[24:39]
    s_barrier
    ds_read_b128 v[88:91], v17 offset:32768
    ds_read_b64_tr_b16 v[104:105], v19 offset:40960
    ds_read_b64_tr_b16 v[106:107], v19 offset:41984
    s_waitcnt lgkmcnt(9)
    v_mfma_f32_32x32x16_bf16 v[24:39], v[108:111], v[92:95], v[24:39]
    ds_read_b128 v[92:95], v17 offset:33792
    ds_read_b64_tr_b16 v[108:109], v19 offset:43008
    ds_read_b64_tr_b16 v[110:111], v19 offset:44032
    s_waitcnt lgkmcnt(9)
    v_mfma_f32_32x32x16_bf16 v[24:39], v[112:115], v[96:99], v[24:39]
    ds_read_b128 v[96:99], v17 offset:34816
    ds_read_b64_tr_b16 v[112:113], v19 offset:45056
    ds_read_b64_tr_b16 v[114:115], v19 offset:46080
    s_waitcnt lgkmcnt(9)
    v_mfma_f32_32x32x16_bf16 v[24:39], v[116:119], v[100:103], v[24:39]
    ds_read_b128 v[100:103], v17 offset:35840
    ds_read_b64_tr_b16 v[116:117], v19 offset:47104
    ds_read_b64_tr_b16 v[118:119], v19 offset:48128
    s_waitcnt lgkmcnt(9)
    v_mfma_f32_32x32x16_bf16 v[24:39], v[104:107], v[88:91], v[24:39]
    s_waitcnt lgkmcnt(6)
    v_mfma_f32_32x32x16_bf16 v[24:39], v[108:111], v[92:95], v[24:39]
    s_waitcnt lgkmcnt(3)
    v_mfma_f32_32x32x16_bf16 v[24:39], v[112:115], v[96:99], v[24:39]
    s_waitcnt lgkmcnt(0)
    v_mfma_f32_32x32x16_bf16 v[24:39], v[116:119], v[100:103], v[24:39]
    s_nop 7
    s_nop 3
    v_pk_add_f32 v[24:25], v[24:25], v[40:41]
    v_pk_add_f32 v[26:27], v[26:27], v[42:43]
    v_pk_add_f32 v[28:29], v[28:29], v[44:45]
    v_pk_add_f32 v[30:31], v[30:31], v[46:47]
    v_pk_add_f32 v[32:33], v[32:33], v[48:49]
    v_pk_add_f32 v[34:35], v[34:35], v[50:51]
    v_pk_add_f32 v[36:37], v[36:37], v[52:53]
    v_pk_add_f32 v[38:39], v[38:39], v[54:55]
    v_cvt_pk_bf16_f32 v56, v24, v25
    v_cvt_pk_bf16_f32 v57, v26, v27
    v_cvt_pk_bf16_f32 v58, v28, v29
    v_cvt_pk_bf16_f32 v59, v30, v31
    v_cvt_pk_bf16_f32 v60, v32, v33
    v_cvt_pk_bf16_f32 v61, v34, v35
    v_cvt_pk_bf16_f32 v62, v36, v37
    v_cvt_pk_bf16_f32 v63, v38, v39
    buffer_store_dwordx4 v[56:59], v10, s[32:35], s40 offen offset:0 sc1
    buffer_store_dwordx4 v[60:63], v10, s[32:35], s40 offen offset:1024 sc1
    v_lshlrev_b32 v72, 16, v56
    v_and_b32 v73, 0xffff0000, v56
    v_lshlrev_b32 v74, 16, v57
    v_and_b32 v75, 0xffff0000, v57
    v_lshlrev_b32 v76, 16, v58
    v_and_b32 v77, 0xffff0000, v58
    v_lshlrev_b32 v78, 16, v59
    v_and_b32 v79, 0xffff0000, v59
    v_lshlrev_b32 v80, 16, v60
    v_and_b32 v81, 0xffff0000, v60
    v_lshlrev_b32 v82, 16, v61
    v_and_b32 v83, 0xffff0000, v61
    v_lshlrev_b32 v84, 16, v62
    v_and_b32 v85, 0xffff0000, v62
    v_lshlrev_b32 v86, 16, v63
    v_and_b32 v87, 0xffff0000, v63
    v_pk_add_f32 v[120:121], v[72:73], v[74:75]
    v_pk_mul_f32 v[122:123], v[72:73], v[72:73]
    v_pk_fma_f32 v[122:123], v[74:75], v[74:75], v[122:123]
    v_pk_add_f32 v[120:121], v[120:121], v[76:77]
    v_pk_fma_f32 v[122:123], v[76:77], v[76:77], v[122:123]
    v_pk_add_f32 v[120:121], v[120:121], v[78:79]
    v_pk_fma_f32 v[122:123], v[78:79], v[78:79], v[122:123]
    v_pk_add_f32 v[120:121], v[120:121], v[80:81]
    v_pk_fma_f32 v[122:123], v[80:81], v[80:81], v[122:123]
    v_pk_add_f32 v[120:121], v[120:121], v[82:83]
    v_pk_fma_f32 v[122:123], v[82:83], v[82:83], v[122:123]
    v_pk_add_f32 v[120:121], v[120:121], v[84:85]
    v_pk_fma_f32 v[122:123], v[84:85], v[84:85], v[122:123]
    v_pk_add_f32 v[120:121], v[120:121], v[86:87]
    v_pk_fma_f32 v[122:123], v[86:87], v[86:87], v[122:123]
    v_add_f32 v64, v120, v121
    v_add_f32 v65, v122, v123
    v_add_f32 v66, v124, v125
    v_mov_b32 v4, v64
    v_mov_b32 v5, v65
    v_mov_b32 v6, v66
    s_nop 1
    v_permlane32_swap_b32 v4, v64
    v_permlane32_swap_b32 v5, v65
    v_permlane32_swap_b32 v6, v66
    v_add_f32 v64, v64, v4
    v_add_f32 v65, v65, v5
    v_add_f32 v66, v66, v6
    v_lshlrev_b32 v2, 8, v12
    s_mov_b64 exec, 0xffffffff
    buffer_store_dwordx4 v[64:67], v2, s[32:35], s41 offen sc1
    s_mov_b64 exec, -1
    v_mov_b32 v2, 0
    v_mov_b32 v3, 4096
    ds_write_b32 v3, v2
    s_waitcnt lgkmcnt(0)
    s_barrier
    s_lshr_b32 s38, s48, 1
    s_lshl_b32 s38, s38, 6
    s_and_b32 s40, s48, 1
    s_lshl_b32 s40, s40, 3
    s_add_u32 s38, s38, s40
    s_add_u32 s38, s38, s49
    s_lshl_b32 s38, s38, 2
    s_add_u32 s38, s38, 25165824
    s_waitcnt vmcnt(0)
    v_mov_b32 v2, 1
    v_mov_b32 v3, 4096
    s_mov_b64 exec, 1
    ds_add_rtn_u32 v4, v3, v2
    s_waitcnt lgkmcnt(0)
    v_readfirstlane_b32 s40, v4
    v_mov_b32 v3, 0
    s_cmp_lg_u32 s40, 3
    s_cbranch_scc1 wgp_28
    buffer_store_dword v2, v3, s[32:35], s38 offen sc1
wgp_28:
    s_mov_b64 exec, -1
    s_barrier
    s_cmp_ge_u32 s63, 28
    s_cbranch_scc1 k2_c5_29
    s_lshl_b32 s64, s61, 2
    s_lshl_b32 s40, s47, 1
    s_add_u32 s64, s64, s40
    s_lshl_b32 s40, s47, 12
    v_add_u32 v17, s40, v10
    v_add_u32 v18, 0x10000, v17
    v_lshl_add_u32 v3, v11, 2, v16
    v_lshl_add_u32 v3, v3, 8, v15
    s_lshl_b32 s40, s46, 1
    v_xor_b32 v2, s40, v16
    v_lshl_add_u32 v19, v2, 6, v3
    v_xor_b32 v21, 64, v19
    v_add_u32 v20, 0x10000, v19
    v_add_u32 v22, 0x10000, v21
    s_barrier
    ds_read_b128 v[88:91], v17 offset:0
    ds_read_b128 v[92:95], v17 offset:2048
    ds_read_b64_tr_b16 v[104:105], v19 offset:8192
    ds_read_b64_tr_b16 v[106:107], v19 offset:10240
    ds_read_b64_tr_b16 v[108:109], v21 offset:8192
    ds_read_b64_tr_b16 v[110:111], v21 offset:10240
    ds_read_b128 v[96:99], v17 offset:1024
    ds_read_b128 v[100:103], v17 offset:3072
    ds_read_b64_tr_b16 v[112:113], v19 offset:12288
    ds_read_b64_tr_b16 v[114:115], v19 offset:14336
    ds_read_b64_tr_b16 v[116:117], v21 offset:12288
    ds_read_b64_tr_b16 v[118:119], v21 offset:14336
    s_waitcnt lgkmcnt(6)
    v_mfma_f32_32x32x16_bf16 v[24:39], v[104:107], v[88:91], 0
    v_mfma_f32_32x32x16_bf16 v[40:55], v[104:107], v[92:95], 0
    v_mfma_f32_32x32x16_bf16 v[56:71], v[108:111], v[88:91], 0
    v_mfma_f32_32x32x16_bf16 v[72:87], v[108:111], v[92:95], 0
    s_barrier
    ds_read_b128 v[88:91], v17 offset:16384
    ds_read_b128 v[92:95], v17 offset:18432
    ds_read_b64_tr_b16 v[104:105], v19 offset:24576
    ds_read_b64_tr_b16 v[106:107], v19 offset:26624
    ds_read_b64_tr_b16 v[108:109], v21 offset:24576
    ds_read_b64_tr_b16 v[110:111], v21 offset:26624
    s_waitcnt lgkmcnt(6)
    v_mfma_f32_32x32x16_bf16 v[24:39], v[112:115], v[96:99], v[24:39]
    v_mfma_f32_32x32x16_bf16 v[40:55], v[112:115], v[100:103], v[40:55]
    v_mfma_f32_32x32x16_bf16 v[56:71], v[116:119], v[96:99], v[56:71]
    v_mfma_f32_32x32x16_bf16 v[72:87], v[116:119], v[100:103], v[72:87]
    ds_read_b128 v[96:99], v17 offset:17408
    ds_read_b128 v[100:103], v17 offset:19456
    ds_read_b64_tr_b16 v[112:113], v19 offset:28672
    ds_read_b64_tr_b16 v[114:115], v19 offset:30720
    ds_read_b64_tr_b16 v[116:117], v21 offset:28672
    ds_read_b64_tr_b16 v[118:119], v21 offset:30720
    s_waitcnt lgkmcnt(6)
    v_mfma_f32_32x32x16_bf16 v[24:39], v[104:107], v[88:91], v[24:39]
    v_mfma_f32_32x32x16_bf16 v[40:55], v[104:107], v[92:95], v[40:55]
    v_mfma_f32_32x32x16_bf16 v[56:71], v[108:111], v[88:91], v[56:71]
    v_mfma_f32_32x32x16_bf16 v[72:87], v[108:111], v[92:95], v[72:87]
    s_barrier
    ds_read_b128 v[88:91], v17 offset:32768
    ds_read_b128 v[92:95], v17 offset:34816
    ds_read_b64_tr_b16 v[104:105], v19 offset:40960
    ds_read_b64_tr_b16 v[106:107], v19 offset:43008
    ds_read_b64_tr_b16 v[108:109], v21 offset:40960
    ds_read_b64_tr_b16 v[110:111], v21 offset:43008
    s_waitcnt lgkmcnt(6)
    v_mfma_f32_32x32x16_bf16 v[24:39], v[112:115], v[96:99], v[24:39]
    v_mfma_f32_32x32x16_bf16 v[40:55], v[112:115], v[100:103], v[40:55]
    v_mfma_f32_32x32x16_bf16 v[56:71], v[116:119], v[96:99], v[56:71]
    v_mfma_f32_32x32x16_bf16 v[72:87], v[116:119], v[100:103], v[72:87]
    ds_read_b128 v[96:99], v17 offset:33792
    ds_read_b128 v[100:103], v17 offset:35840
    ds_read_b64_tr_b16 v[112:113], v19 offset:45056
    ds_read_b64_tr_b16 v[114:115], v19 offset:47104
    ds_read_b64_tr_b16 v[116:117], v21 offset:45056
    ds_read_b64_tr_b16 v[118:119], v21 offset:47104
    s_waitcnt lgkmcnt(6)
    v_mfma_f32_32x32x16_bf16 v[24:39], v[104:107], v[88:91], v[24:39]
    v_mfma_f32_32x32x16_bf16 v[40:55], v[104:107], v[92:95], v[40:55]
    v_mfma_f32_32x32x16_bf16 v[56:71], v[108:111], v[88:91], v[56:71]
    v_mfma_f32_32x32x16_bf16 v[72:87], v[108:111], v[92:95], v[72:87]
    s_barrier
    ds_read_b128 v[88:91], v17 offset:49152
    ds_read_b128 v[92:95], v17 offset:51200
    ds_read_b64_tr_b16 v[104:105], v19 offset:57344
    ds_read_b64_tr_b16 v[106:107], v19 offset:59392
    ds_read_b64_tr_b16 v[108:109], v21 offset:57344
    ds_read_b64_tr_b16 v[110:111], v21 offset:59392
    s_waitcnt lgkmcnt(6)
    v_mfma_f32_32x32x16_bf16 v[24:39], v[112:115], v[96:99], v[24:39]
    v_mfma_f32_32x32x16_bf16 v[40:55], v[112:115], v[100:103], v[40:55]
    v_mfma_f32_32x32x16_bf16 v[56:71], v[116:119], v[96:99], v[56:71]
    v_mfma_f32_32x32x16_bf16 v[72:87], v[116:119], v[100:103], v[72:87]
    ds_read_b128 v[96:99], v17 offset:50176
    ds_read_b128 v[100:103], v17 offset:52224
    ds_read_b64_tr_b16 v[112:113], v19 offset:61440
    ds_read_b64_tr_b16 v[114:115], v19 offset:63488
    ds_read_b64_tr_b16 v[116:117], v21 offset:61440
    ds_read_b64_tr_b16 v[118:119], v21 offset:63488
    s_waitcnt lgkmcnt(6)
    v_mfma_f32_32x32x16_bf16 v[24:39], v[104:107], v[88:91], v[24:39]
    v_mfma_f32_32x32x16_bf16 v[40:55], v[104:107], v[92:95], v[40:55]
    v_mfma_f32_32x32x16_bf16 v[56:71], v[108:111], v[88:91], v[56:71]
    v_mfma_f32_32x32x16_bf16 v[72:87], v[108:111], v[92:95], v[72:87]
    s_barrier
    ds_read_b128 v[88:91], v18 offset:0
    ds_read_b128 v[92:95], v18 offset:2048
    ds_read_b64_tr_b16 v[104:105], v20 offset:8192
    ds_read_b64_tr_b16 v[106:107], v20 offset:10240
    ds_read_b64_tr_b16 v[108:109], v22 offset:8192
    ds_read_b64_tr_b16 v[110:111], v22 offset:10240
    s_waitcnt lgkmcnt(6)
    v_mfma_f32_32x32x16_bf16 v[24:39], v[112:115], v[96:99], v[24:39]
    v_mfma_f32_32x32x16_bf16 v[40:55], v[112:115], v[100:103], v[40:55]
    v_mfma_f32_32x32x16_bf16 v[56:71], v[116:119], v[96:99], v[56:71]
    v_mfma_f32_32x32x16_bf16 v[72:87], v[116:119], v[100:103], v[72:87]
    ds_read_b128 v[96:99], v18 offset:1024
    ds_read_b128 v[100:103], v18 offset:3072
    ds_read_b64_tr_b16 v[112:113], v20 offset:12288
    ds_read_b64_tr_b16 v[114:115], v20 offset:14336
    ds_read_b64_tr_b16 v[116:117], v22 offset:12288
    ds_read_b64_tr_b16 v[118:119], v22 offset:14336
    s_waitcnt lgkmcnt(6)
    v_mfma_f32_32x32x16_bf16 v[24:39], v[104:107], v[88:91], v[24:39]
    v_mfma_f32_32x32x16_bf16 v[40:55], v[104:107], v[92:95], v[40:55]
    v_mfma_f32_32x32x16_bf16 v[56:71], v[108:111], v[88:91], v[56:71]
    v_mfma_f32_32x32x16_bf16 v[72:87], v[108:111], v[92:95], v[72:87]
    s_barrier
    ds_read_b128 v[88:91], v17 offset:0
    ds_read_b128 v[92:95], v17 offset:2048
    ds_read_b64_tr_b16 v[104:105], v19 offset:8192
    ds_read_b64_tr_b16 v[106:107], v19 offset:10240
    ds_read_b64_tr_b16 v[108:109], v21 offset:8192
    ds_read_b64_tr_b16 v[110:111], v21 offset:10240
    s_waitcnt lgkmcnt(6)
    v_mfma_f32_32x32x16_bf16 v[24:39], v[112:115], v[96:99], v[24:39]
    v_mfma_f32_32x32x16_bf16 v[40:55], v[112:115], v[100:103], v[40:55]
    v_mfma_f32_32x32x16_bf16 v[56:71], v[116:119], v[96:99], v[56:71]
    v_mfma_f32_32x32x16_bf16 v[72:87], v[116:119], v[100:103], v[72:87]
    ds_read_b128 v[96:99], v17 offset:1024
    ds_read_b128 v[100:103], v17 offset:3072
    ds_read_b64_tr_b16 v[112:113], v19 offset:12288
    ds_read_b64_tr_b16 v[114:115], v19 offset:14336
    ds_read_b64_tr_b16 v[116:117], v21 offset:12288
    ds_read_b64_tr_b16 v[118:119], v21 offset:14336
    s_waitcnt lgkmcnt(6)
    v_mfma_f32_32x32x16_bf16 v[24:39], v[104:107], v[88:91], v[24:39]
    v_mfma_f32_32x32x16_bf16 v[40:55], v[104:107], v[92:95], v[40:55]
    v_mfma_f32_32x32x16_bf16 v[56:71], v[108:111], v[88:91], v[56:71]
    v_mfma_f32_32x32x16_bf16 v[72:87], v[108:111], v[92:95], v[72:87]
    s_barrier
    ds_read_b128 v[88:91], v17 offset:16384
    ds_read_b128 v[92:95], v17 offset:18432
    ds_read_b64_tr_b16 v[104:105], v19 offset:24576
    ds_read_b64_tr_b16 v[106:107], v19 offset:26624
    ds_read_b64_tr_b16 v[108:109], v21 offset:24576
    ds_read_b64_tr_b16 v[110:111], v21 offset:26624
    s_waitcnt lgkmcnt(6)
    v_mfma_f32_32x32x16_bf16 v[24:39], v[112:115], v[96:99], v[24:39]
    v_mfma_f32_32x32x16_bf16 v[40:55], v[112:115], v[100:103], v[40:55]
    v_mfma_f32_32x32x16_bf16 v[56:71], v[116:119], v[96:99], v[56:71]
    v_mfma_f32_32x32x16_bf16 v[72:87], v[116:119], v[100:103], v[72:87]
    ds_read_b128 v[96:99], v17 offset:17408
    ds_read_b128 v[100:103], v17 offset:19456
    ds_read_b64_tr_b16 v[112:113], v19 offset:28672
    ds_read_b64_tr_b16 v[114:115], v19 offset:30720
    ds_read_b64_tr_b16 v[116:117], v21 offset:28672
    ds_read_b64_tr_b16 v[118:119], v21 offset:30720
    s_waitcnt lgkmcnt(6)
    v_mfma_f32_32x32x16_bf16 v[24:39], v[104:107], v[88:91], v[24:39]
    v_mfma_f32_32x32x16_bf16 v[40:55], v[104:107], v[92:95], v[40:55]
    v_mfma_f32_32x32x16_bf16 v[56:71], v[108:111], v[88:91], v[56:71]
    v_mfma_f32_32x32x16_bf16 v[72:87], v[108:111], v[92:95], v[72:87]
    s_barrier
    ds_read_b128 v[88:91], v17 offset:32768
    ds_read_b128 v[92:95], v17 offset:34816
    ds_read_b64_tr_b16 v[104:105], v19 offset:40960
    ds_read_b64_tr_b16 v[106:107], v19 offset:43008
    ds_read_b64_tr_b16 v[108:109], v21 offset:40960
    ds_read_b64_tr_b16 v[110:111], v21 offset:43008
    s_waitcnt lgkmcnt(6)
    v_mfma_f32_32x32x16_bf16 v[24:39], v[112:115], v[96:99], v[24:39]
    v_mfma_f32_32x32x16_bf16 v[40:55], v[112:115], v[100:103], v[40:55]
    v_mfma_f32_32x32x16_bf16 v[56:71], v[116:119], v[96:99], v[56:71]
    v_mfma_f32_32x32x16_bf16 v[72:87], v[116:119], v[100:103], v[72:87]
    ds_read_b128 v[96:99], v17 offset:33792
    ds_read_b128 v[100:103], v17 offset:35840
    ds_read_b64_tr_b16 v[112:113], v19 offset:45056
    ds_read_b64_tr_b16 v[114:115], v19 offset:47104
    ds_read_b64_tr_b16 v[116:117], v21 offset:45056
    ds_read_b64_tr_b16 v[118:119], v21 offset:47104
    s_waitcnt lgkmcnt(6)
    v_mfma_f32_32x32x16_bf16 v[24:39], v[104:107], v[88:91], v[24:39]
    v_mfma_f32_32x32x16_bf16 v[40:55], v[104:107], v[92:95], v[40:55]
    v_mfma_f32_32x32x16_bf16 v[56:71], v[108:111], v[88:91], v[56:71]
    v_mfma_f32_32x32x16_bf16 v[72:87], v[108:111], v[92:95], v[72:87]
    s_barrier
    ds_read_b128 v[88:91], v17 offset:49152
    ds_read_b128 v[92:95], v17 offset:51200
    ds_read_b64_tr_b16 v[104:105], v19 offset:57344
    ds_read_b64_tr_b16 v[106:107], v19 offset:59392
    ds_read_b64_tr_b16 v[108:109], v21 offset:57344
    ds_read_b64_tr_b16 v[110:111], v21 offset:59392
    s_waitcnt lgkmcnt(6)
    v_mfma_f32_32x32x16_bf16 v[24:39], v[112:115], v[96:99], v[24:39]
    v_mfma_f32_32x32x16_bf16 v[40:55], v[112:115], v[100:103], v[40:55]
    v_mfma_f32_32x32x16_bf16 v[56:71], v[116:119], v[96:99], v[56:71]
    v_mfma_f32_32x32x16_bf16 v[72:87], v[116:119], v[100:103], v[72:87]
    ds_read_b128 v[96:99], v17 offset:50176
    ds_read_b128 v[100:103], v17 offset:52224
    ds_read_b64_tr_b16 v[112:113], v19 offset:61440
    ds_read_b64_tr_b16 v[114:115], v19 offset:63488
    ds_read_b64_tr_b16 v[116:117], v21 offset:61440
    ds_read_b64_tr_b16 v[118:119], v21 offset:63488
    s_waitcnt lgkmcnt(6)
    v_mfma_f32_32x32x16_bf16 v[24:39], v[104:107], v[88:91], v[24:39]
    v_mfma_f32_32x32x16_bf16 v[40:55], v[104:107], v[92:95], v[40:55]
    v_mfma_f32_32x32x16_bf16 v[56:71], v[108:111], v[88:91], v[56:71]
    v_mfma_f32_32x32x16_bf16 v[72:87], v[108:111], v[92:95], v[72:87]
    s_barrier
    ds_read_b128 v[88:91], v18 offset:0
    ds_read_b128 v[92:95], v18 offset:2048
    ds_read_b64_tr_b16 v[104:105], v20 offset:8192
    ds_read_b64_tr_b16 v[106:107], v20 offset:10240
    ds_read_b64_tr_b16 v[108:109], v22 offset:8192
    ds_read_b64_tr_b16 v[110:111], v22 offset:10240
    s_waitcnt lgkmcnt(6)
    v_mfma_f32_32x32x16_bf16 v[24:39], v[112:115], v[96:99], v[24:39]
    v_mfma_f32_32x32x16_bf16 v[40:55], v[112:115], v[100:103], v[40:55]
    v_mfma_f32_32x32x16_bf16 v[56:71], v[116:119], v[96:99], v[56:71]
    v_mfma_f32_32x32x16_bf16 v[72:87], v[116:119], v[100:103], v[72:87]
    ds_read_b128 v[96:99], v18 offset:1024
    ds_read_b128 v[100:103], v18 offset:3072
    ds_read_b64_tr_b16 v[112:113], v20 offset:12288
    ds_read_b64_tr_b16 v[114:115], v20 offset:14336
    ds_read_b64_tr_b16 v[116:117], v22 offset:12288
    ds_read_b64_tr_b16 v[118:119], v22 offset:14336
    s_waitcnt lgkmcnt(6)
    v_mfma_f32_32x32x16_bf16 v[24:39], v[104:107], v[88:91], v[24:39]
    v_mfma_f32_32x32x16_bf16 v[40:55], v[104:107], v[92:95], v[40:55]
    v_mfma_f32_32x32x16_bf16 v[56:71], v[108:111], v[88:91], v[56:71]
    v_mfma_f32_32x32x16_bf16 v[72:87], v[108:111], v[92:95], v[72:87]
    s_barrier
    ds_read_b128 v[88:91], v17 offset:0
    ds_read_b128 v[92:95], v17 offset:2048
    ds_read_b64_tr_b16 v[104:105], v19 offset:8192
    ds_read_b64_tr_b16 v[106:107], v19 offset:10240
    ds_read_b64_tr_b16 v[108:109], v21 offset:8192
    ds_read_b64_tr_b16 v[110:111], v21 offset:10240
    s_waitcnt lgkmcnt(6)
    v_mfma_f32_32x32x16_bf16 v[24:39], v[112:115], v[96:99], v[24:39]
    v_mfma_f32_32x32x16_bf16 v[40:55], v[112:115], v[100:103], v[40:55]
    v_mfma_f32_32x32x16_bf16 v[56:71], v[116:119], v[96:99], v[56:71]
    v_mfma_f32_32x32x16_bf16 v[72:87], v[116:119], v[100:103], v[72:87]
    ds_read_b128 v[96:99], v17 offset:1024
    ds_read_b128 v[100:103], v17 offset:3072
    ds_read_b64_tr_b16 v[112:113], v19 offset:12288
    ds_read_b64_tr_b16 v[114:115], v19 offset:14336
    ds_read_b64_tr_b16 v[116:117], v21 offset:12288
    ds_read_b64_tr_b16 v[118:119], v21 offset:14336
    s_waitcnt lgkmcnt(6)
    v_mfma_f32_32x32x16_bf16 v[24:39], v[104:107], v[88:91], v[24:39]
    v_mfma_f32_32x32x16_bf16 v[40:55], v[104:107], v[92:95], v[40:55]
    v_mfma_f32_32x32x16_bf16 v[56:71], v[108:111], v[88:91], v[56:71]
    v_mfma_f32_32x32x16_bf16 v[72:87], v[108:111], v[92:95], v[72:87]
    s_barrier
    ds_read_b128 v[88:91], v17 offset:16384
    ds_read_b128 v[92:95], v17 offset:18432
    ds_read_b64_tr_b16 v[104:105], v19 offset:24576
    ds_read_b64_tr_b16 v[106:107], v19 offset:26624
    ds_read_b64_tr_b16 v[108:109], v21 offset:24576
    ds_read_b64_tr_b16 v[110:111], v21 offset:26624
    s_waitcnt lgkmcnt(6)
    v_mfma_f32_32x32x16_bf16 v[24:39], v[112:115], v[96:99], v[24:39]
    v_mfma_f32_32x32x16_bf16 v[40:55], v[112:115], v[100:103], v[40:55]
    v_mfma_f32_32x32x16_bf16 v[56:71], v[116:119], v[96:99], v[56:71]
    v_mfma_f32_32x32x16_bf16 v[72:87], v[116:119], v[100:103], v[72:87]
    ds_read_b128 v[96:99], v17 offset:17408
    ds_read_b128 v[100:103], v17 offset:19456
    ds_read_b64_tr_b16 v[112:113], v19 offset:28672
    ds_read_b64_tr_b16 v[114:115], v19 offset:30720
    ds_read_b64_tr_b16 v[116:117], v21 offset:28672
    ds_read_b64_tr_b16 v[118:119], v21 offset:30720
    s_waitcnt lgkmcnt(6)
    v_mfma_f32_32x32x16_bf16 v[24:39], v[104:107], v[88:91], v[24:39]
    v_mfma_f32_32x32x16_bf16 v[40:55], v[104:107], v[92:95], v[40:55]
    v_mfma_f32_32x32x16_bf16 v[56:71], v[108:111], v[88:91], v[56:71]
    v_mfma_f32_32x32x16_bf16 v[72:87], v[108:111], v[92:95], v[72:87]
    s_barrier
    ds_read_b128 v[88:91], v17 offset:32768
    ds_read_b128 v[92:95], v17 offset:34816
    ds_read_b64_tr_b16 v[104:105], v19 offset:40960
    ds_read_b64_tr_b16 v[106:107], v19 offset:43008
    ds_read_b64_tr_b16 v[108:109], v21 offset:40960
    ds_read_b64_tr_b16 v[110:111], v21 offset:43008
    s_waitcnt lgkmcnt(6)
    v_mfma_f32_32x32x16_bf16 v[24:39], v[112:115], v[96:99], v[24:39]
    v_mfma_f32_32x32x16_bf16 v[40:55], v[112:115], v[100:103], v[40:55]
    v_mfma_f32_32x32x16_bf16 v[56:71], v[116:119], v[96:99], v[56:71]
    v_mfma_f32_32x32x16_bf16 v[72:87], v[116:119], v[100:103], v[72:87]
    ds_read_b128 v[96:99], v17 offset:33792
    ds_read_b128 v[100:103], v17 offset:35840
    ds_read_b64_tr_b16 v[112:113], v19 offset:45056
    ds_read_b64_tr_b16 v[114:115], v19 offset:47104
    ds_read_b64_tr_b16 v[116:117], v21 offset:45056
    ds_read_b64_tr_b16 v[118:119], v21 offset:47104
    s_waitcnt lgkmcnt(6)
    v_mfma_f32_32x32x16_bf16 v[24:39], v[104:107], v[88:91], v[24:39]
    v_mfma_f32_32x32x16_bf16 v[40:55], v[104:107], v[92:95], v[40:55]
    v_mfma_f32_32x32x16_bf16 v[56:71], v[108:111], v[88:91], v[56:71]
    v_mfma_f32_32x32x16_bf16 v[72:87], v[108:111], v[92:95], v[72:87]
    s_barrier
    ds_read_b128 v[88:91], v17 offset:49152
    ds_read_b128 v[92:95], v17 offset:51200
    ds_read_b64_tr_b16 v[104:105], v19 offset:57344
    ds_read_b64_tr_b16 v[106:107], v19 offset:59392
    ds_read_b64_tr_b16 v[108:109], v21 offset:57344
    ds_read_b64_tr_b16 v[110:111], v21 offset:59392
    s_waitcnt lgkmcnt(6)
    v_mfma_f32_32x32x16_bf16 v[24:39], v[112:115], v[96:99], v[24:39]
    v_mfma_f32_32x32x16_bf16 v[40:55], v[112:115], v[100:103], v[40:55]
    v_mfma_f32_32x32x16_bf16 v[56:71], v[116:119], v[96:99], v[56:71]
    v_mfma_f32_32x32x16_bf16 v[72:87], v[116:119], v[100:103], v[72:87]
    ds_read_b128 v[96:99], v17 offset:50176
    ds_read_b128 v[100:103], v17 offset:52224
    ds_read_b64_tr_b16 v[112:113], v19 offset:61440
    ds_read_b64_tr_b16 v[114:115], v19 offset:63488
    ds_read_b64_tr_b16 v[116:117], v21 offset:61440
    ds_read_b64_tr_b16 v[118:119], v21 offset:63488
    s_waitcnt lgkmcnt(6)
    v_mfma_f32_32x32x16_bf16 v[24:39], v[104:107], v[88:91], v[24:39]
    v_mfma_f32_32x32x16_bf16 v[40:55], v[104:107], v[92:95], v[40:55]
    v_mfma_f32_32x32x16_bf16 v[56:71], v[108:111], v[88:91], v[56:71]
    v_mfma_f32_32x32x16_bf16 v[72:87], v[108:111], v[92:95], v[72:87]
    s_barrier
    ds_read_b128 v[88:91], v18 offset:0
    ds_read_b128 v[92:95], v18 offset:2048
    ds_read_b64_tr_b16 v[104:105], v20 offset:8192
    ds_read_b64_tr_b16 v[106:107], v20 offset:10240
    ds_read_b64_tr_b16 v[108:109], v22 offset:8192
    ds_read_b64_tr_b16 v[110:111], v22 offset:10240
    s_waitcnt lgkmcnt(6)
    v_mfma_f32_32x32x16_bf16 v[24:39], v[112:115], v[96:99], v[24:39]
    v_mfma_f32_32x32x16_bf16 v[40:55], v[112:115], v[100:103], v[40:55]
    v_mfma_f32_32x32x16_bf16 v[56:71], v[116:119], v[96:99], v[56:71]
    v_mfma_f32_32x32x16_bf16 v[72:87], v[116:119], v[100:103], v[72:87]
    ds_read_b128 v[96:99], v18 offset:1024
    ds_read_b128 v[100:103], v18 offset:3072
    ds_read_b64_tr_b16 v[112:113], v20 offset:12288
    ds_read_b64_tr_b16 v[114:115], v20 offset:14336
    ds_read_b64_tr_b16 v[116:117], v22 offset:12288
    ds_read_b64_tr_b16 v[118:119], v22 offset:14336
    s_waitcnt lgkmcnt(6)
    v_mfma_f32_32x32x16_bf16 v[24:39], v[104:107], v[88:91], v[24:39]
    v_mfma_f32_32x32x16_bf16 v[40:55], v[104:107], v[92:95], v[40:55]
    v_mfma_f32_32x32x16_bf16 v[56:71], v[108:111], v[88:91], v[56:71]
    v_mfma_f32_32x32x16_bf16 v[72:87], v[108:111], v[92:95], v[72:87]
    s_barrier
    ds_read_b128 v[88:91], v17 offset:0
    ds_read_b128 v[92:95], v17 offset:2048
    ds_read_b64_tr_b16 v[104:105], v19 offset:8192
    ds_read_b64_tr_b16 v[106:107], v19 offset:10240
    ds_read_b64_tr_b16 v[108:109], v21 offset:8192
    ds_read_b64_tr_b16 v[110:111], v21 offset:10240
    s_waitcnt lgkmcnt(6)
    v_mfma_f32_32x32x16_bf16 v[24:39], v[112:115], v[96:99], v[24:39]
    v_mfma_f32_32x32x16_bf16 v[40:55], v[112:115], v[100:103], v[40:55]
    v_mfma_f32_32x32x16_bf16 v[56:71], v[116:119], v[96:99], v[56:71]
    v_mfma_f32_32x32x16_bf16 v[72:87], v[116:119], v[100:103], v[72:87]
    ds_read_b128 v[96:99], v17 offset:1024
    ds_read_b128 v[100:103], v17 offset:3072
    ds_read_b64_tr_b16 v[112:113], v19 offset:12288
    ds_read_b64_tr_b16 v[114:115], v19 offset:14336
    ds_read_b64_tr_b16 v[116:117], v21 offset:12288
    ds_read_b64_tr_b16 v[118:119], v21 offset:14336
    s_waitcnt lgkmcnt(6)
    v_mfma_f32_32x32x16_bf16 v[24:39], v[104:107], v[88:91], v[24:39]
    v_mfma_f32_32x32x16_bf16 v[40:55], v[104:107], v[92:95], v[40:55]
    v_mfma_f32_32x32x16_bf16 v[56:71], v[108:111], v[88:91], v[56:71]
    v_mfma_f32_32x32x16_bf16 v[72:87], v[108:111], v[92:95], v[72:87]
    s_waitcnt lgkmcnt(0)
    v_mfma_f32_32x32x16_bf16 v[24:39], v[112:115], v[96:99], v[24:39]
    v_mfma_f32_32x32x16_bf16 v[40:55], v[112:115], v[100:103], v[40:55]
    v_mfma_f32_32x32x16_bf16 v[56:71], v[116:119], v[96:99], v[56:71]
    v_mfma_f32_32x32x16_bf16 v[72:87], v[116:119], v[100:103], v[72:87]
    s_barrier
    s_lshl_b32 s40, s46, 8
    v_lshlrev_b32 v3, 4, v11
    v_add_u32 v3, s40, v3
    s_lshl_b32 s40, s47, 10
    v_lshlrev_b32 v2, 4, v12
    v_add_u32 v2, s40, v2
    s_barrier
    ds_read_b128 v[88:91], v3 offset:0
    ds_read_b128 v[92:95], v3 offset:32
    ds_read_b128 v[96:99], v3 offset:64
    ds_read_b128 v[100:103], v3 offset:96
    ds_read_b128 v[104:107], v3 offset:128
    ds_read_b128 v[108:111], v3 offset:160
    ds_read_b128 v[112:115], v3 offset:192
    ds_read_b128 v[116:119], v3 offset:224
    ds_read_b128 v[120:123], v2 offset:1024
    ds_read_b128 v[124:127], v2 offset:1536
    s_mul_i32 s40, s64, 112
    s_lshl_b32 s41, s62, 3
    s_add_u32 s40, s40, s41
    s_lshl_b32 s41, s46, 2
    s_add_u32 s40, s40, s41
    s_lshl_b32 s40, s40, 10
    s_add_u32 s40, s40, 14680064
    s_add_u32 s41, s40, 114688
    s_waitcnt lgkmcnt(0)
    v_pk_fma_f32 v[24:25], v[88:89], v[122:123], v[24:25] op_sel:[0,1,0] op_sel_hi:[1,1,1]
    v_pk_fma_f32 v[26:27], v[90:91], v[122:123], v[26:27] op_sel:[0,1,0] op_sel_hi:[1,1,1]
    v_pk_fma_f32 v[28:29], v[92:93], v[122:123], v[28:29] op_sel:[0,1,0] op_sel_hi:[1,1,1]
    v_pk_fma_f32 v[30:31], v[94:95], v[122:123], v[30:31] op_sel:[0,1,0] op_sel_hi:[1,1,1]
    v_pk_fma_f32 v[32:33], v[96:97], v[122:123], v[32:33] op_sel:[0,1,0] op_sel_hi:[1,1,1]
    v_pk_fma_f32 v[34:35], v[98:99], v[122:123], v[34:35] op_sel:[0,1,0] op_sel_hi:[1,1,1]
    v_pk_fma_f32 v[36:37], v[100:101], v[122:123], v[36:37] op_sel:[0,1,0] op_sel_hi:[1,1,1]
    v_pk_fma_f32 v[38:39], v[102:103], v[122:123], v[38:39] op_sel:[0,1,0] op_sel_hi:[1,1,1]
    v_pk_fma_f32 v[40:41], v[88:89], v[126:127], v[40:41] op_sel:[0,1,0] op_sel_hi:[1,1,1]
    v_pk_fma_f32 v[42:43], v[90:91], v[126:127], v[42:43] op_sel:[0,1,0] op_sel_hi:[1,1,1]
    v_pk_fma_f32 v[44:45], v[92:93], v[126:127], v[44:45] op_sel:[0,1,0] op_sel_hi:[1,1,1]
    v_pk_fma_f32 v[46:47], v[94:95], v[126:127], v[46:47] op_sel:[0,1,0] op_sel_hi:[1,1,1]
    v_pk_fma_f32 v[48:49], v[96:97], v[126:127], v[48:49] op_sel:[0,1,0] op_sel_hi:[1,1,1]
    v_pk_fma_f32 v[50:51], v[98:99], v[126:127], v[50:51] op_sel:[0,1,0] op_sel_hi:[1,1,1]
    v_pk_fma_f32 v[52:53], v[100:101], v[126:127], v[52:53] op_sel:[0,1,0] op_sel_hi:[1,1,1]
    v_pk_fma_f32 v[54:55], v[102:103], v[126:127], v[54:55] op_sel:[0,1,0] op_sel_hi:[1,1,1]
    v_pk_fma_f32 v[56:57], v[104:105], v[122:123], v[56:57] op_sel:[0,1,0] op_sel_hi:[1,1,1]
    v_pk_fma_f32 v[58:59], v[106:107], v[122:123], v[58:59] op_sel:[0,1,0] op_sel_hi:[1,1,1]
    v_pk_fma_f32 v[60:61], v[108:109], v[122:123], v[60:61] op_sel:[0,1,0] op_sel_hi:[1,1,1]
    v_pk_fma_f32 v[62:63], v[110:111], v[122:123], v[62:63] op_sel:[0,1,0] op_sel_hi:[1,1,1]
    v_pk_fma_f32 v[64:65], v[112:113], v[122:123], v[64:65] op_sel:[0,1,0] op_sel_hi:[1,1,1]
    v_pk_fma_f32 v[66:67], v[114:115], v[122:123], v[66:67] op_sel:[0,1,0] op_sel_hi:[1,1,1]
    v_pk_fma_f32 v[68:69], v[116:117], v[122:123], v[68:69] op_sel:[0,1,0] op_sel_hi:[1,1,1]
    v_pk_fma_f32 v[70:71], v[118:119], v[122:123], v[70:71] op_sel:[0,1,0] op_sel_hi:[1,1,1]
    v_pk_fma_f32 v[72:73], v[104:105], v[126:127], v[72:73] op_sel:[0,1,0] op_sel_hi:[1,1,1]
    v_pk_fma_f32 v[74:75], v[106:107], v[126:127], v[74:75] op_sel:[0,1,0] op_sel_hi:[1,1,1]
    v_pk_fma_f32 v[76:77], v[108:109], v[126:127], v[76:77] op_sel:[0,1,0] op_sel_hi:[1,1,1]
    v_pk_fma_f32 v[78:79], v[110:111], v[126:127], v[78:79] op_sel:[0,1,0] op_sel_hi:[1,1,1]
    v_pk_fma_f32 v[80:81], v[112:113], v[126:127], v[80:81] op_sel:[0,1,0] op_sel_hi:[1,1,1]
    v_pk_fma_f32 v[82:83], v[114:115], v[126:127], v[82:83] op_sel:[0,1,0] op_sel_hi:[1,1,1]
    v_pk_fma_f32 v[84:85], v[116:117], v[126:127], v[84:85] op_sel:[0,1,0] op_sel_hi:[1,1,1]
    v_pk_fma_f32 v[86:87], v[118:119], v[126:127], v[86:87] op_sel:[0,1,0] op_sel_hi:[1,1,1]
    v_pk_mul_f32 v[88:89], v[24:25], v[24:25]
    v_pk_mul_f32 v[90:91], v[26:27], v[26:27]
    v_pk_mul_f32 v[92:93], v[28:29], v[28:29]
    v_pk_mul_f32 v[94:95], v[30:31], v[30:31]
    v_pk_mul_f32 v[96:97], v[32:33], v[32:33]
    v_pk_mul_f32 v[98:99], v[34:35], v[34:35]
    v_pk_mul_f32 v[100:101], v[36:37], v[36:37]
    v_pk_mul_f32 v[102:103], v[38:39], v[38:39]
    v_pk_fma_f32 v[88:89], v[88:89], v[120:121], v[120:121] op_sel:[0,1,0] op_sel_hi:[1,1,0]
    v_pk_fma_f32 v[90:91], v[90:91], v[120:121], v[120:121] op_sel:[0,1,0] op_sel_hi:[1,1,0]
    v_pk_fma_f32 v[92:93], v[92:93], v[120:121], v[120:121] op_sel:[0,1,0] op_sel_hi:[1,1,0]
    v_pk_fma_f32 v[94:95], v[94:95], v[120:121], v[120:121] op_sel:[0,1,0] op_sel_hi:[1,1,0]
    v_pk_fma_f32 v[96:97], v[96:97], v[120:121], v[120:121] op_sel:[0,1,0] op_sel_hi:[1,1,0]
    v_pk_fma_f32 v[98:99], v[98:99], v[120:121], v[120:121] op_sel:[0,1,0] op_sel_hi:[1,1,0]
    v_pk_fma_f32 v[100:101], v[100:101], v[120:121], v[120:121] op_sel:[0,1,0] op_sel_hi:[1,1,0]
    v_pk_fma_f32 v[102:103], v[102:103], v[120:121], v[120:121] op_sel:[0,1,0] op_sel_hi:[1,1,0]
    v_pk_mul_f32 v[88:89], v[88:89], v[24:25]
    v_pk_mul_f32 v[90:91], v[90:91], v[26:27]
    v_pk_mul_f32 v[92:93], v[92:93], v[28:29]
    v_pk_mul_f32 v[94:95], v[94:95], v[30:31]
    v_pk_mul_f32 v[96:97], v[96:97], v[32:33]
    v_pk_mul_f32 v[98:99], v[98:99], v[34:35]
    v_pk_mul_f32 v[100:101], v[100:101], v[36:37]
    v_pk_mul_f32 v[102:103], v[102:103], v[38:39]
    v_exp_f32 v88, v88
    v_exp_f32 v89, v89
    v_exp_f32 v90, v90
    v_exp_f32 v91, v91
    v_exp_f32 v92, v92
    v_exp_f32 v93, v93
    v_exp_f32 v94, v94
    v_exp_f32 v95, v95
    v_exp_f32 v96, v96
    v_exp_f32 v97, v97
    v_exp_f32 v98, v98
    v_exp_f32 v99, v99
    v_exp_f32 v100, v100
    v_exp_f32 v101, v101
    v_exp_f32 v102, v102
    v_exp_f32 v103, v103
    v_pk_fma_f32 v[88:89], v[88:89], v[122:123], v[122:123] op_sel:[0,0,0] op_sel_hi:[1,0,0]
    v_pk_fma_f32 v[90:91], v[90:91], v[122:123], v[122:123] op_sel:[0,0,0] op_sel_hi:[1,0,0]
    v_pk_fma_f32 v[92:93], v[92:93], v[122:123], v[122:123] op_sel:[0,0,0] op_sel_hi:[1,0,0]
    v_pk_fma_f32 v[94:95], v[94:95], v[122:123], v[122:123] op_sel:[0,0,0] op_sel_hi:[1,0,0]
    v_pk_fma_f32 v[96:97], v[96:97], v[122:123], v[122:123] op_sel:[0,0,0] op_sel_hi:[1,0,0]
    v_pk_fma_f32 v[98:99], v[98:99], v[122:123], v[122:123] op_sel:[0,0,0] op_sel_hi:[1,0,0]
    v_pk_fma_f32 v[100:101], v[100:101], v[122:123], v[122:123] op_sel:[0,0,0] op_sel_hi:[1,0,0]
    v_pk_fma_f32 v[102:103], v[102:103], v[122:123], v[122:123] op_sel:[0,0,0] op_sel_hi:[1,0,0]
    v_rcp_f32 v88, v88
    v_rcp_f32 v89, v89
    v_rcp_f32 v90, v90
    v_rcp_f32 v91, v91
    v_rcp_f32 v92, v92
    v_rcp_f32 v93, v93
    v_rcp_f32 v94, v94
    v_rcp_f32 v95, v95
    v_rcp_f32 v96, v96
    v_rcp_f32 v97, v97
    v_rcp_f32 v98, v98
    v_rcp_f32 v99, v99
    v_rcp_f32 v100, v100
    v_rcp_f32 v101, v101
    v_rcp_f32 v102, v102
    v_rcp_f32 v103, v103
    v_pk_mul_f32 v[24:25], v[24:25], v[88:89]
    v_pk_mul_f32 v[26:27], v[26:27], v[90:91]
    v_pk_mul_f32 v[28:29], v[28:29], v[92:93]
    v_pk_mul_f32 v[30:31], v[30:31], v[94:95]
    v_pk_mul_f32 v[32:33], v[32:33], v[96:97]
    v_pk_mul_f32 v[34:35], v[34:35], v[98:99]
    v_pk_mul_f32 v[36:37], v[36:37], v[100:101]
    v_pk_mul_f32 v[38:39], v[38:39], v[102:103]
    v_cvt_pk_bf16_f32 v24, v24, v25
    v_cvt_pk_bf16_f32 v25, v26, v27
    v_cvt_pk_bf16_f32 v26, v28, v29
    v_cvt_pk_bf16_f32 v27, v30, v31
    v_cvt_pk_bf16_f32 v28, v32, v33
    v_cvt_pk_bf16_f32 v29, v34, v35
    v_cvt_pk_bf16_f32 v30, v36, v37
    v_cvt_pk_bf16_f32 v31, v38, v39
    buffer_store_dwordx4 v[24:27], v10, s[32:35], s40 offen offset:0 sc1
    buffer_store_dwordx4 v[28:31], v10, s[32:35], s40 offen offset:1024 sc1
    v_pk_mul_f32 v[88:89], v[40:41], v[40:41]
    v_pk_mul_f32 v[90:91], v[42:43], v[42:43]
    v_pk_mul_f32 v[92:93], v[44:45], v[44:45]
    v_pk_mul_f32 v[94:95], v[46:47], v[46:47]
    v_pk_mul_f32 v[96:97], v[48:49], v[48:49]
    v_pk_mul_f32 v[98:99], v[50:51], v[50:51]
    v_pk_mul_f32 v[100:101], v[52:53], v[52:53]
    v_pk_mul_f32 v[102:103], v[54:55], v[54:55]
    v_pk_fma_f32 v[88:89], v[88:89], v[124:125], v[124:125] op_sel:[0,1,0] op_sel_hi:[1,1,0]
    v_pk_fma_f32 v[90:91], v[90:91], v[124:125], v[124:125] op_sel:[0,1,0] op_sel_hi:[1,1,0]
    v_pk_fma_f32 v[92:93], v[92:93], v[124:125], v[124:125] op_sel:[0,1,0] op_sel_hi:[1,1,0]
    v_pk_fma_f32 v[94:95], v[94:95], v[124:125], v[124:125] op_sel:[0,1,0] op_sel_hi:[1,1,0]
    v_pk_fma_f32 v[96:97], v[96:97], v[124:125], v[124:125] op_sel:[0,1,0] op_sel_hi:[1,1,0]
    v_pk_fma_f32 v[98:99], v[98:99], v[124:125], v[124:125] op_sel:[0,1,0] op_sel_hi:[1,1,0]
    v_pk_fma_f32 v[100:101], v[100:101], v[124:125], v[124:125] op_sel:[0,1,0] op_sel_hi:[1,1,0]
    v_pk_fma_f32 v[102:103], v[102:103], v[124:125], v[124:125] op_sel:[0,1,0] op_sel_hi:[1,1,0]
    v_pk_mul_f32 v[88:89], v[88:89], v[40:41]
    v_pk_mul_f32 v[90:91], v[90:91], v[42:43]
    v_pk_mul_f32 v[92:93], v[92:93], v[44:45]
    v_pk_mul_f32 v[94:95], v[94:95], v[46:47]
    v_pk_mul_f32 v[96:97], v[96:97], v[48:49]
    v_pk_mul_f32 v[98:99], v[98:99], v[50:51]
    v_pk_mul_f32 v[100:101], v[100:101], v[52:53]
    v_pk_mul_f32 v[102:103], v[102:103], v[54:55]
    v_exp_f32 v88, v88
    v_exp_f32 v89, v89
    v_exp_f32 v90, v90
    v_exp_f32 v91, v91
    v_exp_f32 v92, v92
    v_exp_f32 v93, v93
    v_exp_f32 v94, v94
    v_exp_f32 v95, v95
    v_exp_f32 v96, v96
    v_exp_f32 v97, v97
    v_exp_f32 v98, v98
    v_exp_f32 v99, v99
    v_exp_f32 v100, v100
    v_exp_f32 v101, v101
    v_exp_f32 v102, v102
    v_exp_f32 v103, v103
    v_pk_fma_f32 v[88:89], v[88:89], v[126:127], v[126:127] op_sel:[0,0,0] op_sel_hi:[1,0,0]
    v_pk_fma_f32 v[90:91], v[90:91], v[126:127], v[126:127] op_sel:[0,0,0] op_sel_hi:[1,0,0]
    v_pk_fma_f32 v[92:93], v[92:93], v[126:127], v[126:127] op_sel:[0,0,0] op_sel_hi:[1,0,0]
    v_pk_fma_f32 v[94:95], v[94:95], v[126:127], v[126:127] op_sel:[0,0,0] op_sel_hi:[1,0,0]
    v_pk_fma_f32 v[96:97], v[96:97], v[126:127], v[126:127] op_sel:[0,0,0] op_sel_hi:[1,0,0]
    v_pk_fma_f32 v[98:99], v[98:99], v[126:127], v[126:127] op_sel:[0,0,0] op_sel_hi:[1,0,0]
    v_pk_fma_f32 v[100:101], v[100:101], v[126:127], v[126:127] op_sel:[0,0,0] op_sel_hi:[1,0,0]
    v_pk_fma_f32 v[102:103], v[102:103], v[126:127], v[126:127] op_sel:[0,0,0] op_sel_hi:[1,0,0]
    v_rcp_f32 v88, v88
    v_rcp_f32 v89, v89
    v_rcp_f32 v90, v90
    v_rcp_f32 v91, v91
    v_rcp_f32 v92, v92
    v_rcp_f32 v93, v93
    v_rcp_f32 v94, v94
    v_rcp_f32 v95, v95
    v_rcp_f32 v96, v96
    v_rcp_f32 v97, v97
    v_rcp_f32 v98, v98
    v_rcp_f32 v99, v99
    v_rcp_f32 v100, v100
    v_rcp_f32 v101, v101
    v_rcp_f32 v102, v102
    v_rcp_f32 v103, v103
    v_pk_mul_f32 v[40:41], v[40:41], v[88:89]
    v_pk_mul_f32 v[42:43], v[42:43], v[90:91]
    v_pk_mul_f32 v[44:45], v[44:45], v[92:93]
    v_pk_mul_f32 v[46:47], v[46:47], v[94:95]
    v_pk_mul_f32 v[48:49], v[48:49], v[96:97]
    v_pk_mul_f32 v[50:51], v[50:51], v[98:99]
    v_pk_mul_f32 v[52:53], v[52:53], v[100:101]
    v_pk_mul_f32 v[54:55], v[54:55], v[102:103]
    v_cvt_pk_bf16_f32 v40, v40, v41
    v_cvt_pk_bf16_f32 v41, v42, v43
    v_cvt_pk_bf16_f32 v42, v44, v45
    v_cvt_pk_bf16_f32 v43, v46, v47
    v_cvt_pk_bf16_f32 v44, v48, v49
    v_cvt_pk_bf16_f32 v45, v50, v51
    v_cvt_pk_bf16_f32 v46, v52, v53
    v_cvt_pk_bf16_f32 v47, v54, v55
    buffer_store_dwordx4 v[40:43], v10, s[32:35], s41 offen offset:0 sc1
    buffer_store_dwordx4 v[44:47], v10, s[32:35], s41 offen offset:1024 sc1
    v_pk_mul_f32 v[88:89], v[56:57], v[56:57]
    v_pk_mul_f32 v[90:91], v[58:59], v[58:59]
    v_pk_mul_f32 v[92:93], v[60:61], v[60:61]
    v_pk_mul_f32 v[94:95], v[62:63], v[62:63]
    v_pk_mul_f32 v[96:97], v[64:65], v[64:65]
    v_pk_mul_f32 v[98:99], v[66:67], v[66:67]
    v_pk_mul_f32 v[100:101], v[68:69], v[68:69]
    v_pk_mul_f32 v[102:103], v[70:71], v[70:71]
    v_pk_fma_f32 v[88:89], v[88:89], v[120:121], v[120:121] op_sel:[0,1,0] op_sel_hi:[1,1,0]
    v_pk_fma_f32 v[90:91], v[90:91], v[120:121], v[120:121] op_sel:[0,1,0] op_sel_hi:[1,1,0]
    v_pk_fma_f32 v[92:93], v[92:93], v[120:121], v[120:121] op_sel:[0,1,0] op_sel_hi:[1,1,0]
    v_pk_fma_f32 v[94:95], v[94:95], v[120:121], v[120:121] op_sel:[0,1,0] op_sel_hi:[1,1,0]
    v_pk_fma_f32 v[96:97], v[96:97], v[120:121], v[120:121] op_sel:[0,1,0] op_sel_hi:[1,1,0]
    v_pk_fma_f32 v[98:99], v[98:99], v[120:121], v[120:121] op_sel:[0,1,0] op_sel_hi:[1,1,0]
    v_pk_fma_f32 v[100:101], v[100:101], v[120:121], v[120:121] op_sel:[0,1,0] op_sel_hi:[1,1,0]
    v_pk_fma_f32 v[102:103], v[102:103], v[120:121], v[120:121] op_sel:[0,1,0] op_sel_hi:[1,1,0]
    v_pk_mul_f32 v[88:89], v[88:89], v[56:57]
    v_pk_mul_f32 v[90:91], v[90:91], v[58:59]
    v_pk_mul_f32 v[92:93], v[92:93], v[60:61]
    v_pk_mul_f32 v[94:95], v[94:95], v[62:63]
    v_pk_mul_f32 v[96:97], v[96:97], v[64:65]
    v_pk_mul_f32 v[98:99], v[98:99], v[66:67]
    v_pk_mul_f32 v[100:101], v[100:101], v[68:69]
    v_pk_mul_f32 v[102:103], v[102:103], v[70:71]
    v_exp_f32 v88, v88
    v_exp_f32 v89, v89
    v_exp_f32 v90, v90
    v_exp_f32 v91, v91
    v_exp_f32 v92, v92
    v_exp_f32 v93, v93
    v_exp_f32 v94, v94
    v_exp_f32 v95, v95
    v_exp_f32 v96, v96
    v_exp_f32 v97, v97
    v_exp_f32 v98, v98
    v_exp_f32 v99, v99
    v_exp_f32 v100, v100
    v_exp_f32 v101, v101
    v_exp_f32 v102, v102
    v_exp_f32 v103, v103
    v_pk_fma_f32 v[88:89], v[88:89], v[122:123], v[122:123] op_sel:[0,0,0] op_sel_hi:[1,0,0]
    v_pk_fma_f32 v[90:91], v[90:91], v[122:123], v[122:123] op_sel:[0,0,0] op_sel_hi:[1,0,0]
    v_pk_fma_f32 v[92:93], v[92:93], v[122:123], v[122:123] op_sel:[0,0,0] op_sel_hi:[1,0,0]
    v_pk_fma_f32 v[94:95], v[94:95], v[122:123], v[122:123] op_sel:[0,0,0] op_sel_hi:[1,0,0]
    v_pk_fma_f32 v[96:97], v[96:97], v[122:123], v[122:123] op_sel:[0,0,0] op_sel_hi:[1,0,0]
    v_pk_fma_f32 v[98:99], v[98:99], v[122:123], v[122:123] op_sel:[0,0,0] op_sel_hi:[1,0,0]
    v_pk_fma_f32 v[100:101], v[100:101], v[122:123], v[122:123] op_sel:[0,0,0] op_sel_hi:[1,0,0]
    v_pk_fma_f32 v[102:103], v[102:103], v[122:123], v[122:123] op_sel:[0,0,0] op_sel_hi:[1,0,0]
    v_rcp_f32 v88, v88
    v_rcp_f32 v89, v89
    v_rcp_f32 v90, v90
    v_rcp_f32 v91, v91
    v_rcp_f32 v92, v92
    v_rcp_f32 v93, v93
    v_rcp_f32 v94, v94
    v_rcp_f32 v95, v95
    v_rcp_f32 v96, v96
    v_rcp_f32 v97, v97
    v_rcp_f32 v98, v98
    v_rcp_f32 v99, v99
    v_rcp_f32 v100, v100
    v_rcp_f32 v101, v101
    v_rcp_f32 v102, v102
    v_rcp_f32 v103, v103
    v_pk_mul_f32 v[56:57], v[56:57], v[88:89]
    v_pk_mul_f32 v[58:59], v[58:59], v[90:91]
    v_pk_mul_f32 v[60:61], v[60:61], v[92:93]
    v_pk_mul_f32 v[62:63], v[62:63], v[94:95]
    v_pk_mul_f32 v[64:65], v[64:65], v[96:97]
    v_pk_mul_f32 v[66:67], v[66:67], v[98:99]
    v_pk_mul_f32 v[68:69], v[68:69], v[100:101]
    v_pk_mul_f32 v[70:71], v[70:71], v[102:103]
    v_cvt_pk_bf16_f32 v56, v56, v57
    v_cvt_pk_bf16_f32 v57, v58, v59
    v_cvt_pk_bf16_f32 v58, v60, v61
    v_cvt_pk_bf16_f32 v59, v62, v63
    v_cvt_pk_bf16_f32 v60, v64, v65
    v_cvt_pk_bf16_f32 v61, v66, v67
    v_cvt_pk_bf16_f32 v62, v68, v69
    v_cvt_pk_bf16_f32 v63, v70, v71
    buffer_store_dwordx4 v[56:59], v10, s[32:35], s40 offen offset:2048 sc1
    buffer_store_dwordx4 v[60:63], v10, s[32:35], s40 offen offset:3072 sc1
    v_pk_mul_f32 v[88:89], v[72:73], v[72:73]
    v_pk_mul_f32 v[90:91], v[74:75], v[74:75]
    v_pk_mul_f32 v[92:93], v[76:77], v[76:77]
    v_pk_mul_f32 v[94:95], v[78:79], v[78:79]
    v_pk_mul_f32 v[96:97], v[80:81], v[80:81]
    v_pk_mul_f32 v[98:99], v[82:83], v[82:83]
    v_pk_mul_f32 v[100:101], v[84:85], v[84:85]
    v_pk_mul_f32 v[102:103], v[86:87], v[86:87]
    v_pk_fma_f32 v[88:89], v[88:89], v[124:125], v[124:125] op_sel:[0,1,0] op_sel_hi:[1,1,0]
    v_pk_fma_f32 v[90:91], v[90:91], v[124:125], v[124:125] op_sel:[0,1,0] op_sel_hi:[1,1,0]
    v_pk_fma_f32 v[92:93], v[92:93], v[124:125], v[124:125] op_sel:[0,1,0] op_sel_hi:[1,1,0]
    v_pk_fma_f32 v[94:95], v[94:95], v[124:125], v[124:125] op_sel:[0,1,0] op_sel_hi:[1,1,0]
    v_pk_fma_f32 v[96:97], v[96:97], v[124:125], v[124:125] op_sel:[0,1,0] op_sel_hi:[1,1,0]
    v_pk_fma_f32 v[98:99], v[98:99], v[124:125], v[124:125] op_sel:[0,1,0] op_sel_hi:[1,1,0]
    v_pk_fma_f32 v[100:101], v[100:101], v[124:125], v[124:125] op_sel:[0,1,0] op_sel_hi:[1,1,0]
    v_pk_fma_f32 v[102:103], v[102:103], v[124:125], v[124:125] op_sel:[0,1,0] op_sel_hi:[1,1,0]
    v_pk_mul_f32 v[88:89], v[88:89], v[72:73]
    v_pk_mul_f32 v[90:91], v[90:91], v[74:75]
    v_pk_mul_f32 v[92:93], v[92:93], v[76:77]
    v_pk_mul_f32 v[94:95], v[94:95], v[78:79]
    v_pk_mul_f32 v[96:97], v[96:97], v[80:81]
    v_pk_mul_f32 v[98:99], v[98:99], v[82:83]
    v_pk_mul_f32 v[100:101], v[100:101], v[84:85]
    v_pk_mul_f32 v[102:103], v[102:103], v[86:87]
    v_exp_f32 v88, v88
    v_exp_f32 v89, v89
    v_exp_f32 v90, v90
    v_exp_f32 v91, v91
    v_exp_f32 v92, v92
    v_exp_f32 v93, v93
    v_exp_f32 v94, v94
    v_exp_f32 v95, v95
    v_exp_f32 v96, v96
    v_exp_f32 v97, v97
    v_exp_f32 v98, v98
    v_exp_f32 v99, v99
    v_exp_f32 v100, v100
    v_exp_f32 v101, v101
    v_exp_f32 v102, v102
    v_exp_f32 v103, v103
    v_pk_fma_f32 v[88:89], v[88:89], v[126:127], v[126:127] op_sel:[0,0,0] op_sel_hi:[1,0,0]
    v_pk_fma_f32 v[90:91], v[90:91], v[126:127], v[126:127] op_sel:[0,0,0] op_sel_hi:[1,0,0]
    v_pk_fma_f32 v[92:93], v[92:93], v[126:127], v[126:127] op_sel:[0,0,0] op_sel_hi:[1,0,0]
    v_pk_fma_f32 v[94:95], v[94:95], v[126:127], v[126:127] op_sel:[0,0,0] op_sel_hi:[1,0,0]
    v_pk_fma_f32 v[96:97], v[96:97], v[126:127], v[126:127] op_sel:[0,0,0] op_sel_hi:[1,0,0]
    v_pk_fma_f32 v[98:99], v[98:99], v[126:127], v[126:127] op_sel:[0,0,0] op_sel_hi:[1,0,0]
    v_pk_fma_f32 v[100:101], v[100:101], v[126:127], v[126:127] op_sel:[0,0,0] op_sel_hi:[1,0,0]
    v_pk_fma_f32 v[102:103], v[102:103], v[126:127], v[126:127] op_sel:[0,0,0] op_sel_hi:[1,0,0]
    v_rcp_f32 v88, v88
    v_rcp_f32 v89, v89
    v_rcp_f32 v90, v90
    v_rcp_f32 v91, v91
    v_rcp_f32 v92, v92
    v_rcp_f32 v93, v93
    v_rcp_f32 v94, v94
    v_rcp_f32 v95, v95
    v_rcp_f32 v96, v96
    v_rcp_f32 v97, v97
    v_rcp_f32 v98, v98
    v_rcp_f32 v99, v99
    v_rcp_f32 v100, v100
    v_rcp_f32 v101, v101
    v_rcp_f32 v102, v102
    v_rcp_f32 v103, v103
    v_pk_mul_f32 v[72:73], v[72:73], v[88:89]
    v_pk_mul_f32 v[74:75], v[74:75], v[90:91]
    v_pk_mul_f32 v[76:77], v[76:77], v[92:93]
    v_pk_mul_f32 v[78:79], v[78:79], v[94:95]
    v_pk_mul_f32 v[80:81], v[80:81], v[96:97]
    v_pk_mul_f32 v[82:83], v[82:83], v[98:99]
    v_pk_mul_f32 v[84:85], v[84:85], v[100:101]
    v_pk_mul_f32 v[86:87], v[86:87], v[102:103]
    v_cvt_pk_bf16_f32 v72, v72, v73
    v_cvt_pk_bf16_f32 v73, v74, v75
    v_cvt_pk_bf16_f32 v74, v76, v77
    v_cvt_pk_bf16_f32 v75, v78, v79
    v_cvt_pk_bf16_f32 v76, v80, v81
    v_cvt_pk_bf16_f32 v77, v82, v83
    v_cvt_pk_bf16_f32 v78, v84, v85
    v_cvt_pk_bf16_f32 v79, v86, v87
    buffer_store_dwordx4 v[72:75], v10, s[32:35], s41 offen offset:2048 sc1
    buffer_store_dwordx4 v[76:79], v10, s[32:35], s41 offen offset:3072 sc1
    s_barrier
    s_lshl_b32 s38, s61, 6
    s_add_u32 s38, s38, s62
    s_lshl_b32 s38, s38, 2
    s_add_u32 s38, s38, 25169920
    s_waitcnt vmcnt(0)
    v_mov_b32 v2, 1
    v_mov_b32 v3, 4096
    s_mov_b64 exec, 1
    ds_add_rtn_u32 v4, v3, v2
    s_waitcnt lgkmcnt(0)
    v_readfirstlane_b32 s42, v4
    v_mov_b32 v3, 0
    s_cmp_lg_u32 s42, 3
    s_cbranch_scc1 wgp_30
    buffer_store_dword v2, v3, s[32:35], s38 offen sc1
wgp_30:
    s_mov_b64 exec, -1
    s_barrier
    s_lshl_b32 s40, s47, 12
    v_add_u32 v17, s40, v10
    v_add_u32 v18, 0x10000, v17
    v_bfe_u32 v16, v1, 2, 2
    v_and_b32 v2, 3, v1
    v_lshlrev_b32 v2, 3, v2
    v_bfe_u32 v3, v1, 4, 1
    v_lshl_add_u32 v15, v3, 5, v2
    v_lshl_add_u32 v3, v11, 2, v16
    v_lshl_add_u32 v4, v3, 7, v15
    v_lshrrev_b32 v2, 1, v16
    v_xor_b32 v2, s46, v2
    v_lshl_add_u32 v19, v2, 6, v4
    v_add_u32 v20, 0x10000, v19
k2_c5_29:
    s_barrier
    s_lshl_b32 s40, s51, 5
    s_add_u32 s40, s40, s52
    s_lshl_b32 s40, s40, 10
    s_add_u32 s40, s40, 8388608
    buffer_load_dwordx4 v[120:123], v10, s[32:35], s40 offen offset:0
    buffer_load_dwordx4 v[124:127], v10, s[32:35], s40 offen offset:1024
    s_lshl_b32 s40, s51, 13
    s_add_u32 s40, s40, 24117248
    v_lshlrev_b32 v2, 7, v11
    v_lshl_add_u32 v2, v12, 8, v2
    buffer_load_dwordx4 v[56:59], v2, s[32:35], s40 offen offset:0
    buffer_load_dwordx4 v[60:63], v2, s[32:35], s40 offen offset:16
    buffer_load_dwordx4 v[64:67], v2, s[32:35], s40 offen offset:32
    buffer_load_dwordx4 v[68:71], v2, s[32:35], s40 offen offset:48
    buffer_load_dwordx4 v[72:75], v2, s[32:35], s40 offen offset:64
    buffer_load_dwordx4 v[76:79], v2, s[32:35], s40 offen offset:80
    buffer_load_dwordx4 v[80:83], v2, s[32:35], s40 offen offset:96
    buffer_load_dwordx4 v[84:87], v2, s[32:35], s40 offen offset:112
    ds_read_b128 v[88:91], v17 offset:0
    ds_read_b64_tr_b16 v[104:105], v19 offset:8192
    ds_read_b64_tr_b16 v[106:107], v19 offset:9216
    ds_read_b128 v[92:95], v17 offset:1024
    ds_read_b64_tr_b16 v[108:109], v19 offset:10240
    ds_read_b64_tr_b16 v[110:111], v19 offset:11264
    ds_read_b128 v[96:99], v17 offset:2048
    ds_read_b64_tr_b16 v[112:113], v19 offset:12288
    ds_read_b64_tr_b16 v[114:115], v19 offset:13312
    ds_read_b128 v[100:103], v17 offset:3072
    ds_read_b64_tr_b16 v[116:117], v19 offset:14336
    ds_read_b64_tr_b16 v[118:119], v19 offset:15360
    s_waitcnt lgkmcnt(9)
    v_mfma_f32_32x32x16_bf16 v[40:55], v[104:107], v[88:91], 0
    s_barrier
    ds_read_b128 v[88:91], v17 offset:16384
    ds_read_b64_tr_b16 v[104:105], v19 offset:24576
    ds_read_b64_tr_b16 v[106:107], v19 offset:25600
    s_waitcnt lgkmcnt(9)
    v_mfma_f32_32x32x16_bf16 v[40:55], v[108:111], v[92:95], v[40:55]
    ds_read_b128 v[92:95], v17 offset:17408
    ds_read_b64_tr_b16 v[108:109], v19 offset:26624
    ds_read_b64_tr_b16 v[110:111], v19 offset:27648
    s_waitcnt lgkmcnt(9)
    v_mfma_f32_32x32x16_bf16 v[40:55], v[112:115], v[96:99], v[40:55]
    ds_read_b128 v[96:99], v17 offset:18432
    ds_read_b64_tr_b16 v[112:113], v19 offset:28672
    ds_read_b64_tr_b16 v[114:115], v19 offset:29696
    s_waitcnt lgkmcnt(9)
    v_mfma_f32_32x32x16_bf16 v[40:55], v[116:119], v[100:103], v[40:55]
    ds_read_b128 v[100:103], v17 offset:19456
    ds_read_b64_tr_b16 v[116:117], v19 offset:30720
    ds_read_b64_tr_b16 v[118:119], v19 offset:31744
    s_waitcnt lgkmcnt(9)
    v_mfma_f32_32x32x16_bf16 v[40:55], v[104:107], v[88:91], v[40:55]
    s_barrier
    ds_read_b128 v[88:91], v17 offset:32768
    ds_read_b64_tr_b16 v[104:105], v19 offset:40960
    ds_read_b64_tr_b16 v[106:107], v19 offset:41984
    s_waitcnt lgkmcnt(9)
    v_mfma_f32_32x32x16_bf16 v[40:55], v[108:111], v[92:95], v[40:55]
    ds_read_b128 v[92:95], v17 offset:33792
    ds_read_b64_tr_b16 v[108:109], v19 offset:43008
    ds_read_b64_tr_b16 v[110:111], v19 offset:44032
    s_waitcnt lgkmcnt(9)
    v_mfma_f32_32x32x16_bf16 v[40:55], v[112:115], v[96:99], v[40:55]
    ds_read_b128 v[96:99], v17 offset:34816
    ds_read_b64_tr_b16 v[112:113], v19 offset:45056
    ds_read_b64_tr_b16 v[114:115], v19 offset:46080
    s_waitcnt lgkmcnt(9)
    v_mfma_f32_32x32x16_bf16 v[40:55], v[116:119], v[100:103], v[40:55]
    ds_read_b128 v[100:103], v17 offset:35840
    ds_read_b64_tr_b16 v[116:117], v19 offset:47104
    ds_read_b64_tr_b16 v[118:119], v19 offset:48128
    s_waitcnt lgkmcnt(9)
    v_mfma_f32_32x32x16_bf16 v[40:55], v[104:107], v[88:91], v[40:55]
    s_barrier
    ds_read_b128 v[88:91], v17 offset:49152
    ds_read_b64_tr_b16 v[104:105], v19 offset:57344
    ds_read_b64_tr_b16 v[106:107], v19 offset:58368
    s_waitcnt lgkmcnt(9)
    v_mfma_f32_32x32x16_bf16 v[40:55], v[108:111], v[92:95], v[40:55]
    ds_read_b128 v[92:95], v17 offset:50176
    ds_read_b64_tr_b16 v[108:109], v19 offset:59392
    ds_read_b64_tr_b16 v[110:111], v19 offset:60416
    s_waitcnt lgkmcnt(9)
    v_mfma_f32_32x32x16_bf16 v[40:55], v[112:115], v[96:99], v[40:55]
    ds_read_b128 v[96:99], v17 offset:51200
    ds_read_b64_tr_b16 v[112:113], v19 offset:61440
    ds_read_b64_tr_b16 v[114:115], v19 offset:62464
    s_waitcnt lgkmcnt(9)
    v_mfma_f32_32x32x16_bf16 v[40:55], v[116:119], v[100:103], v[40:55]
    ds_read_b128 v[100:103], v17 offset:52224
    ds_read_b64_tr_b16 v[116:117], v19 offset:63488
    ds_read_b64_tr_b16 v[118:119], v19 offset:64512
    s_waitcnt lgkmcnt(9)
    v_mfma_f32_32x32x16_bf16 v[40:55], v[104:107], v[88:91], v[40:55]
    s_barrier
    ds_read_b128 v[88:91], v18 offset:0
    ds_read_b64_tr_b16 v[104:105], v20 offset:8192
    ds_read_b64_tr_b16 v[106:107], v20 offset:9216
    s_waitcnt lgkmcnt(9)
    v_mfma_f32_32x32x16_bf16 v[40:55], v[108:111], v[92:95], v[40:55]
    ds_read_b128 v[92:95], v18 offset:1024
    ds_read_b64_tr_b16 v[108:109], v20 offset:10240
    ds_read_b64_tr_b16 v[110:111], v20 offset:11264
    s_waitcnt lgkmcnt(9)
    v_mfma_f32_32x32x16_bf16 v[40:55], v[112:115], v[96:99], v[40:55]
    ds_read_b128 v[96:99], v18 offset:2048
    ds_read_b64_tr_b16 v[112:113], v20 offset:12288
    ds_read_b64_tr_b16 v[114:115], v20 offset:13312
    s_waitcnt lgkmcnt(9)
    v_mfma_f32_32x32x16_bf16 v[40:55], v[116:119], v[100:103], v[40:55]
    ds_read_b128 v[100:103], v18 offset:3072
    ds_read_b64_tr_b16 v[116:117], v20 offset:14336
    ds_read_b64_tr_b16 v[118:119], v20 offset:15360
    s_waitcnt lgkmcnt(9)
    v_mfma_f32_32x32x16_bf16 v[40:55], v[104:107], v[88:91], v[40:55]
    s_barrier
    ds_read_b128 v[88:91], v17 offset:0
    ds_read_b64_tr_b16 v[104:105], v19 offset:8192
    ds_read_b64_tr_b16 v[106:107], v19 offset:9216
    s_waitcnt lgkmcnt(9)
    v_mfma_f32_32x32x16_bf16 v[40:55], v[108:111], v[92:95], v[40:55]
    ds_read_b128 v[92:95], v17 offset:1024
    ds_read_b64_tr_b16 v[108:109], v19 offset:10240
    ds_read_b64_tr_b16 v[110:111], v19 offset:11264
    s_waitcnt lgkmcnt(9)
    v_mfma_f32_32x32x16_bf16 v[40:55], v[112:115], v[96:99], v[40:55]
    ds_read_b128 v[96:99], v17 offset:2048
    ds_read_b64_tr_b16 v[112:113], v19 offset:12288
    ds_read_b64_tr_b16 v[114:115], v19 offset:13312
    s_waitcnt lgkmcnt(9)
    v_mfma_f32_32x32x16_bf16 v[40:55], v[116:119], v[100:103], v[40:55]
    ds_read_b128 v[100:103], v17 offset:3072
    ds_read_b64_tr_b16 v[116:117], v19 offset:14336
    ds_read_b64_tr_b16 v[118:119], v19 offset:15360
    s_waitcnt lgkmcnt(9)
    v_mfma_f32_32x32x16_bf16 v[40:55], v[104:107], v[88:91], v[40:55]
    s_barrier
    ds_read_b128 v[88:91], v17 offset:16384
    ds_read_b64_tr_b16 v[104:105], v19 offset:24576
    ds_read_b64_tr_b16 v[106:107], v19 offset:25600
    s_waitcnt lgkmcnt(9)
    v_mfma_f32_32x32x16_bf16 v[40:55], v[108:111], v[92:95], v[40:55]
    ds_read_b128 v[92:95], v17 offset:17408
    ds_read_b64_tr_b16 v[108:109], v19 offset:26624
    ds_read_b64_tr_b16 v[110:111], v19 offset:27648
    s_waitcnt lgkmcnt(9)
    v_mfma_f32_32x32x16_bf16 v[40:55], v[112:115], v[96:99], v[40:55]
    ds_read_b128 v[96:99], v17 offset:18432
    ds_read_b64_tr_b16 v[112:113], v19 offset:28672
    ds_read_b64_tr_b16 v[114:115], v19 offset:29696
    s_waitcnt lgkmcnt(9)
    v_mfma_f32_32x32x16_bf16 v[40:55], v[116:119], v[100:103], v[40:55]
    ds_read_b128 v[100:103], v17 offset:19456
    ds_read_b64_tr_b16 v[116:117], v19 offset:30720
    ds_read_b64_tr_b16 v[118:119], v19 offset:31744
    s_waitcnt lgkmcnt(9)
    v_mfma_f32_32x32x16_bf16 v[40:55], v[104:107], v[88:91], v[40:55]
    s_barrier
    ds_read_b128 v[88:91], v17 offset:32768
    ds_read_b64_tr_b16 v[104:105], v19 offset:40960
    ds_read_b64_tr_b16 v[106:107], v19 offset:41984
    s_waitcnt lgkmcnt(9)
    v_mfma_f32_32x32x16_bf16 v[40:55], v[108:111], v[92:95], v[40:55]
    ds_read_b128 v[92:95], v17 offset:33792
    ds_read_b64_tr_b16 v[108:109], v19 offset:43008
    ds_read_b64_tr_b16 v[110:111], v19 offset:44032
    s_waitcnt lgkmcnt(9)
    v_mfma_f32_32x32x16_bf16 v[40:55], v[112:115], v[96:99], v[40:55]
    ds_read_b128 v[96:99], v17 offset:34816
    ds_read_b64_tr_b16 v[112:113], v19 offset:45056
    ds_read_b64_tr_b16 v[114:115], v19 offset:46080
    s_waitcnt lgkmcnt(9)
    v_mfma_f32_32x32x16_bf16 v[40:55], v[116:119], v[100:103], v[40:55]
    ds_read_b128 v[100:103], v17 offset:35840
    ds_read_b64_tr_b16 v[116:117], v19 offset:47104
    ds_read_b64_tr_b16 v[118:119], v19 offset:48128
    s_waitcnt lgkmcnt(9)
    v_mfma_f32_32x32x16_bf16 v[40:55], v[104:107], v[88:91], v[40:55]
    s_barrier
    ds_read_b128 v[88:91], v17 offset:49152
    ds_read_b64_tr_b16 v[104:105], v19 offset:57344
    ds_read_b64_tr_b16 v[106:107], v19 offset:58368
    s_waitcnt lgkmcnt(9)
    v_mfma_f32_32x32x16_bf16 v[40:55], v[108:111], v[92:95], v[40:55]
    ds_read_b128 v[92:95], v17 offset:50176
    ds_read_b64_tr_b16 v[108:109], v19 offset:59392
    ds_read_b64_tr_b16 v[110:111], v19 offset:60416
    s_waitcnt lgkmcnt(9)
    v_mfma_f32_32x32x16_bf16 v[40:55], v[112:115], v[96:99], v[40:55]
    ds_read_b128 v[96:99], v17 offset:51200
    ds_read_b64_tr_b16 v[112:113], v19 offset:61440
    ds_read_b64_tr_b16 v[114:115], v19 offset:62464
    s_waitcnt lgkmcnt(9)
    v_mfma_f32_32x32x16_bf16 v[40:55], v[116:119], v[100:103], v[40:55]
    ds_read_b128 v[100:103], v17 offset:52224
    ds_read_b64_tr_b16 v[116:117], v19 offset:63488
    ds_read_b64_tr_b16 v[118:119], v19 offset:64512
    s_waitcnt lgkmcnt(9)
    v_mfma_f32_32x32x16_bf16 v[40:55], v[104:107], v[88:91], v[40:55]
    s_barrier
    ds_read_b128 v[88:91], v18 offset:0
    ds_read_b64_tr_b16 v[104:105], v20 offset:8192
    ds_read_b64_tr_b16 v[106:107], v20 offset:9216
    s_waitcnt lgkmcnt(9)
    v_mfma_f32_32x32x16_bf16 v[40:55], v[108:111], v[92:95], v[40:55]
    ds_read_b128 v[92:95], v18 offset:1024
    ds_read_b64_tr_b16 v[108:109], v20 offset:10240
    ds_read_b64_tr_b16 v[110:111], v20 offset:11264
    s_waitcnt lgkmcnt(9)
    v_mfma_f32_32x32x16_bf16 v[40:55], v[112:115], v[96:99], v[40:55]
    ds_read_b128 v[96:99], v18 offset:2048
    ds_read_b64_tr_b16 v[112:113], v20 offset:12288
    ds_read_b64_tr_b16 v[114:115], v20 offset:13312
    s_waitcnt lgkmcnt(9)
    v_mfma_f32_32x32x16_bf16 v[40:55], v[116:119], v[100:103], v[40:55]
    ds_read_b128 v[100:103], v18 offset:3072
    ds_read_b64_tr_b16 v[116:117], v20 offset:14336
    ds_read_b64_tr_b16 v[118:119], v20 offset:15360
    s_waitcnt lgkmcnt(9)
    v_mfma_f32_32x32x16_bf16 v[40:55], v[104:107], v[88:91], v[40:55]
    s_barrier
    ds_read_b128 v[88:91], v17 offset:0
    ds_read_b64_tr_b16 v[104:105], v19 offset:8192
    ds_read_b64_tr_b16 v[106:107], v19 offset:9216
    s_waitcnt lgkmcnt(9)
    v_mfma_f32_32x32x16_bf16 v[40:55], v[108:111], v[92:95], v[40:55]
    ds_read_b128 v[92:95], v17 offset:1024
    ds_read_b64_tr_b16 v[108:109], v19 offset:10240
    ds_read_b64_tr_b16 v[110:111], v19 offset:11264
    s_waitcnt lgkmcnt(9)
    v_mfma_f32_32x32x16_bf16 v[40:55], v[112:115], v[96:99], v[40:55]
    ds_read_b128 v[96:99], v17 offset:2048
    ds_read_b64_tr_b16 v[112:113], v19 offset:12288
    ds_read_b64_tr_b16 v[114:115], v19 offset:13312
    s_waitcnt lgkmcnt(9)
    v_mfma_f32_32x32x16_bf16 v[40:55], v[116:119], v[100:103], v[40:55]
    ds_read_b128 v[100:103], v17 offset:3072
    ds_read_b64_tr_b16 v[116:117], v19 offset:14336
    ds_read_b64_tr_b16 v[118:119], v19 offset:15360
    s_waitcnt lgkmcnt(9)
    v_mfma_f32_32x32x16_bf16 v[40:55], v[104:107], v[88:91], v[40:55]
    s_barrier
    ds_read_b128 v[88:91], v17 offset:16384
    ds_read_b64_tr_b16 v[104:105], v19 offset:24576
    ds_read_b64_tr_b16 v[106:107], v19 offset:25600
    s_waitcnt lgkmcnt(9)
    v_mfma_f32_32x32x16_bf16 v[40:55], v[108:111], v[92:95], v[40:55]
    ds_read_b128 v[92:95], v17 offset:17408
    ds_read_b64_tr_b16 v[108:109], v19 offset:26624
    ds_read_b64_tr_b16 v[110:111], v19 offset:27648
    s_waitcnt lgkmcnt(9)
    v_mfma_f32_32x32x16_bf16 v[40:55], v[112:115], v[96:99], v[40:55]
    ds_read_b128 v[96:99], v17 offset:18432
    ds_read_b64_tr_b16 v[112:113], v19 offset:28672
    ds_read_b64_tr_b16 v[114:115], v19 offset:29696
    s_waitcnt lgkmcnt(9)
    v_mfma_f32_32x32x16_bf16 v[40:55], v[116:119], v[100:103], v[40:55]
    ds_read_b128 v[100:103], v17 offset:19456
    ds_read_b64_tr_b16 v[116:117], v19 offset:30720
    ds_read_b64_tr_b16 v[118:119], v19 offset:31744
    s_waitcnt lgkmcnt(9)
    v_mfma_f32_32x32x16_bf16 v[40:55], v[104:107], v[88:91], v[40:55]
    s_barrier
    ds_read_b128 v[88:91], v17 offset:32768
    ds_read_b64_tr_b16 v[104:105], v19 offset:40960
    ds_read_b64_tr_b16 v[106:107], v19 offset:41984
    s_waitcnt lgkmcnt(9)
    v_mfma_f32_32x32x16_bf16 v[40:55], v[108:111], v[92:95], v[40:55]
    ds_read_b128 v[92:95], v17 offset:33792
    ds_read_b64_tr_b16 v[108:109], v19 offset:43008
    ds_read_b64_tr_b16 v[110:111], v19 offset:44032
    s_waitcnt lgkmcnt(9)
    v_mfma_f32_32x32x16_bf16 v[40:55], v[112:115], v[96:99], v[40:55]
    ds_read_b128 v[96:99], v17 offset:34816
    ds_read_b64_tr_b16 v[112:113], v19 offset:45056
    ds_read_b64_tr_b16 v[114:115], v19 offset:46080
    s_waitcnt lgkmcnt(9)
    v_mfma_f32_32x32x16_bf16 v[40:55], v[116:119], v[100:103], v[40:55]
    ds_read_b128 v[100:103], v17 offset:35840
    ds_read_b64_tr_b16 v[116:117], v19 offset:47104
    ds_read_b64_tr_b16 v[118:119], v19 offset:48128
    s_waitcnt lgkmcnt(9)
    v_mfma_f32_32x32x16_bf16 v[40:55], v[104:107], v[88:91], v[40:55]
    s_barrier
    ds_read_b128 v[88:91], v17 offset:49152
    ds_read_b64_tr_b16 v[104:105], v19 offset:57344
    ds_read_b64_tr_b16 v[106:107], v19 offset:58368
    s_waitcnt lgkmcnt(9)
    v_mfma_f32_32x32x16_bf16 v[40:55], v[108:111], v[92:95], v[40:55]
    ds_read_b128 v[92:95], v17 offset:50176
    ds_read_b64_tr_b16 v[108:109], v19 offset:59392
    ds_read_b64_tr_b16 v[110:111], v19 offset:60416
    s_waitcnt lgkmcnt(9)
    v_mfma_f32_32x32x16_bf16 v[40:55], v[112:115], v[96:99], v[40:55]
    ds_read_b128 v[96:99], v17 offset:51200
    ds_read_b64_tr_b16 v[112:113], v19 offset:61440
    ds_read_b64_tr_b16 v[114:115], v19 offset:62464
    s_waitcnt lgkmcnt(9)
    v_mfma_f32_32x32x16_bf16 v[40:55], v[116:119], v[100:103], v[40:55]
    ds_read_b128 v[100:103], v17 offset:52224
    ds_read_b64_tr_b16 v[116:117], v19 offset:63488
    ds_read_b64_tr_b16 v[118:119], v19 offset:64512
    s_waitcnt lgkmcnt(9)
    v_mfma_f32_32x32x16_bf16 v[40:55], v[104:107], v[88:91], v[40:55]
    s_barrier
    ds_read_b128 v[88:91], v18 offset:0
    ds_read_b64_tr_b16 v[104:105], v20 offset:8192
    ds_read_b64_tr_b16 v[106:107], v20 offset:9216
    s_waitcnt lgkmcnt(9)
    v_mfma_f32_32x32x16_bf16 v[40:55], v[108:111], v[92:95], v[40:55]
    ds_read_b128 v[92:95], v18 offset:1024
    ds_read_b64_tr_b16 v[108:109], v20 offset:10240
    ds_read_b64_tr_b16 v[110:111], v20 offset:11264
    s_waitcnt lgkmcnt(9)
    v_mfma_f32_32x32x16_bf16 v[40:55], v[112:115], v[96:99], v[40:55]
    ds_read_b128 v[96:99], v18 offset:2048
    ds_read_b64_tr_b16 v[112:113], v20 offset:12288
    ds_read_b64_tr_b16 v[114:115], v20 offset:13312
    s_waitcnt lgkmcnt(9)
    v_mfma_f32_32x32x16_bf16 v[40:55], v[116:119], v[100:103], v[40:55]
    ds_read_b128 v[100:103], v18 offset:3072
    ds_read_b64_tr_b16 v[116:117], v20 offset:14336
    ds_read_b64_tr_b16 v[118:119], v20 offset:15360
    s_waitcnt lgkmcnt(9)
    v_mfma_f32_32x32x16_bf16 v[40:55], v[104:107], v[88:91], v[40:55]
    s_barrier
    ds_read_b128 v[88:91], v17 offset:0
    ds_read_b64_tr_b16 v[104:105], v19 offset:8192
    ds_read_b64_tr_b16 v[106:107], v19 offset:9216
    s_waitcnt lgkmcnt(9)
    v_mfma_f32_32x32x16_bf16 v[40:55], v[108:111], v[92:95], v[40:55]
    ds_read_b128 v[92:95], v17 offset:1024
    ds_read_b64_tr_b16 v[108:109], v19 offset:10240
    ds_read_b64_tr_b16 v[110:111], v19 offset:11264
    s_waitcnt lgkmcnt(9)
    v_mfma_f32_32x32x16_bf16 v[40:55], v[112:115], v[96:99], v[40:55]
    ds_read_b128 v[96:99], v17 offset:2048
    ds_read_b64_tr_b16 v[112:113], v19 offset:12288
    ds_read_b64_tr_b16 v[114:115], v19 offset:13312
    s_waitcnt lgkmcnt(9)
    v_mfma_f32_32x32x16_bf16 v[40:55], v[116:119], v[100:103], v[40:55]
    ds_read_b128 v[100:103], v17 offset:3072
    ds_read_b64_tr_b16 v[116:117], v19 offset:14336
    ds_read_b64_tr_b16 v[118:119], v19 offset:15360
    s_waitcnt lgkmcnt(9)
    v_mfma_f32_32x32x16_bf16 v[40:55], v[104:107], v[88:91], v[40:55]
    s_barrier
    ds_read_b128 v[88:91], v17 offset:16384
    ds_read_b64_tr_b16 v[104:105], v19 offset:24576
    ds_read_b64_tr_b16 v[106:107], v19 offset:25600
    s_waitcnt lgkmcnt(9)
    v_mfma_f32_32x32x16_bf16 v[40:55], v[108:111], v[92:95], v[40:55]
    ds_read_b128 v[92:95], v17 offset:17408
    ds_read_b64_tr_b16 v[108:109], v19 offset:26624
    ds_read_b64_tr_b16 v[110:111], v19 offset:27648
    s_waitcnt lgkmcnt(9)
    v_mfma_f32_32x32x16_bf16 v[40:55], v[112:115], v[96:99], v[40:55]
    ds_read_b128 v[96:99], v17 offset:18432
    ds_read_b64_tr_b16 v[112:113], v19 offset:28672
    ds_read_b64_tr_b16 v[114:115], v19 offset:29696
    s_waitcnt lgkmcnt(9)
    v_mfma_f32_32x32x16_bf16 v[40:55], v[116:119], v[100:103], v[40:55]
    ds_read_b128 v[100:103], v17 offset:19456
    ds_read_b64_tr_b16 v[116:117], v19 offset:30720
    ds_read_b64_tr_b16 v[118:119], v19 offset:31744
    s_waitcnt lgkmcnt(9)
    v_mfma_f32_32x32x16_bf16 v[40:55], v[104:107], v[88:91], v[40:55]
    s_barrier
    ds_read_b128 v[88:91], v17 offset:32768
    ds_read_b64_tr_b16 v[104:105], v19 offset:40960
    ds_read_b64_tr_b16 v[106:107], v19 offset:41984
    s_waitcnt lgkmcnt(9)
    v_mfma_f32_32x32x16_bf16 v[40:55], v[108:111], v[92:95], v[40:55]
    ds_read_b128 v[92:95], v17 offset:33792
    ds_read_b64_tr_b16 v[108:109], v19 offset:43008
    ds_read_b64_tr_b16 v[110:111], v19 offset:44032
    s_waitcnt lgkmcnt(9)
    v_mfma_f32_32x32x16_bf16 v[40:55], v[112:115], v[96:99], v[40:55]
    ds_read_b128 v[96:99], v17 offset:34816
    ds_read_b64_tr_b16 v[112:113], v19 offset:45056
    ds_read_b64_tr_b16 v[114:115], v19 offset:46080
    s_waitcnt lgkmcnt(9)
    v_mfma_f32_32x32x16_bf16 v[40:55], v[116:119], v[100:103], v[40:55]
    ds_read_b128 v[100:103], v17 offset:35840
    ds_read_b64_tr_b16 v[116:117], v19 offset:47104
    ds_read_b64_tr_b16 v[118:119], v19 offset:48128
    s_waitcnt lgkmcnt(9)
    v_mfma_f32_32x32x16_bf16 v[40:55], v[104:107], v[88:91], v[40:55]
    s_barrier
    ds_read_b128 v[88:91], v17 offset:49152
    ds_read_b64_tr_b16 v[104:105], v19 offset:57344
    ds_read_b64_tr_b16 v[106:107], v19 offset:58368
    s_waitcnt lgkmcnt(9)
    v_mfma_f32_32x32x16_bf16 v[40:55], v[108:111], v[92:95], v[40:55]
    ds_read_b128 v[92:95], v17 offset:50176
    ds_read_b64_tr_b16 v[108:109], v19 offset:59392
    ds_read_b64_tr_b16 v[110:111], v19 offset:60416
    s_waitcnt lgkmcnt(9)
    v_mfma_f32_32x32x16_bf16 v[40:55], v[112:115], v[96:99], v[40:55]
    ds_read_b128 v[96:99], v17 offset:51200
    ds_read_b64_tr_b16 v[112:113], v19 offset:61440
    ds_read_b64_tr_b16 v[114:115], v19 offset:62464
    s_waitcnt lgkmcnt(9)
    v_mfma_f32_32x32x16_bf16 v[40:55], v[116:119], v[100:103], v[40:55]
    ds_read_b128 v[100:103], v17 offset:52224
    ds_read_b64_tr_b16 v[116:117], v19 offset:63488
    ds_read_b64_tr_b16 v[118:119], v19 offset:64512
    s_waitcnt lgkmcnt(9)
    v_mfma_f32_32x32x16_bf16 v[40:55], v[104:107], v[88:91], v[40:55]
    s_barrier
    ds_read_b128 v[88:91], v18 offset:0
    ds_read_b64_tr_b16 v[104:105], v20 offset:8192
    ds_read_b64_tr_b16 v[106:107], v20 offset:9216
    s_waitcnt lgkmcnt(9)
    v_mfma_f32_32x32x16_bf16 v[40:55], v[108:111], v[92:95], v[40:55]
    ds_read_b128 v[92:95], v18 offset:1024
    ds_read_b64_tr_b16 v[108:109], v20 offset:10240
    ds_read_b64_tr_b16 v[110:111], v20 offset:11264
    s_waitcnt lgkmcnt(9)
    v_mfma_f32_32x32x16_bf16 v[40:55], v[112:115], v[96:99], v[40:55]
    ds_read_b128 v[96:99], v18 offset:2048
    ds_read_b64_tr_b16 v[112:113], v20 offset:12288
    ds_read_b64_tr_b16 v[114:115], v20 offset:13312
    s_waitcnt lgkmcnt(9)
    v_mfma_f32_32x32x16_bf16 v[40:55], v[116:119], v[100:103], v[40:55]
    ds_read_b128 v[100:103], v18 offset:3072
    ds_read_b64_tr_b16 v[116:117], v20 offset:14336
    ds_read_b64_tr_b16 v[118:119], v20 offset:15360
    s_waitcnt lgkmcnt(9)
    v_mfma_f32_32x32x16_bf16 v[40:55], v[104:107], v[88:91], v[40:55]
    s_barrier
    ds_read_b128 v[88:91], v17 offset:0
    ds_read_b64_tr_b16 v[104:105], v19 offset:8192
    ds_read_b64_tr_b16 v[106:107], v19 offset:9216
    s_waitcnt lgkmcnt(9)
    v_mfma_f32_32x32x16_bf16 v[40:55], v[108:111], v[92:95], v[40:55]
    ds_read_b128 v[92:95], v17 offset:1024
    ds_read_b64_tr_b16 v[108:109], v19 offset:10240
    ds_read_b64_tr_b16 v[110:111], v19 offset:11264
    s_waitcnt lgkmcnt(9)
    v_mfma_f32_32x32x16_bf16 v[40:55], v[112:115], v[96:99], v[40:55]
    ds_read_b128 v[96:99], v17 offset:2048
    ds_read_b64_tr_b16 v[112:113], v19 offset:12288
    ds_read_b64_tr_b16 v[114:115], v19 offset:13312
    s_waitcnt lgkmcnt(9)
    v_mfma_f32_32x32x16_bf16 v[40:55], v[116:119], v[100:103], v[40:55]
    ds_read_b128 v[100:103], v17 offset:3072
    ds_read_b64_tr_b16 v[116:117], v19 offset:14336
    ds_read_b64_tr_b16 v[118:119], v19 offset:15360
    s_waitcnt lgkmcnt(9)
    v_mfma_f32_32x32x16_bf16 v[40:55], v[104:107], v[88:91], v[40:55]
    s_barrier
    ds_read_b128 v[88:91], v17 offset:16384
    ds_read_b64_tr_b16 v[104:105], v19 offset:24576
    ds_read_b64_tr_b16 v[106:107], v19 offset:25600
    s_waitcnt lgkmcnt(9)
    v_mfma_f32_32x32x16_bf16 v[40:55], v[108:111], v[92:95], v[40:55]
    ds_read_b128 v[92:95], v17 offset:17408
    ds_read_b64_tr_b16 v[108:109], v19 offset:26624
    ds_read_b64_tr_b16 v[110:111], v19 offset:27648
    s_waitcnt lgkmcnt(9)
    v_mfma_f32_32x32x16_bf16 v[40:55], v[112:115], v[96:99], v[40:55]
    ds_read_b128 v[96:99], v17 offset:18432
    ds_read_b64_tr_b16 v[112:113], v19 offset:28672
    ds_read_b64_tr_b16 v[114:115], v19 offset:29696
    s_waitcnt lgkmcnt(9)
    v_mfma_f32_32x32x16_bf16 v[40:55], v[116:119], v[100:103], v[40:55]
    ds_read_b128 v[100:103], v17 offset:19456
    ds_read_b64_tr_b16 v[116:117], v19 offset:30720
    ds_read_b64_tr_b16 v[118:119], v19 offset:31744
    s_waitcnt lgkmcnt(9)
    v_mfma_f32_32x32x16_bf16 v[40:55], v[104:107], v[88:91], v[40:55]
    s_barrier
    ds_read_b128 v[88:91], v17 offset:32768
    ds_read_b64_tr_b16 v[104:105], v19 offset:40960
    ds_read_b64_tr_b16 v[106:107], v19 offset:41984
    s_waitcnt lgkmcnt(9)
    v_mfma_f32_32x32x16_bf16 v[40:55], v[108:111], v[92:95], v[40:55]
    ds_read_b128 v[92:95], v17 offset:33792
    ds_read_b64_tr_b16 v[108:109], v19 offset:43008
    ds_read_b64_tr_b16 v[110:111], v19 offset:44032
    s_waitcnt lgkmcnt(9)
    v_mfma_f32_32x32x16_bf16 v[40:55], v[112:115], v[96:99], v[40:55]
    ds_read_b128 v[96:99], v17 offset:34816
    ds_read_b64_tr_b16 v[112:113], v19 offset:45056
    ds_read_b64_tr_b16 v[114:115], v19 offset:46080
    s_waitcnt lgkmcnt(9)
    v_mfma_f32_32x32x16_bf16 v[40:55], v[116:119], v[100:103], v[40:55]
    ds_read_b128 v[100:103], v17 offset:35840
    ds_read_b64_tr_b16 v[116:117], v19 offset:47104
    ds_read_b64_tr_b16 v[118:119], v19 offset:48128
    s_waitcnt lgkmcnt(9)
    v_mfma_f32_32x32x16_bf16 v[40:55], v[104:107], v[88:91], v[40:55]
    s_barrier
    ds_read_b128 v[88:91], v17 offset:49152
    ds_read_b64_tr_b16 v[104:105], v19 offset:57344
    ds_read_b64_tr_b16 v[106:107], v19 offset:58368
    s_waitcnt lgkmcnt(9)
    v_mfma_f32_32x32x16_bf16 v[40:55], v[108:111], v[92:95], v[40:55]
    ds_read_b128 v[92:95], v17 offset:50176
    ds_read_b64_tr_b16 v[108:109], v19 offset:59392
    ds_read_b64_tr_b16 v[110:111], v19 offset:60416
    s_waitcnt lgkmcnt(9)
    v_mfma_f32_32x32x16_bf16 v[40:55], v[112:115], v[96:99], v[40:55]
    ds_read_b128 v[96:99], v17 offset:51200
    ds_read_b64_tr_b16 v[112:113], v19 offset:61440
    ds_read_b64_tr_b16 v[114:115], v19 offset:62464
    s_waitcnt lgkmcnt(9)
    v_mfma_f32_32x32x16_bf16 v[40:55], v[116:119], v[100:103], v[40:55]
    ds_read_b128 v[100:103], v17 offset:52224
    ds_read_b64_tr_b16 v[116:117], v19 offset:63488
    ds_read_b64_tr_b16 v[118:119], v19 offset:64512
    s_waitcnt lgkmcnt(9)
    v_mfma_f32_32x32x16_bf16 v[40:55], v[104:107], v[88:91], v[40:55]
    s_barrier
    ds_read_b128 v[88:91], v18 offset:0
    ds_read_b64_tr_b16 v[104:105], v20 offset:8192
    ds_read_b64_tr_b16 v[106:107], v20 offset:9216
    s_waitcnt lgkmcnt(9)
    v_mfma_f32_32x32x16_bf16 v[40:55], v[108:111], v[92:95], v[40:55]
    ds_read_b128 v[92:95], v18 offset:1024
    ds_read_b64_tr_b16 v[108:109], v20 offset:10240
    ds_read_b64_tr_b16 v[110:111], v20 offset:11264
    s_waitcnt lgkmcnt(9)
    v_mfma_f32_32x32x16_bf16 v[40:55], v[112:115], v[96:99], v[40:55]
    ds_read_b128 v[96:99], v18 offset:2048
    ds_read_b64_tr_b16 v[112:113], v20 offset:12288
    ds_read_b64_tr_b16 v[114:115], v20 offset:13312
    s_waitcnt lgkmcnt(9)
    v_mfma_f32_32x32x16_bf16 v[40:55], v[116:119], v[100:103], v[40:55]
    ds_read_b128 v[100:103], v18 offset:3072
    ds_read_b64_tr_b16 v[116:117], v20 offset:14336
    ds_read_b64_tr_b16 v[118:119], v20 offset:15360
    s_waitcnt lgkmcnt(9)
    v_mfma_f32_32x32x16_bf16 v[40:55], v[104:107], v[88:91], v[40:55]
    s_barrier
    ds_read_b128 v[88:91], v17 offset:0
    ds_read_b64_tr_b16 v[104:105], v19 offset:8192
    ds_read_b64_tr_b16 v[106:107], v19 offset:9216
    s_waitcnt lgkmcnt(9)
    v_mfma_f32_32x32x16_bf16 v[40:55], v[108:111], v[92:95], v[40:55]
    ds_read_b128 v[92:95], v17 offset:1024
    ds_read_b64_tr_b16 v[108:109], v19 offset:10240
    ds_read_b64_tr_b16 v[110:111], v19 offset:11264
    s_waitcnt lgkmcnt(9)
    v_mfma_f32_32x32x16_bf16 v[40:55], v[112:115], v[96:99], v[40:55]
    ds_read_b128 v[96:99], v17 offset:2048
    ds_read_b64_tr_b16 v[112:113], v19 offset:12288
    ds_read_b64_tr_b16 v[114:115], v19 offset:13312
    s_waitcnt lgkmcnt(9)
    v_mfma_f32_32x32x16_bf16 v[40:55], v[116:119], v[100:103], v[40:55]
    ds_read_b128 v[100:103], v17 offset:3072
    ds_read_b64_tr_b16 v[116:117], v19 offset:14336
    ds_read_b64_tr_b16 v[118:119], v19 offset:15360
    s_waitcnt lgkmcnt(9)
    v_mfma_f32_32x32x16_bf16 v[40:55], v[104:107], v[88:91], v[40:55]
    s_barrier
    ds_read_b128 v[88:91], v17 offset:16384
    ds_read_b64_tr_b16 v[104:105], v19 offset:24576
    ds_read_b64_tr_b16 v[106:107], v19 offset:25600
    s_waitcnt lgkmcnt(9)
    v_mfma_f32_32x32x16_bf16 v[40:55], v[108:111], v[92:95], v[40:55]
    ds_read_b128 v[92:95], v17 offset:17408
    ds_read_b64_tr_b16 v[108:109], v19 offset:26624
    ds_read_b64_tr_b16 v[110:111], v19 offset:27648
    s_waitcnt lgkmcnt(9)
    v_mfma_f32_32x32x16_bf16 v[40:55], v[112:115], v[96:99], v[40:55]
    ds_read_b128 v[96:99], v17 offset:18432
    ds_read_b64_tr_b16 v[112:113], v19 offset:28672
    ds_read_b64_tr_b16 v[114:115], v19 offset:29696
    s_waitcnt lgkmcnt(9)
    v_mfma_f32_32x32x16_bf16 v[40:55], v[116:119], v[100:103], v[40:55]
    ds_read_b128 v[100:103], v17 offset:19456
    ds_read_b64_tr_b16 v[116:117], v19 offset:30720
    ds_read_b64_tr_b16 v[118:119], v19 offset:31744
    s_waitcnt lgkmcnt(9)
    v_mfma_f32_32x32x16_bf16 v[40:55], v[104:107], v[88:91], v[40:55]
    s_barrier
    ds_read_b128 v[88:91], v17 offset:32768
    ds_read_b64_tr_b16 v[104:105], v19 offset:40960
    ds_read_b64_tr_b16 v[106:107], v19 offset:41984
    s_waitcnt lgkmcnt(9)
    v_mfma_f32_32x32x16_bf16 v[40:55], v[108:111], v[92:95], v[40:55]
    ds_read_b128 v[92:95], v17 offset:33792
    ds_read_b64_tr_b16 v[108:109], v19 offset:43008
    ds_read_b64_tr_b16 v[110:111], v19 offset:44032
    s_waitcnt lgkmcnt(9)
    v_mfma_f32_32x32x16_bf16 v[40:55], v[112:115], v[96:99], v[40:55]
    ds_read_b128 v[96:99], v17 offset:34816
    ds_read_b64_tr_b16 v[112:113], v19 offset:45056
    ds_read_b64_tr_b16 v[114:115], v19 offset:46080
    s_waitcnt lgkmcnt(9)
    v_mfma_f32_32x32x16_bf16 v[40:55], v[116:119], v[100:103], v[40:55]
    ds_read_b128 v[100:103], v17 offset:35840
    ds_read_b64_tr_b16 v[116:117], v19 offset:47104
    ds_read_b64_tr_b16 v[118:119], v19 offset:48128
    s_waitcnt lgkmcnt(9)
    v_mfma_f32_32x32x16_bf16 v[40:55], v[104:107], v[88:91], v[40:55]
    s_waitcnt lgkmcnt(6)
    v_mfma_f32_32x32x16_bf16 v[40:55], v[108:111], v[92:95], v[40:55]
    s_waitcnt lgkmcnt(3)
    v_mfma_f32_32x32x16_bf16 v[40:55], v[112:115], v[96:99], v[40:55]
    s_waitcnt lgkmcnt(0)
    v_mfma_f32_32x32x16_bf16 v[40:55], v[116:119], v[100:103], v[40:55]
    s_barrier
    s_waitcnt vmcnt(0)
    v_add_f32 v58, v58, v62
    v_add_f32 v66, v66, v70
    v_add_f32 v74, v74, v78
    v_add_f32 v82, v82, v86
    v_add_f32 v58, v58, v66
    v_add_f32 v74, v74, v82
    v_add_f32 v8, v58, v74
    v_mov_b32 v4, v8
    s_nop 1
    v_permlane32_swap_b32 v4, v8
    v_add_f32 v8, v8, v4
    v_mul_f32 v8, 0xbfb8aa3b, v8
    v_exp_f32 v8, v8
    s_nop 0
    v_add_f32 v8, 1.0, v8
    v_rcp_f32 v8, v8
    s_nop 0
    v_sub_f32 v9, 1.0, v8
    v_lshlrev_b32 v24, 16, v120
    v_and_b32 v25, 0xffff0000, v120
    v_lshlrev_b32 v26, 16, v121
    v_and_b32 v27, 0xffff0000, v121
    v_lshlrev_b32 v28, 16, v122
    v_and_b32 v29, 0xffff0000, v122
    v_lshlrev_b32 v30, 16, v123
    v_and_b32 v31, 0xffff0000, v123
    v_lshlrev_b32 v32, 16, v124
    v_and_b32 v33, 0xffff0000, v124
    v_lshlrev_b32 v34, 16, v125
    v_and_b32 v35, 0xffff0000, v125
    v_lshlrev_b32 v36, 16, v126
    v_and_b32 v37, 0xffff0000, v126
    v_lshlrev_b32 v38, 16, v127
    v_and_b32 v39, 0xffff0000, v127
    s_lshl_b32 s44, s52, 5
    s_lshl_b32 s64, s51, 15
    s_add_u32 s64, s64, s44
    v_lshlrev_b32 v6, 4, v11
    v_lshl_add_u32 v6, v12, 10, v6
    s_nop 7
    v_pk_add_f32 v[40:41], v[40:41], v[24:25]
    v_pk_add_f32 v[42:43], v[42:43], v[26:27]
    v_pk_add_f32 v[44:45], v[44:45], v[28:29]
    v_pk_add_f32 v[46:47], v[46:47], v[30:31]
    v_pk_add_f32 v[48:49], v[48:49], v[32:33]
    v_pk_add_f32 v[50:51], v[50:51], v[34:35]
    v_pk_add_f32 v[52:53], v[52:53], v[36:37]
    v_pk_add_f32 v[54:55], v[54:55], v[38:39]
    v_pk_mul_f32 v[40:41], v[40:41], v[8:9] op_sel:[0,1] op_sel_hi:[1,1]
    v_pk_mul_f32 v[42:43], v[42:43], v[8:9] op_sel:[0,1] op_sel_hi:[1,1]
    v_pk_mul_f32 v[44:45], v[44:45], v[8:9] op_sel:[0,1] op_sel_hi:[1,1]
    v_pk_mul_f32 v[46:47], v[46:47], v[8:9] op_sel:[0,1] op_sel_hi:[1,1]
    v_pk_mul_f32 v[48:49], v[48:49], v[8:9] op_sel:[0,1] op_sel_hi:[1,1]
    v_pk_mul_f32 v[50:51], v[50:51], v[8:9] op_sel:[0,1] op_sel_hi:[1,1]
    v_pk_mul_f32 v[52:53], v[52:53], v[8:9] op_sel:[0,1] op_sel_hi:[1,1]
    v_pk_mul_f32 v[54:55], v[54:55], v[8:9] op_sel:[0,1] op_sel_hi:[1,1]
    s_barrier
    ds_read_b128 v[88:91], v17 offset:0
    ds_read_b64_tr_b16 v[104:105], v19 offset:8192
    ds_read_b64_tr_b16 v[106:107], v19 offset:9216
    ds_read_b128 v[92:95], v17 offset:1024
    ds_read_b64_tr_b16 v[108:109], v19 offset:10240
    ds_read_b64_tr_b16 v[110:111], v19 offset:11264
    ds_read_b128 v[96:99], v17 offset:2048
    ds_read_b64_tr_b16 v[112:113], v19 offset:12288
    ds_read_b64_tr_b16 v[114:115], v19 offset:13312
    ds_read_b128 v[100:103], v17 offset:3072
    ds_read_b64_tr_b16 v[116:117], v19 offset:14336
    ds_read_b64_tr_b16 v[118:119], v19 offset:15360
    s_waitcnt lgkmcnt(9)
    v_mfma_f32_32x32x16_bf16 v[24:39], v[104:107], v[88:91], 0
    s_barrier
    ds_read_b128 v[88:91], v17 offset:16384
    ds_read_b64_tr_b16 v[104:105], v19 offset:24576
    ds_read_b64_tr_b16 v[106:107], v19 offset:25600
    s_waitcnt lgkmcnt(9)
    v_mfma_f32_32x32x16_bf16 v[24:39], v[108:111], v[92:95], v[24:39]
    ds_read_b128 v[92:95], v17 offset:17408
    ds_read_b64_tr_b16 v[108:109], v19 offset:26624
    ds_read_b64_tr_b16 v[110:111], v19 offset:27648
    s_waitcnt lgkmcnt(9)
    v_mfma_f32_32x32x16_bf16 v[24:39], v[112:115], v[96:99], v[24:39]
    ds_read_b128 v[96:99], v17 offset:18432
    ds_read_b64_tr_b16 v[112:113], v19 offset:28672
    ds_read_b64_tr_b16 v[114:115], v19 offset:29696
    s_waitcnt lgkmcnt(9)
    v_mfma_f32_32x32x16_bf16 v[24:39], v[116:119], v[100:103], v[24:39]
    ds_read_b128 v[100:103], v17 offset:19456
    ds_read_b64_tr_b16 v[116:117], v19 offset:30720
    ds_read_b64_tr_b16 v[118:119], v19 offset:31744
    s_waitcnt lgkmcnt(9)
    v_mfma_f32_32x32x16_bf16 v[24:39], v[104:107], v[88:91], v[24:39]
    s_barrier
    ds_read_b128 v[88:91], v17 offset:32768
    ds_read_b64_tr_b16 v[104:105], v19 offset:40960
    ds_read_b64_tr_b16 v[106:107], v19 offset:41984
    s_waitcnt lgkmcnt(9)
    v_mfma_f32_32x32x16_bf16 v[24:39], v[108:111], v[92:95], v[24:39]
    ds_read_b128 v[92:95], v17 offset:33792
    ds_read_b64_tr_b16 v[108:109], v19 offset:43008
    ds_read_b64_tr_b16 v[110:111], v19 offset:44032
    s_waitcnt lgkmcnt(9)
    v_mfma_f32_32x32x16_bf16 v[24:39], v[112:115], v[96:99], v[24:39]
    ds_read_b128 v[96:99], v17 offset:34816
    ds_read_b64_tr_b16 v[112:113], v19 offset:45056
    ds_read_b64_tr_b16 v[114:115], v19 offset:46080
    s_waitcnt lgkmcnt(9)
    v_mfma_f32_32x32x16_bf16 v[24:39], v[116:119], v[100:103], v[24:39]
    ds_read_b128 v[100:103], v17 offset:35840
    ds_read_b64_tr_b16 v[116:117], v19 offset:47104
    ds_read_b64_tr_b16 v[118:119], v19 offset:48128
    s_waitcnt lgkmcnt(9)
    v_mfma_f32_32x32x16_bf16 v[24:39], v[104:107], v[88:91], v[24:39]
    s_barrier
    ds_read_b128 v[88:91], v17 offset:49152
    ds_read_b64_tr_b16 v[104:105], v19 offset:57344
    ds_read_b64_tr_b16 v[106:107], v19 offset:58368
    s_waitcnt lgkmcnt(9)
    v_mfma_f32_32x32x16_bf16 v[24:39], v[108:111], v[92:95], v[24:39]
    ds_read_b128 v[92:95], v17 offset:50176
    ds_read_b64_tr_b16 v[108:109], v19 offset:59392
    ds_read_b64_tr_b16 v[110:111], v19 offset:60416
    s_waitcnt lgkmcnt(9)
    v_mfma_f32_32x32x16_bf16 v[24:39], v[112:115], v[96:99], v[24:39]
    ds_read_b128 v[96:99], v17 offset:51200
    ds_read_b64_tr_b16 v[112:113], v19 offset:61440
    ds_read_b64_tr_b16 v[114:115], v19 offset:62464
    s_waitcnt lgkmcnt(9)
    v_mfma_f32_32x32x16_bf16 v[24:39], v[116:119], v[100:103], v[24:39]
    ds_read_b128 v[100:103], v17 offset:52224
    ds_read_b64_tr_b16 v[116:117], v19 offset:63488
    ds_read_b64_tr_b16 v[118:119], v19 offset:64512
    s_waitcnt lgkmcnt(9)
    v_mfma_f32_32x32x16_bf16 v[24:39], v[104:107], v[88:91], v[24:39]
    s_barrier
    ds_read_b128 v[88:91], v18 offset:0
    ds_read_b64_tr_b16 v[104:105], v20 offset:8192
    ds_read_b64_tr_b16 v[106:107], v20 offset:9216
    s_waitcnt lgkmcnt(9)
    v_mfma_f32_32x32x16_bf16 v[24:39], v[108:111], v[92:95], v[24:39]
    ds_read_b128 v[92:95], v18 offset:1024
    ds_read_b64_tr_b16 v[108:109], v20 offset:10240
    ds_read_b64_tr_b16 v[110:111], v20 offset:11264
    s_waitcnt lgkmcnt(9)
    v_mfma_f32_32x32x16_bf16 v[24:39], v[112:115], v[96:99], v[24:39]
    ds_read_b128 v[96:99], v18 offset:2048
    ds_read_b64_tr_b16 v[112:113], v20 offset:12288
    ds_read_b64_tr_b16 v[114:115], v20 offset:13312
    s_waitcnt lgkmcnt(9)
    v_mfma_f32_32x32x16_bf16 v[24:39], v[116:119], v[100:103], v[24:39]
    ds_read_b128 v[100:103], v18 offset:3072
    ds_read_b64_tr_b16 v[116:117], v20 offset:14336
    ds_read_b64_tr_b16 v[118:119], v20 offset:15360
    s_waitcnt lgkmcnt(9)
    v_mfma_f32_32x32x16_bf16 v[24:39], v[104:107], v[88:91], v[24:39]
    s_barrier
    ds_read_b128 v[88:91], v17 offset:0
    ds_read_b64_tr_b16 v[104:105], v19 offset:8192
    ds_read_b64_tr_b16 v[106:107], v19 offset:9216
    s_waitcnt lgkmcnt(9)
    v_mfma_f32_32x32x16_bf16 v[24:39], v[108:111], v[92:95], v[24:39]
    ds_read_b128 v[92:95], v17 offset:1024
    ds_read_b64_tr_b16 v[108:109], v19 offset:10240
    ds_read_b64_tr_b16 v[110:111], v19 offset:11264
    s_waitcnt lgkmcnt(9)
    v_mfma_f32_32x32x16_bf16 v[24:39], v[112:115], v[96:99], v[24:39]
    ds_read_b128 v[96:99], v17 offset:2048
    ds_read_b64_tr_b16 v[112:113], v19 offset:12288
    ds_read_b64_tr_b16 v[114:115], v19 offset:13312
    s_waitcnt lgkmcnt(9)
    v_mfma_f32_32x32x16_bf16 v[24:39], v[116:119], v[100:103], v[24:39]
    ds_read_b128 v[100:103], v17 offset:3072
    ds_read_b64_tr_b16 v[116:117], v19 offset:14336
    ds_read_b64_tr_b16 v[118:119], v19 offset:15360
    s_waitcnt lgkmcnt(9)
    v_mfma_f32_32x32x16_bf16 v[24:39], v[104:107], v[88:91], v[24:39]
    s_barrier
    ds_read_b128 v[88:91], v17 offset:16384
    ds_read_b64_tr_b16 v[104:105], v19 offset:24576
    ds_read_b64_tr_b16 v[106:107], v19 offset:25600
    s_waitcnt lgkmcnt(9)
    v_mfma_f32_32x32x16_bf16 v[24:39], v[108:111], v[92:95], v[24:39]
    ds_read_b128 v[92:95], v17 offset:17408
    ds_read_b64_tr_b16 v[108:109], v19 offset:26624
    ds_read_b64_tr_b16 v[110:111], v19 offset:27648
    s_waitcnt lgkmcnt(9)
    v_mfma_f32_32x32x16_bf16 v[24:39], v[112:115], v[96:99], v[24:39]
    ds_read_b128 v[96:99], v17 offset:18432
    ds_read_b64_tr_b16 v[112:113], v19 offset:28672
    ds_read_b64_tr_b16 v[114:115], v19 offset:29696
    s_waitcnt lgkmcnt(9)
    v_mfma_f32_32x32x16_bf16 v[24:39], v[116:119], v[100:103], v[24:39]
    ds_read_b128 v[100:103], v17 offset:19456
    ds_read_b64_tr_b16 v[116:117], v19 offset:30720
    ds_read_b64_tr_b16 v[118:119], v19 offset:31744
    s_waitcnt lgkmcnt(9)
    v_mfma_f32_32x32x16_bf16 v[24:39], v[104:107], v[88:91], v[24:39]
    s_barrier
    ds_read_b128 v[88:91], v17 offset:32768
    ds_read_b64_tr_b16 v[104:105], v19 offset:40960
    ds_read_b64_tr_b16 v[106:107], v19 offset:41984
    s_waitcnt lgkmcnt(9)
    v_mfma_f32_32x32x16_bf16 v[24:39], v[108:111], v[92:95], v[24:39]
    ds_read_b128 v[92:95], v17 offset:33792
    ds_read_b64_tr_b16 v[108:109], v19 offset:43008
    ds_read_b64_tr_b16 v[110:111], v19 offset:44032
    s_waitcnt lgkmcnt(9)
    v_mfma_f32_32x32x16_bf16 v[24:39], v[112:115], v[96:99], v[24:39]
    ds_read_b128 v[96:99], v17 offset:34816
    ds_read_b64_tr_b16 v[112:113], v19 offset:45056
    ds_read_b64_tr_b16 v[114:115], v19 offset:46080
    s_waitcnt lgkmcnt(9)
    v_mfma_f32_32x32x16_bf16 v[24:39], v[116:119], v[100:103], v[24:39]
    ds_read_b128 v[100:103], v17 offset:35840
    ds_read_b64_tr_b16 v[116:117], v19 offset:47104
    ds_read_b64_tr_b16 v[118:119], v19 offset:48128
    s_waitcnt lgkmcnt(9)
    v_mfma_f32_32x32x16_bf16 v[24:39], v[104:107], v[88:91], v[24:39]
    s_waitcnt lgkmcnt(6)
    v_mfma_f32_32x32x16_bf16 v[24:39], v[108:111], v[92:95], v[24:39]
    s_waitcnt lgkmcnt(3)
    v_mfma_f32_32x32x16_bf16 v[24:39], v[112:115], v[96:99], v[24:39]
    s_waitcnt lgkmcnt(0)
    v_mfma_f32_32x32x16_bf16 v[24:39], v[116:119], v[100:103], v[24:39]
    s_nop 7
    s_nop 3
    v_pk_fma_f32 v[24:25], v[24:25], v[8:9], v[40:41] op_sel_hi:[1,0,1]
    v_pk_fma_f32 v[26:27], v[26:27], v[8:9], v[42:43] op_sel_hi:[1,0,1]
    v_pk_fma_f32 v[28:29], v[28:29], v[8:9], v[44:45] op_sel_hi:[1,0,1]
    v_pk_fma_f32 v[30:31], v[30:31], v[8:9], v[46:47] op_sel_hi:[1,0,1]
    v_pk_fma_f32 v[32:33], v[32:33], v[8:9], v[48:49] op_sel_hi:[1,0,1]
    v_pk_fma_f32 v[34:35], v[34:35], v[8:9], v[50:51] op_sel_hi:[1,0,1]
    v_pk_fma_f32 v[36:37], v[36:37], v[8:9], v[52:53] op_sel_hi:[1,0,1]
    v_pk_fma_f32 v[38:39], v[38:39], v[8:9], v[54:55] op_sel_hi:[1,0,1]
    v_cvt_pk_bf16_f32 v56, v24, v25
    v_cvt_pk_bf16_f32 v57, v26, v27
    v_cvt_pk_bf16_f32 v58, v28, v29
    v_cvt_pk_bf16_f32 v59, v30, v31
    v_cvt_pk_bf16_f32 v60, v32, v33
    v_cvt_pk_bf16_f32 v61, v34, v35
    v_cvt_pk_bf16_f32 v62, v36, v37
    v_cvt_pk_bf16_f32 v63, v38, v39
    s_nop 1
    v_permlane32_swap_b32 v56, v58
    v_permlane32_swap_b32 v57, v59
    buffer_store_dwordx4 v[56:59], v6, s[28:31], s64 offen offset:0
    v_permlane32_swap_b32 v60, v62
    v_permlane32_swap_b32 v61, v63
    buffer_store_dwordx4 v[60:63], v6, s[28:31], s64 offen offset:32
    s_branch k2_kernel_end_20
k2_prod_27:
    s_lshl_b32 s65, s47, 12
    v_lshlrev_b32 v23, 2, v1
    s_cmp_ge_u32 s39, 2
    s_cbranch_scc1 k2_wp_31
    s_lshl_b32 s43, s48, 1
    s_add_u32 s43, s43, s47
    s_lshl_b32 s54, s43, 15
    s_add_u32 s54, s54, 6258688
    v_lshlrev_b32 v4, 9, v11
    v_add_u32 v2, 31, v12
    v_lshrrev_b32 v3, 5, v2
    v_lshl_add_u32 v3, v3, 15, v4
    v_and_b32 v2, 31, v2
    v_lshl_add_u32 v24, v2, 4, v3
    v_add_u32 v2, 33, v12
    v_lshrrev_b32 v3, 5, v2
    v_lshl_add_u32 v3, v3, 15, v4
    v_and_b32 v2, 31, v2
    v_lshl_add_u32 v25, v2, 4, v3
    v_add_u32 v2, 30, v12
    v_lshrrev_b32 v3, 5, v2
    v_lshl_add_u32 v3, v3, 15, v4
    v_and_b32 v2, 31, v2
    v_lshl_add_u32 v26, v2, 4, v3
    v_add_u32 v2, 34, v12
    v_lshrrev_b32 v3, 5, v2
    v_lshl_add_u32 v3, v3, 15, v4
    v_and_b32 v2, 31, v2
    v_lshl_add_u32 v27, v2, 4, v3
    s_cmp_eq_u32 s43, 63
    s_cbranch_scc1 g3_hi_33
    s_cmp_lg_u32 s43, 0
    s_cbranch_scc1 g3_nb_32
    v_mov_b32 v2, 0x7f000000
    v_cmp_gt_u32 vcc, 1, v12
    s_nop 1
    v_cndmask_b32 v24, v24, v2, vcc
    v_cmp_gt_u32 vcc, 2, v12
    s_nop 1
    v_cndmask_b32 v26, v26, v2, vcc
    s_branch g3_nb_32
g3_hi_33:
    v_mov_b32 v2, 0x7f000000
    v_cmp_lt_u32 vcc, 30, v12
    s_nop 1
    v_cndmask_b32 v25, v25, v2, vcc
    v_cmp_lt_u32 vcc, 29, v12
    s_nop 1
    v_cndmask_b32 v27, v27, v2, vcc
g3_nb_32:
    s_add_u32 m0, s65, 0
    s_nop 0
    buffer_load_dwordx4 v24, s[32:35], s54 offen offset:0 lds
    buffer_load_dwordx4 v24, s[32:35], s54 offen offset:1024 lds
    buffer_load_dwordx4 v24, s[32:35], s54 offen offset:2048 lds
    buffer_load_dwordx4 v24, s[32:35], s54 offen offset:3072 lds
    s_add_u32 s54, s54, 4096
    s_add_u32 m0, s65, 16384
    s_nop 0
    buffer_load_dwordx4 v24, s[32:35], s54 offen offset:0 lds
    buffer_load_dwordx4 v24, s[32:35], s54 offen offset:1024 lds
    buffer_load_dwordx4 v24, s[32:35], s54 offen offset:2048 lds
    buffer_load_dwordx4 v24, s[32:35], s54 offen offset:3072 lds
    s_add_u32 s54, s54, 4096
    s_add_u32 m0, s65, 32768
    s_nop 0
    buffer_load_dwordx4 v25, s[32:35], s54 offen offset:0 lds
    buffer_load_dwordx4 v25, s[32:35], s54 offen offset:1024 lds
    buffer_load_dwordx4 v25, s[32:35], s54 offen offset:2048 lds
    buffer_load_dwordx4 v25, s[32:35], s54 offen offset:3072 lds
    s_add_u32 s54, s54, 4096
    s_add_u32 m0, s65, 49152
    s_nop 0
    buffer_load_dwordx4 v25, s[32:35], s54 offen offset:0 lds
    buffer_load_dwordx4 v25, s[32:35], s54 offen offset:1024 lds
    buffer_load_dwordx4 v25, s[32:35], s54 offen offset:2048 lds
    buffer_load_dwordx4 v25, s[32:35], s54 offen offset:3072 lds
    s_add_u32 s54, s54, 4096
    s_add_u32 m0, s65, 65536
    s_nop 0
    buffer_load_dwordx4 v26, s[32:35], s54 offen offset:0 lds
    buffer_load_dwordx4 v26, s[32:35], s54 offen offset:1024 lds
    buffer_load_dwordx4 v26, s[32:35], s54 offen offset:2048 lds
    buffer_load_dwordx4 v26, s[32:35], s54 offen offset:3072 lds
    s_add_u32 s54, s54, 4096
    s_waitcnt vmcnt(16)
    s_barrier
    s_waitcnt vmcnt(12)
    s_barrier
    s_waitcnt vmcnt(8)
    s_barrier
    s_add_u32 m0, s65, 0
    s_nop 0
    buffer_load_dwordx4 v26, s[32:35], s54 offen offset:0 lds
    buffer_load_dwordx4 v26, s[32:35], s54 offen offset:1024 lds
    buffer_load_dwordx4 v26, s[32:35], s54 offen offset:2048 lds
    buffer_load_dwordx4 v26, s[32:35], s54 offen offset:3072 lds
    s_add_u32 s54, s54, 4096
    s_waitcnt vmcnt(8)
    s_barrier
    s_add_u32 m0, s65, 16384
    s_nop 0
    buffer_load_dwordx4 v27, s[32:35], s54 offen offset:0 lds
    buffer_load_dwordx4 v27, s[32:35], s54 offen offset:1024 lds
    buffer_load_dwordx4 v27, s[32:35], s54 offen offset:2048 lds
    buffer_load_dwordx4 v27, s[32:35], s54 offen offset:3072 lds
    s_add_u32 s54, s54, 4096
    s_waitcnt vmcnt(8)
    s_barrier
    s_add_u32 m0, s65, 32768
    s_nop 0
    buffer_load_dwordx4 v27, s[32:35], s54 offen offset:0 lds
    buffer_load_dwordx4 v27, s[32:35], s54 offen offset:1024 lds
    buffer_load_dwordx4 v27, s[32:35], s54 offen offset:2048 lds
    buffer_load_dwordx4 v27, s[32:35], s54 offen offset:3072 lds
    s_add_u32 s54, s54, 4096
    s_waitcnt vmcnt(8)
    s_barrier
    s_waitcnt vmcnt(4)
    s_barrier
    s_waitcnt vmcnt(0)
    s_barrier
    v_add_u32 v28, 30720, v10
    s_barrier
    s_barrier
    s_cmp_ge_u32 s63, 28
    s_cbranch_scc1 k2_x5_34
    s_and_b32 s42, s63, 1
    s_lshl_b32 s42, s42, 3
    s_add_u32 s42, s42, s62
    s_and_b32 s67, s42, 15
    s_movk_i32 s59, 2048
    s_lshl_b32 s40, s61, 2
    s_lshl_b32 s41, s47, 1
    s_add_u32 s40, s40, s41
    s_lshl_b32 s40, s40, 5
    s_lshl_b32 s41, s67, 1
    s_add_u32 s40, s40, s41
    s_lshl_b32 s40, s40, 10
    s_add_u32 s54, s40, 8388608
    s_lshl_b32 s38, s61, 8
    s_add_u32 s38, s38, 25165824
    s_mov_b32 s66, 0
    s_lshr_b32 s68, s67, 1
    s_lshl_b32 s68, 0x101, s68
    s_andn2_b32 s40, s68, s66
    s_cbranch_scc0 nd_ok_35
    s_mov_b64 exec, 0xffff
    s_mov_b32 s41, 200000
nd_poll_36:
    buffer_load_dword v2, v23, s[32:35], s38 offen sc1
    s_waitcnt vmcnt(0)
    v_cmp_eq_u32 vcc, 1, v2
    s_nop 1
    s_mov_b32 s66, vcc_lo
    s_andn2_b32 s40, s68, s66
    s_cbranch_scc0 nd_go_37
    s_sleep 4
    s_sub_u32 s41, s41, 1
    s_cmp_lg_u32 s41, 0
    s_cbranch_scc1 nd_poll_36
nd_go_37:
    s_mov_b64 exec, -1
nd_ok_35:
    s_add_u32 m0, s65, 0
    s_nop 0
    buffer_load_dwordx4 v10, s[32:35], s54 offen offset:0 lds
    buffer_load_dwordx4 v10, s[32:35], s54 offen offset:1024 lds
    buffer_load_dwordx4 v28, s[32:35], s54 offen offset:2048 lds
    buffer_load_dwordx4 v28, s[32:35], s54 offen offset:3072 lds
    s_add_u32 s67, s67, 1
    s_cmp_eq_u32 s67, 16
    s_cselect_b32 s58, 0xffff8800, s59
    s_cselect_b32 s67, 0, s67
    s_add_u32 s54, s54, s58
    s_lshr_b32 s68, s67, 1
    s_lshl_b32 s68, 0x101, s68
    s_andn2_b32 s40, s68, s66
    s_cbranch_scc0 nd_ok_38
    s_mov_b64 exec, 0xffff
    s_mov_b32 s41, 200000
nd_poll_39:
    buffer_load_dword v2, v23, s[32:35], s38 offen sc1
    s_waitcnt vmcnt(0)
    v_cmp_eq_u32 vcc, 1, v2
    s_nop 1
    s_mov_b32 s66, vcc_lo
    s_andn2_b32 s40, s68, s66
    s_cbranch_scc0 nd_go_40
    s_sleep 4
    s_sub_u32 s41, s41, 1
    s_cmp_lg_u32 s41, 0
    s_cbranch_scc1 nd_poll_39
nd_go_40:
    s_mov_b64 exec, -1
nd_ok_38:
    s_add_u32 m0, s65, 16384
    s_nop 0
    buffer_load_dwordx4 v10, s[32:35], s54 offen offset:0 lds
    buffer_load_dwordx4 v10, s[32:35], s54 offen offset:1024 lds
    buffer_load_dwordx4 v28, s[32:35], s54 offen offset:2048 lds
    buffer_load_dwordx4 v28, s[32:35], s54 offen offset:3072 lds
    s_add_u32 s67, s67, 1
    s_cmp_eq_u32 s67, 16
    s_cselect_b32 s58, 0xffff8800, s59
    s_cselect_b32 s67, 0, s67
    s_add_u32 s54, s54, s58
    s_lshr_b32 s68, s67, 1
    s_lshl_b32 s68, 0x101, s68
    s_andn2_b32 s40, s68, s66
    s_cbranch_scc0 nd_ok_41
    s_mov_b64 exec, 0xffff
    s_mov_b32 s41, 200000
nd_poll_42:
    buffer_load_dword v2, v23, s[32:35], s38 offen sc1
    s_waitcnt vmcnt(0)
    v_cmp_eq_u32 vcc, 1, v2
    s_nop 1
    s_mov_b32 s66, vcc_lo
    s_andn2_b32 s40, s68, s66
    s_cbranch_scc0 nd_go_43
    s_sleep 4
    s_sub_u32 s41, s41, 1
    s_cmp_lg_u32 s41, 0
    s_cbranch_scc1 nd_poll_42
nd_go_43:
    s_mov_b64 exec, -1
nd_ok_41:
    s_add_u32 m0, s65, 32768
    s_nop 0
    buffer_load_dwordx4 v10, s[32:35], s54 offen offset:0 lds
    buffer_load_dwordx4 v10, s[32:35], s54 offen offset:1024 lds
    buffer_load_dwordx4 v28, s[32:35], s54 offen offset:2048 lds
    buffer_load_dwordx4 v28, s[32:35], s54 offen offset:3072 lds
    s_add_u32 s67, s67, 1
    s_cmp_eq_u32 s67, 16
    s_cselect_b32 s58, 0xffff8800, s59
    s_cselect_b32 s67, 0, s67
    s_add_u32 s54, s54, s58
    s_lshr_b32 s68, s67, 1
    s_lshl_b32 s68, 0x101, s68
    s_andn2_b32 s40, s68, s66
    s_cbranch_scc0 nd_ok_44
    s_mov_b64 exec, 0xffff
    s_mov_b32 s41, 200000
nd_poll_45:
    buffer_load_dword v2, v23, s[32:35], s38 offen sc1
    s_waitcnt vmcnt(0)
    v_cmp_eq_u32 vcc, 1, v2
    s_nop 1
    s_mov_b32 s66, vcc_lo
    s_andn2_b32 s40, s68, s66
    s_cbranch_scc0 nd_go_46
    s_sleep 4
    s_sub_u32 s41, s41, 1
    s_cmp_lg_u32 s41, 0
    s_cbranch_scc1 nd_poll_45
nd_go_46:
    s_mov_b64 exec, -1
nd_ok_44:
    s_add_u32 m0, s65, 49152
    s_nop 0
    buffer_load_dwordx4 v10, s[32:35], s54 offen offset:0 lds
    buffer_load_dwordx4 v10, s[32:35], s54 offen offset:1024 lds
    buffer_load_dwordx4 v28, s[32:35], s54 offen offset:2048 lds
    buffer_load_dwordx4 v28, s[32:35], s54 offen offset:3072 lds
    s_add_u32 s67, s67, 1
    s_cmp_eq_u32 s67, 16
    s_cselect_b32 s58, 0xffff8800, s59
    s_cselect_b32 s67, 0, s67
    s_add_u32 s54, s54, s58
    s_lshr_b32 s68, s67, 1
    s_lshl_b32 s68, 0x101, s68
    s_andn2_b32 s40, s68, s66
    s_cbranch_scc0 nd_ok_47
    s_mov_b64 exec, 0xffff
    s_mov_b32 s41, 200000
nd_poll_48:
    buffer_load_dword v2, v23, s[32:35], s38 offen sc1
    s_waitcnt vmcnt(0)
    v_cmp_eq_u32 vcc, 1, v2
    s_nop 1
    s_mov_b32 s66, vcc_lo
    s_andn2_b32 s40, s68, s66
    s_cbranch_scc0 nd_go_49
    s_sleep 4
    s_sub_u32 s41, s41, 1
    s_cmp_lg_u32 s41, 0
    s_cbranch_scc1 nd_poll_48
nd_go_49:
    s_mov_b64 exec, -1
nd_ok_47:
    s_add_u32 m0, s65, 65536
    s_nop 0
    buffer_load_dwordx4 v10, s[32:35], s54 offen offset:0 lds
    buffer_load_dwordx4 v10, s[32:35], s54 offen offset:1024 lds
    buffer_load_dwordx4 v28, s[32:35], s54 offen offset:2048 lds
    buffer_load_dwordx4 v28, s[32:35], s54 offen offset:3072 lds
    s_add_u32 s67, s67, 1
    s_cmp_eq_u32 s67, 16
    s_cselect_b32 s58, 0xffff8800, s59
    s_cselect_b32 s67, 0, s67
    s_add_u32 s54, s54, s58
    s_waitcnt vmcnt(16)
    s_barrier
    s_waitcnt vmcnt(12)
    s_barrier
    s_waitcnt vmcnt(8)
    s_barrier
    s_lshr_b32 s68, s67, 1
    s_lshl_b32 s68, 0x101, s68
    s_andn2_b32 s40, s68, s66
    s_cbranch_scc0 nd_ok_50
    s_mov_b64 exec, 0xffff
    s_mov_b32 s41, 200000
nd_poll_51:
    buffer_load_dword v2, v23, s[32:35], s38 offen sc1
    s_waitcnt vmcnt(0)
    v_cmp_eq_u32 vcc, 1, v2
    s_nop 1
    s_mov_b32 s66, vcc_lo
    s_andn2_b32 s40, s68, s66
    s_cbranch_scc0 nd_go_52
    s_sleep 4
    s_sub_u32 s41, s41, 1
    s_cmp_lg_u32 s41, 0
    s_cbranch_scc1 nd_poll_51
nd_go_52:
    s_mov_b64 exec, -1
nd_ok_50:
    s_add_u32 m0, s65, 0
    s_nop 0
    buffer_load_dwordx4 v10, s[32:35], s54 offen offset:0 lds
    buffer_load_dwordx4 v10, s[32:35], s54 offen offset:1024 lds
    buffer_load_dwordx4 v28, s[32:35], s54 offen offset:2048 lds
    buffer_load_dwordx4 v28, s[32:35], s54 offen offset:3072 lds
    s_add_u32 s67, s67, 1
    s_cmp_eq_u32 s67, 16
    s_cselect_b32 s58, 0xffff8800, s59
    s_cselect_b32 s67, 0, s67
    s_add_u32 s54, s54, s58
    s_waitcnt vmcnt(8)
    s_barrier
    s_lshr_b32 s68, s67, 1
    s_lshl_b32 s68, 0x101, s68
    s_andn2_b32 s40, s68, s66
    s_cbranch_scc0 nd_ok_53
    s_mov_b64 exec, 0xffff
    s_mov_b32 s41, 200000
nd_poll_54:
    buffer_load_dword v2, v23, s[32:35], s38 offen sc1
    s_waitcnt vmcnt(0)
    v_cmp_eq_u32 vcc, 1, v2
    s_nop 1
    s_mov_b32 s66, vcc_lo
    s_andn2_b32 s40, s68, s66
    s_cbranch_scc0 nd_go_55
    s_sleep 4
    s_sub_u32 s41, s41, 1
    s_cmp_lg_u32 s41, 0
    s_cbranch_scc1 nd_poll_54
nd_go_55:
    s_mov_b64 exec, -1
nd_ok_53:
    s_add_u32 m0, s65, 16384
    s_nop 0
    buffer_load_dwordx4 v10, s[32:35], s54 offen offset:0 lds
    buffer_load_dwordx4 v10, s[32:35], s54 offen offset:1024 lds
    buffer_load_dwordx4 v28, s[32:35], s54 offen offset:2048 lds
    buffer_load_dwordx4 v28, s[32:35], s54 offen offset:3072 lds
    s_add_u32 s67, s67, 1
    s_cmp_eq_u32 s67, 16
    s_cselect_b32 s58, 0xffff8800, s59
    s_cselect_b32 s67, 0, s67
    s_add_u32 s54, s54, s58
    s_waitcnt vmcnt(8)
    s_barrier
    s_lshr_b32 s68, s67, 1
    s_lshl_b32 s68, 0x101, s68
    s_andn2_b32 s40, s68, s66
    s_cbranch_scc0 nd_ok_56
    s_mov_b64 exec, 0xffff
    s_mov_b32 s41, 200000
nd_poll_57:
    buffer_load_dword v2, v23, s[32:35], s38 offen sc1
    s_waitcnt vmcnt(0)
    v_cmp_eq_u32 vcc, 1, v2
    s_nop 1
    s_mov_b32 s66, vcc_lo
    s_andn2_b32 s40, s68, s66
    s_cbranch_scc0 nd_go_58
    s_sleep 4
    s_sub_u32 s41, s41, 1
    s_cmp_lg_u32 s41, 0
    s_cbranch_scc1 nd_poll_57
nd_go_58:
    s_mov_b64 exec, -1
nd_ok_56:
    s_add_u32 m0, s65, 32768
    s_nop 0
    buffer_load_dwordx4 v10, s[32:35], s54 offen offset:0 lds
    buffer_load_dwordx4 v10, s[32:35], s54 offen offset:1024 lds
    buffer_load_dwordx4 v28, s[32:35], s54 offen offset:2048 lds
    buffer_load_dwordx4 v28, s[32:35], s54 offen offset:3072 lds
    s_add_u32 s67, s67, 1
    s_cmp_eq_u32 s67, 16
    s_cselect_b32 s58, 0xffff8800, s59
    s_cselect_b32 s67, 0, s67
    s_add_u32 s54, s54, s58
    s_waitcnt vmcnt(8)
    s_barrier
    s_lshr_b32 s68, s67, 1
    s_lshl_b32 s68, 0x101, s68
    s_andn2_b32 s40, s68, s66
    s_cbranch_scc0 nd_ok_59
    s_mov_b64 exec, 0xffff
    s_mov_b32 s41, 200000
nd_poll_60:
    buffer_load_dword v2, v23, s[32:35], s38 offen sc1
    s_waitcnt vmcnt(0)
    v_cmp_eq_u32 vcc, 1, v2
    s_nop 1
    s_mov_b32 s66, vcc_lo
    s_andn2_b32 s40, s68, s66
    s_cbranch_scc0 nd_go_61
    s_sleep 4
    s_sub_u32 s41, s41, 1
    s_cmp_lg_u32 s41, 0
    s_cbranch_scc1 nd_poll_60
nd_go_61:
    s_mov_b64 exec, -1
nd_ok_59:
    s_add_u32 m0, s65, 49152
    s_nop 0
    buffer_load_dwordx4 v10, s[32:35], s54 offen offset:0 lds
    buffer_load_dwordx4 v10, s[32:35], s54 offen offset:1024 lds
    buffer_load_dwordx4 v28, s[32:35], s54 offen offset:2048 lds
    buffer_load_dwordx4 v28, s[32:35], s54 offen offset:3072 lds
    s_add_u32 s67, s67, 1
    s_cmp_eq_u32 s67, 16
    s_cselect_b32 s58, 0xffff8800, s59
    s_cselect_b32 s67, 0, s67
    s_add_u32 s54, s54, s58
    s_waitcnt vmcnt(8)
    s_barrier
    s_lshr_b32 s68, s67, 1
    s_lshl_b32 s68, 0x101, s68
    s_andn2_b32 s40, s68, s66
    s_cbranch_scc0 nd_ok_62
    s_mov_b64 exec, 0xffff
    s_mov_b32 s41, 200000
nd_poll_63:
    buffer_load_dword v2, v23, s[32:35], s38 offen sc1
    s_waitcnt vmcnt(0)
    v_cmp_eq_u32 vcc, 1, v2
    s_nop 1
    s_mov_b32 s66, vcc_lo
    s_andn2_b32 s40, s68, s66
    s_cbranch_scc0 nd_go_64
    s_sleep 4
    s_sub_u32 s41, s41, 1
    s_cmp_lg_u32 s41, 0
    s_cbranch_scc1 nd_poll_63
nd_go_64:
    s_mov_b64 exec, -1
nd_ok_62:
    s_add_u32 m0, s65, 65536
    s_nop 0
    buffer_load_dwordx4 v10, s[32:35], s54 offen offset:0 lds
    buffer_load_dwordx4 v10, s[32:35], s54 offen offset:1024 lds
    buffer_load_dwordx4 v28, s[32:35], s54 offen offset:2048 lds
    buffer_load_dwordx4 v28, s[32:35], s54 offen offset:3072 lds
    s_add_u32 s67, s67, 1
    s_cmp_eq_u32 s67, 16
    s_cselect_b32 s58, 0xffff8800, s59
    s_cselect_b32 s67, 0, s67
    s_add_u32 s54, s54, s58
    s_waitcnt vmcnt(8)
    s_barrier
    s_lshr_b32 s68, s67, 1
    s_lshl_b32 s68, 0x101, s68
    s_andn2_b32 s40, s68, s66
    s_cbranch_scc0 nd_ok_65
    s_mov_b64 exec, 0xffff
    s_mov_b32 s41, 200000
nd_poll_66:
    buffer_load_dword v2, v23, s[32:35], s38 offen sc1
    s_waitcnt vmcnt(0)
    v_cmp_eq_u32 vcc, 1, v2
    s_nop 1
    s_mov_b32 s66, vcc_lo
    s_andn2_b32 s40, s68, s66
    s_cbranch_scc0 nd_go_67
    s_sleep 4
    s_sub_u32 s41, s41, 1
    s_cmp_lg_u32 s41, 0
    s_cbranch_scc1 nd_poll_66
nd_go_67:
    s_mov_b64 exec, -1
nd_ok_65:
    s_add_u32 m0, s65, 0
    s_nop 0
    buffer_load_dwordx4 v10, s[32:35], s54 offen offset:0 lds
    buffer_load_dwordx4 v10, s[32:35], s54 offen offset:1024 lds
    buffer_load_dwordx4 v28, s[32:35], s54 offen offset:2048 lds
    buffer_load_dwordx4 v28, s[32:35], s54 offen offset:3072 lds
    s_add_u32 s67, s67, 1
    s_cmp_eq_u32 s67, 16
    s_cselect_b32 s58, 0xffff8800, s59
    s_cselect_b32 s67, 0, s67
    s_add_u32 s54, s54, s58
    s_waitcnt vmcnt(8)
    s_barrier
    s_lshr_b32 s68, s67, 1
    s_lshl_b32 s68, 0x101, s68
    s_andn2_b32 s40, s68, s66
    s_cbranch_scc0 nd_ok_68
    s_mov_b64 exec, 0xffff
    s_mov_b32 s41, 200000
nd_poll_69:
    buffer_load_dword v2, v23, s[32:35], s38 offen sc1
    s_waitcnt vmcnt(0)
    v_cmp_eq_u32 vcc, 1, v2
    s_nop 1
    s_mov_b32 s66, vcc_lo
    s_andn2_b32 s40, s68, s66
    s_cbranch_scc0 nd_go_70
    s_sleep 4
    s_sub_u32 s41, s41, 1
    s_cmp_lg_u32 s41, 0
    s_cbranch_scc1 nd_poll_69
nd_go_70:
    s_mov_b64 exec, -1
nd_ok_68:
    s_add_u32 m0, s65, 16384
    s_nop 0
    buffer_load_dwordx4 v10, s[32:35], s54 offen offset:0 lds
    buffer_load_dwordx4 v10, s[32:35], s54 offen offset:1024 lds
    buffer_load_dwordx4 v28, s[32:35], s54 offen offset:2048 lds
    buffer_load_dwordx4 v28, s[32:35], s54 offen offset:3072 lds
    s_add_u32 s67, s67, 1
    s_cmp_eq_u32 s67, 16
    s_cselect_b32 s58, 0xffff8800, s59
    s_cselect_b32 s67, 0, s67
    s_add_u32 s54, s54, s58
    s_waitcnt vmcnt(8)
    s_barrier
    s_lshr_b32 s68, s67, 1
    s_lshl_b32 s68, 0x101, s68
    s_andn2_b32 s40, s68, s66
    s_cbranch_scc0 nd_ok_71
    s_mov_b64 exec, 0xffff
    s_mov_b32 s41, 200000
nd_poll_72:
    buffer_load_dword v2, v23, s[32:35], s38 offen sc1
    s_waitcnt vmcnt(0)
    v_cmp_eq_u32 vcc, 1, v2
    s_nop 1
    s_mov_b32 s66, vcc_lo
    s_andn2_b32 s40, s68, s66
    s_cbranch_scc0 nd_go_73
    s_sleep 4
    s_sub_u32 s41, s41, 1
    s_cmp_lg_u32 s41, 0
    s_cbranch_scc1 nd_poll_72
nd_go_73:
    s_mov_b64 exec, -1
nd_ok_71:
    s_add_u32 m0, s65, 32768
    s_nop 0
    buffer_load_dwordx4 v10, s[32:35], s54 offen offset:0 lds
    buffer_load_dwordx4 v10, s[32:35], s54 offen offset:1024 lds
    buffer_load_dwordx4 v28, s[32:35], s54 offen offset:2048 lds
    buffer_load_dwordx4 v28, s[32:35], s54 offen offset:3072 lds
    s_add_u32 s67, s67, 1
    s_cmp_eq_u32 s67, 16
    s_cselect_b32 s58, 0xffff8800, s59
    s_cselect_b32 s67, 0, s67
    s_add_u32 s54, s54, s58
    s_waitcnt vmcnt(8)
    s_barrier
    s_lshr_b32 s68, s67, 1
    s_lshl_b32 s68, 0x101, s68
    s_andn2_b32 s40, s68, s66
    s_cbranch_scc0 nd_ok_74
    s_mov_b64 exec, 0xffff
    s_mov_b32 s41, 200000
nd_poll_75:
    buffer_load_dword v2, v23, s[32:35], s38 offen sc1
    s_waitcnt vmcnt(0)
    v_cmp_eq_u32 vcc, 1, v2
    s_nop 1
    s_mov_b32 s66, vcc_lo
    s_andn2_b32 s40, s68, s66
    s_cbranch_scc0 nd_go_76
    s_sleep 4
    s_sub_u32 s41, s41, 1
    s_cmp_lg_u32 s41, 0
    s_cbranch_scc1 nd_poll_75
nd_go_76:
    s_mov_b64 exec, -1
nd_ok_74:
    s_add_u32 m0, s65, 49152
    s_nop 0
    buffer_load_dwordx4 v10, s[32:35], s54 offen offset:0 lds
    buffer_load_dwordx4 v10, s[32:35], s54 offen offset:1024 lds
    buffer_load_dwordx4 v28, s[32:35], s54 offen offset:2048 lds
    buffer_load_dwordx4 v28, s[32:35], s54 offen offset:3072 lds
    s_add_u32 s67, s67, 1
    s_cmp_eq_u32 s67, 16
    s_cselect_b32 s58, 0xffff8800, s59
    s_cselect_b32 s67, 0, s67
    s_add_u32 s54, s54, s58
    s_waitcnt vmcnt(8)
    s_barrier
    s_lshr_b32 s68, s67, 1
    s_lshl_b32 s68, 0x101, s68
    s_andn2_b32 s40, s68, s66
    s_cbranch_scc0 nd_ok_77
    s_mov_b64 exec, 0xffff
    s_mov_b32 s41, 200000
nd_poll_78:
    buffer_load_dword v2, v23, s[32:35], s38 offen sc1
    s_waitcnt vmcnt(0)
    v_cmp_eq_u32 vcc, 1, v2
    s_nop 1
    s_mov_b32 s66, vcc_lo
    s_andn2_b32 s40, s68, s66
    s_cbranch_scc0 nd_go_79
    s_sleep 4
    s_sub_u32 s41, s41, 1
    s_cmp_lg_u32 s41, 0
    s_cbranch_scc1 nd_poll_78
nd_go_79:
    s_mov_b64 exec, -1
nd_ok_77:
    s_add_u32 m0, s65, 65536
    s_nop 0
    buffer_load_dwordx4 v10, s[32:35], s54 offen offset:0 lds
    buffer_load_dwordx4 v10, s[32:35], s54 offen offset:1024 lds
    buffer_load_dwordx4 v28, s[32:35], s54 offen offset:2048 lds
    buffer_load_dwordx4 v28, s[32:35], s54 offen offset:3072 lds
    s_add_u32 s67, s67, 1
    s_cmp_eq_u32 s67, 16
    s_cselect_b32 s58, 0xffff8800, s59
    s_cselect_b32 s67, 0, s67
    s_add_u32 s54, s54, s58
    s_waitcnt vmcnt(8)
    s_barrier
    s_lshr_b32 s68, s67, 1
    s_lshl_b32 s68, 0x101, s68
    s_andn2_b32 s40, s68, s66
    s_cbranch_scc0 nd_ok_80
    s_mov_b64 exec, 0xffff
    s_mov_b32 s41, 200000
nd_poll_81:
    buffer_load_dword v2, v23, s[32:35], s38 offen sc1
    s_waitcnt vmcnt(0)
    v_cmp_eq_u32 vcc, 1, v2
    s_nop 1
    s_mov_b32 s66, vcc_lo
    s_andn2_b32 s40, s68, s66
    s_cbranch_scc0 nd_go_82
    s_sleep 4
    s_sub_u32 s41, s41, 1
    s_cmp_lg_u32 s41, 0
    s_cbranch_scc1 nd_poll_81
nd_go_82:
    s_mov_b64 exec, -1
nd_ok_80:
    s_add_u32 m0, s65, 0
    s_nop 0
    buffer_load_dwordx4 v10, s[32:35], s54 offen offset:0 lds
    buffer_load_dwordx4 v10, s[32:35], s54 offen offset:1024 lds
    buffer_load_dwordx4 v28, s[32:35], s54 offen offset:2048 lds
    buffer_load_dwordx4 v28, s[32:35], s54 offen offset:3072 lds
    s_lshl_b32 s44, s61, 2
    s_add_u32 s44, s44, s39
    s_lshl_b32 s40, s44, 13
    s_add_u32 s40, s40, 24117248
    v_lshlrev_b32 v2, 7, v11
    v_lshl_add_u32 v2, v12, 8, v2
    buffer_load_dwordx4 v[36:39], v2, s[32:35], s40 offen offset:0
    buffer_load_dwordx4 v[40:43], v2, s[32:35], s40 offen offset:16
    buffer_load_dwordx4 v[44:47], v2, s[32:35], s40 offen offset:32
    buffer_load_dwordx4 v[48:51], v2, s[32:35], s40 offen offset:48
    buffer_load_dwordx4 v[52:55], v2, s[32:35], s40 offen offset:64
    buffer_load_dwordx4 v[56:59], v2, s[32:35], s40 offen offset:80
    buffer_load_dwordx4 v[60:63], v2, s[32:35], s40 offen offset:96
    buffer_load_dwordx4 v[64:67], v2, s[32:35], s40 offen offset:112
    s_waitcnt vmcnt(16)
    s_barrier
    s_waitcnt vmcnt(12)
    s_barrier
    s_waitcnt vmcnt(8)
    s_barrier
    s_waitcnt vmcnt(0)
    v_pk_add_f32 v[36:37], v[36:37], v[40:41]
    v_pk_add_f32 v[44:45], v[44:45], v[48:49]
    v_pk_add_f32 v[52:53], v[52:53], v[56:57]
    v_pk_add_f32 v[60:61], v[60:61], v[64:65]
    v_pk_add_f32 v[36:37], v[36:37], v[44:45]
    v_pk_add_f32 v[52:53], v[52:53], v[60:61]
    v_pk_add_f32 v[36:37], v[36:37], v[52:53]
    v_mov_b32 v4, v36
    v_mov_b32 v5, v37
    s_nop 1
    v_permlane32_swap_b32 v4, v36
    v_permlane32_swap_b32 v5, v37
    v_add_f32 v36, v36, v4
    v_add_f32 v37, v37, v5
    v_mul_f32 v79, 0xbb000000, v36
    v_mul_f32 v37, 0x3b000000, v37
    v_fma_f32 v37, -v79, v79, v37
    v_max_f32 v37, 0, v37
    v_add_f32 v37, 0x3727c5ac, v37
    v_rsq_f32 v38, v37
    v_sqrt_f32 v78, v37
    v_mul_f32 v76, 0xc0135761, v38
    v_mul_f32 v39, v38, v38
    v_mul_f32 v39, v39, v38
    v_mul_f32 v77, 0xbdd2d3e8, v39
    s_lshl_b32 s40, s39, 9
    v_lshlrev_b32 v7, 4, v12
    v_add_u32 v7, s40, v7
    s_barrier
    ds_write_b128 v7, v[76:79] offset:1024
    s_waitcnt lgkmcnt(0)
    s_barrier
    s_barrier
    s_barrier
k2_x5_34:
    s_waitcnt vmcnt(0)
    s_movk_i32 s59, 4096
    s_mul_i32 s67, s49, 3
    s_mul_i32 s40, s50, 7
    s_add_u32 s67, s67, s40
    s_sub_u32 s40, s67, 28
    s_min_u32 s67, s67, s40
    s_mul_i32 s40, s43, 112
    s_lshl_b32 s41, s67, 2
    s_add_u32 s40, s40, s41
    s_lshl_b32 s40, s40, 10
    s_add_u32 s54, s40, 14680064
    s_lshr_b32 s38, s48, 1
    s_lshl_b32 s38, s38, 8
    s_add_u32 s38, s38, 25169920
    s_mov_b32 s66, 0
    s_lshr_b32 s68, s67, 1
    s_lshl_b32 s68, 1, s68
    s_andn2_b32 s40, s68, s66
    s_cbranch_scc0 nd_ok_83
    s_mov_b64 exec, 0x3fff
    s_mov_b32 s41, 200000
nd_poll_84:
    buffer_load_dword v2, v23, s[32:35], s38 offen sc1
    s_waitcnt vmcnt(0)
    v_cmp_eq_u32 vcc, 1, v2
    s_nop 1
    s_mov_b32 s66, vcc_lo
    s_andn2_b32 s40, s68, s66
    s_cbranch_scc0 nd_go_85
    s_sleep 4
    s_sub_u32 s41, s41, 1
    s_cmp_lg_u32 s41, 0
    s_cbranch_scc1 nd_poll_84
nd_go_85:
    s_mov_b64 exec, -1
nd_ok_83:
    s_add_u32 m0, s65, 0
    s_nop 0
    buffer_load_dwordx4 v10, s[32:35], s54 offen offset:0 lds
    buffer_load_dwordx4 v10, s[32:35], s54 offen offset:1024 lds
    buffer_load_dwordx4 v10, s[32:35], s54 offen offset:2048 lds
    buffer_load_dwordx4 v10, s[32:35], s54 offen offset:3072 lds
    s_add_u32 s67, s67, 1
    s_cmp_eq_u32 s67, 28
    s_cselect_b32 s58, 0xfffe5000, s59
    s_cselect_b32 s67, 0, s67
    s_add_u32 s54, s54, s58
    s_lshr_b32 s68, s67, 1
    s_lshl_b32 s68, 1, s68
    s_andn2_b32 s40, s68, s66
    s_cbranch_scc0 nd_ok_86
    s_mov_b64 exec, 0x3fff
    s_mov_b32 s41, 200000
nd_poll_87:
    buffer_load_dword v2, v23, s[32:35], s38 offen sc1
    s_waitcnt vmcnt(0)
    v_cmp_eq_u32 vcc, 1, v2
    s_nop 1
    s_mov_b32 s66, vcc_lo
    s_andn2_b32 s40, s68, s66
    s_cbranch_scc0 nd_go_88
    s_sleep 4
    s_sub_u32 s41, s41, 1
    s_cmp_lg_u32 s41, 0
    s_cbranch_scc1 nd_poll_87
nd_go_88:
    s_mov_b64 exec, -1
nd_ok_86:
    s_add_u32 m0, s65, 16384
    s_nop 0
    buffer_load_dwordx4 v10, s[32:35], s54 offen offset:0 lds
    buffer_load_dwordx4 v10, s[32:35], s54 offen offset:1024 lds
    buffer_load_dwordx4 v10, s[32:35], s54 offen offset:2048 lds
    buffer_load_dwordx4 v10, s[32:35], s54 offen offset:3072 lds
    s_add_u32 s67, s67, 1
    s_cmp_eq_u32 s67, 28
    s_cselect_b32 s58, 0xfffe5000, s59
    s_cselect_b32 s67, 0, s67
    s_add_u32 s54, s54, s58
    s_lshr_b32 s68, s67, 1
    s_lshl_b32 s68, 1, s68
    s_andn2_b32 s40, s68, s66
    s_cbranch_scc0 nd_ok_89
    s_mov_b64 exec, 0x3fff
    s_mov_b32 s41, 200000
nd_poll_90:
    buffer_load_dword v2, v23, s[32:35], s38 offen sc1
    s_waitcnt vmcnt(0)
    v_cmp_eq_u32 vcc, 1, v2
    s_nop 1
    s_mov_b32 s66, vcc_lo
    s_andn2_b32 s40, s68, s66
    s_cbranch_scc0 nd_go_91
    s_sleep 4
    s_sub_u32 s41, s41, 1
    s_cmp_lg_u32 s41, 0
    s_cbranch_scc1 nd_poll_90
nd_go_91:
    s_mov_b64 exec, -1
nd_ok_89:
    s_add_u32 m0, s65, 32768
    s_nop 0
    buffer_load_dwordx4 v10, s[32:35], s54 offen offset:0 lds
    buffer_load_dwordx4 v10, s[32:35], s54 offen offset:1024 lds
    buffer_load_dwordx4 v10, s[32:35], s54 offen offset:2048 lds
    buffer_load_dwordx4 v10, s[32:35], s54 offen offset:3072 lds
    s_add_u32 s67, s67, 1
    s_cmp_eq_u32 s67, 28
    s_cselect_b32 s58, 0xfffe5000, s59
    s_cselect_b32 s67, 0, s67
    s_add_u32 s54, s54, s58
    s_lshr_b32 s68, s67, 1
    s_lshl_b32 s68, 1, s68
    s_andn2_b32 s40, s68, s66
    s_cbranch_scc0 nd_ok_92
    s_mov_b64 exec, 0x3fff
    s_mov_b32 s41, 200000
nd_poll_93:
    buffer_load_dword v2, v23, s[32:35], s38 offen sc1
    s_waitcnt vmcnt(0)
    v_cmp_eq_u32 vcc, 1, v2
    s_nop 1
    s_mov_b32 s66, vcc_lo
    s_andn2_b32 s40, s68, s66
    s_cbranch_scc0 nd_go_94
    s_sleep 4
    s_sub_u32 s41, s41, 1
    s_cmp_lg_u32 s41, 0
    s_cbranch_scc1 nd_poll_93
nd_go_94:
    s_mov_b64 exec, -1
nd_ok_92:
    s_add_u32 m0, s65, 49152
    s_nop 0
    buffer_load_dwordx4 v10, s[32:35], s54 offen offset:0 lds
    buffer_load_dwordx4 v10, s[32:35], s54 offen offset:1024 lds
    buffer_load_dwordx4 v10, s[32:35], s54 offen offset:2048 lds
    buffer_load_dwordx4 v10, s[32:35], s54 offen offset:3072 lds
    s_add_u32 s67, s67, 1
    s_cmp_eq_u32 s67, 28
    s_cselect_b32 s58, 0xfffe5000, s59
    s_cselect_b32 s67, 0, s67
    s_add_u32 s54, s54, s58
    s_lshr_b32 s68, s67, 1
    s_lshl_b32 s68, 1, s68
    s_andn2_b32 s40, s68, s66
    s_cbranch_scc0 nd_ok_95
    s_mov_b64 exec, 0x3fff
    s_mov_b32 s41, 200000
nd_poll_96:
    buffer_load_dword v2, v23, s[32:35], s38 offen sc1
    s_waitcnt vmcnt(0)
    v_cmp_eq_u32 vcc, 1, v2
    s_nop 1
    s_mov_b32 s66, vcc_lo
    s_andn2_b32 s40, s68, s66
    s_cbranch_scc0 nd_go_97
    s_sleep 4
    s_sub_u32 s41, s41, 1
    s_cmp_lg_u32 s41, 0
    s_cbranch_scc1 nd_poll_96
nd_go_97:
    s_mov_b64 exec, -1
nd_ok_95:
    s_add_u32 m0, s65, 65536
    s_nop 0
    buffer_load_dwordx4 v10, s[32:35], s54 offen offset:0 lds
    buffer_load_dwordx4 v10, s[32:35], s54 offen offset:1024 lds
    buffer_load_dwordx4 v10, s[32:35], s54 offen offset:2048 lds
    buffer_load_dwordx4 v10, s[32:35], s54 offen offset:3072 lds
    s_add_u32 s67, s67, 1
    s_cmp_eq_u32 s67, 28
    s_cselect_b32 s58, 0xfffe5000, s59
    s_cselect_b32 s67, 0, s67
    s_add_u32 s54, s54, s58
    s_waitcnt vmcnt(16)
    s_barrier
    s_waitcnt vmcnt(12)
    s_barrier
    s_waitcnt vmcnt(8)
    s_barrier
    s_lshr_b32 s68, s67, 1
    s_lshl_b32 s68, 1, s68
    s_andn2_b32 s40, s68, s66
    s_cbranch_scc0 nd_ok_98
    s_mov_b64 exec, 0x3fff
    s_mov_b32 s41, 200000
nd_poll_99:
    buffer_load_dword v2, v23, s[32:35], s38 offen sc1
    s_waitcnt vmcnt(0)
    v_cmp_eq_u32 vcc, 1, v2
    s_nop 1
    s_mov_b32 s66, vcc_lo
    s_andn2_b32 s40, s68, s66
    s_cbranch_scc0 nd_go_100
    s_sleep 4
    s_sub_u32 s41, s41, 1
    s_cmp_lg_u32 s41, 0
    s_cbranch_scc1 nd_poll_99
nd_go_100:
    s_mov_b64 exec, -1
nd_ok_98:
    s_add_u32 m0, s65, 0
    s_nop 0
    buffer_load_dwordx4 v10, s[32:35], s54 offen offset:0 lds
    buffer_load_dwordx4 v10, s[32:35], s54 offen offset:1024 lds
    buffer_load_dwordx4 v10, s[32:35], s54 offen offset:2048 lds
    buffer_load_dwordx4 v10, s[32:35], s54 offen offset:3072 lds
    s_add_u32 s67, s67, 1
    s_cmp_eq_u32 s67, 28
    s_cselect_b32 s58, 0xfffe5000, s59
    s_cselect_b32 s67, 0, s67
    s_add_u32 s54, s54, s58
    s_waitcnt vmcnt(8)
    s_barrier
    s_lshr_b32 s68, s67, 1
    s_lshl_b32 s68, 1, s68
    s_andn2_b32 s40, s68, s66
    s_cbranch_scc0 nd_ok_101
    s_mov_b64 exec, 0x3fff
    s_mov_b32 s41, 200000
nd_poll_102:
    buffer_load_dword v2, v23, s[32:35], s38 offen sc1
    s_waitcnt vmcnt(0)
    v_cmp_eq_u32 vcc, 1, v2
    s_nop 1
    s_mov_b32 s66, vcc_lo
    s_andn2_b32 s40, s68, s66
    s_cbranch_scc0 nd_go_103
    s_sleep 4
    s_sub_u32 s41, s41, 1
    s_cmp_lg_u32 s41, 0
    s_cbranch_scc1 nd_poll_102
nd_go_103:
    s_mov_b64 exec, -1
nd_ok_101:
    s_add_u32 m0, s65, 16384
    s_nop 0
    buffer_load_dwordx4 v10, s[32:35], s54 offen offset:0 lds
    buffer_load_dwordx4 v10, s[32:35], s54 offen offset:1024 lds
    buffer_load_dwordx4 v10, s[32:35], s54 offen offset:2048 lds
    buffer_load_dwordx4 v10, s[32:35], s54 offen offset:3072 lds
    s_add_u32 s67, s67, 1
    s_cmp_eq_u32 s67, 28
    s_cselect_b32 s58, 0xfffe5000, s59
    s_cselect_b32 s67, 0, s67
    s_add_u32 s54, s54, s58
    s_waitcnt vmcnt(8)
    s_barrier
    s_lshr_b32 s68, s67, 1
    s_lshl_b32 s68, 1, s68
    s_andn2_b32 s40, s68, s66
    s_cbranch_scc0 nd_ok_104
    s_mov_b64 exec, 0x3fff
    s_mov_b32 s41, 200000
nd_poll_105:
    buffer_load_dword v2, v23, s[32:35], s38 offen sc1
    s_waitcnt vmcnt(0)
    v_cmp_eq_u32 vcc, 1, v2
    s_nop 1
    s_mov_b32 s66, vcc_lo
    s_andn2_b32 s40, s68, s66
    s_cbranch_scc0 nd_go_106
    s_sleep 4
    s_sub_u32 s41, s41, 1
    s_cmp_lg_u32 s41, 0
    s_cbranch_scc1 nd_poll_105
nd_go_106:
    s_mov_b64 exec, -1
nd_ok_104:
    s_add_u32 m0, s65, 32768
    s_nop 0
    buffer_load_dwordx4 v10, s[32:35], s54 offen offset:0 lds
    buffer_load_dwordx4 v10, s[32:35], s54 offen offset:1024 lds
    buffer_load_dwordx4 v10, s[32:35], s54 offen offset:2048 lds
    buffer_load_dwordx4 v10, s[32:35], s54 offen offset:3072 lds
    s_add_u32 s67, s67, 1
    s_cmp_eq_u32 s67, 28
    s_cselect_b32 s58, 0xfffe5000, s59
    s_cselect_b32 s67, 0, s67
    s_add_u32 s54, s54, s58
    s_waitcnt vmcnt(8)
    s_barrier
    s_lshr_b32 s68, s67, 1
    s_lshl_b32 s68, 1, s68
    s_andn2_b32 s40, s68, s66
    s_cbranch_scc0 nd_ok_107
    s_mov_b64 exec, 0x3fff
    s_mov_b32 s41, 200000
nd_poll_108:
    buffer_load_dword v2, v23, s[32:35], s38 offen sc1
    s_waitcnt vmcnt(0)
    v_cmp_eq_u32 vcc, 1, v2
    s_nop 1
    s_mov_b32 s66, vcc_lo
    s_andn2_b32 s40, s68, s66
    s_cbranch_scc0 nd_go_109
    s_sleep 4
    s_sub_u32 s41, s41, 1
    s_cmp_lg_u32 s41, 0
    s_cbranch_scc1 nd_poll_108
nd_go_109:
    s_mov_b64 exec, -1
nd_ok_107:
    s_add_u32 m0, s65, 49152
    s_nop 0
    buffer_load_dwordx4 v10, s[32:35], s54 offen offset:0 lds
    buffer_load_dwordx4 v10, s[32:35], s54 offen offset:1024 lds
    buffer_load_dwordx4 v10, s[32:35], s54 offen offset:2048 lds
    buffer_load_dwordx4 v10, s[32:35], s54 offen offset:3072 lds
    s_add_u32 s67, s67, 1
    s_cmp_eq_u32 s67, 28
    s_cselect_b32 s58, 0xfffe5000, s59
    s_cselect_b32 s67, 0, s67
    s_add_u32 s54, s54, s58
    s_waitcnt vmcnt(8)
    s_barrier
    s_lshr_b32 s68, s67, 1
    s_lshl_b32 s68, 1, s68
    s_andn2_b32 s40, s68, s66
    s_cbranch_scc0 nd_ok_110
    s_mov_b64 exec, 0x3fff
    s_mov_b32 s41, 200000
nd_poll_111:
    buffer_load_dword v2, v23, s[32:35], s38 offen sc1
    s_waitcnt vmcnt(0)
    v_cmp_eq_u32 vcc, 1, v2
    s_nop 1
    s_mov_b32 s66, vcc_lo
    s_andn2_b32 s40, s68, s66
    s_cbranch_scc0 nd_go_112
    s_sleep 4
    s_sub_u32 s41, s41, 1
    s_cmp_lg_u32 s41, 0
    s_cbranch_scc1 nd_poll_111
nd_go_112:
    s_mov_b64 exec, -1
nd_ok_110:
    s_add_u32 m0, s65, 65536
    s_nop 0
    buffer_load_dwordx4 v10, s[32:35], s54 offen offset:0 lds
    buffer_load_dwordx4 v10, s[32:35], s54 offen offset:1024 lds
    buffer_load_dwordx4 v10, s[32:35], s54 offen offset:2048 lds
    buffer_load_dwordx4 v10, s[32:35], s54 offen offset:3072 lds
    s_add_u32 s67, s67, 1
    s_cmp_eq_u32 s67, 28
    s_cselect_b32 s58, 0xfffe5000, s59
    s_cselect_b32 s67, 0, s67
    s_add_u32 s54, s54, s58
    s_waitcnt vmcnt(8)
    s_barrier
    s_lshr_b32 s68, s67, 1
    s_lshl_b32 s68, 1, s68
    s_andn2_b32 s40, s68, s66
    s_cbranch_scc0 nd_ok_113
    s_mov_b64 exec, 0x3fff
    s_mov_b32 s41, 200000
nd_poll_114:
    buffer_load_dword v2, v23, s[32:35], s38 offen sc1
    s_waitcnt vmcnt(0)
    v_cmp_eq_u32 vcc, 1, v2
    s_nop 1
    s_mov_b32 s66, vcc_lo
    s_andn2_b32 s40, s68, s66
    s_cbranch_scc0 nd_go_115
    s_sleep 4
    s_sub_u32 s41, s41, 1
    s_cmp_lg_u32 s41, 0
    s_cbranch_scc1 nd_poll_114
nd_go_115:
    s_mov_b64 exec, -1
nd_ok_113:
    s_add_u32 m0, s65, 0
    s_nop 0
    buffer_load_dwordx4 v10, s[32:35], s54 offen offset:0 lds
    buffer_load_dwordx4 v10, s[32:35], s54 offen offset:1024 lds
    buffer_load_dwordx4 v10, s[32:35], s54 offen offset:2048 lds
    buffer_load_dwordx4 v10, s[32:35], s54 offen offset:3072 lds
    s_add_u32 s67, s67, 1
    s_cmp_eq_u32 s67, 28
    s_cselect_b32 s58, 0xfffe5000, s59
    s_cselect_b32 s67, 0, s67
    s_add_u32 s54, s54, s58
    s_waitcnt vmcnt(8)
    s_barrier
    s_lshr_b32 s68, s67, 1
    s_lshl_b32 s68, 1, s68
    s_andn2_b32 s40, s68, s66
    s_cbranch_scc0 nd_ok_116
    s_mov_b64 exec, 0x3fff
    s_mov_b32 s41, 200000
nd_poll_117:
    buffer_load_dword v2, v23, s[32:35], s38 offen sc1
    s_waitcnt vmcnt(0)
    v_cmp_eq_u32 vcc, 1, v2
    s_nop 1
    s_mov_b32 s66, vcc_lo
    s_andn2_b32 s40, s68, s66
    s_cbranch_scc0 nd_go_118
    s_sleep 4
    s_sub_u32 s41, s41, 1
    s_cmp_lg_u32 s41, 0
    s_cbranch_scc1 nd_poll_117
nd_go_118:
    s_mov_b64 exec, -1
nd_ok_116:
    s_add_u32 m0, s65, 16384
    s_nop 0
    buffer_load_dwordx4 v10, s[32:35], s54 offen offset:0 lds
    buffer_load_dwordx4 v10, s[32:35], s54 offen offset:1024 lds
    buffer_load_dwordx4 v10, s[32:35], s54 offen offset:2048 lds
    buffer_load_dwordx4 v10, s[32:35], s54 offen offset:3072 lds
    s_add_u32 s67, s67, 1
    s_cmp_eq_u32 s67, 28
    s_cselect_b32 s58, 0xfffe5000, s59
    s_cselect_b32 s67, 0, s67
    s_add_u32 s54, s54, s58
    s_waitcnt vmcnt(8)
    s_barrier
    s_lshr_b32 s68, s67, 1
    s_lshl_b32 s68, 1, s68
    s_andn2_b32 s40, s68, s66
    s_cbranch_scc0 nd_ok_119
    s_mov_b64 exec, 0x3fff
    s_mov_b32 s41, 200000
nd_poll_120:
    buffer_load_dword v2, v23, s[32:35], s38 offen sc1
    s_waitcnt vmcnt(0)
    v_cmp_eq_u32 vcc, 1, v2
    s_nop 1
    s_mov_b32 s66, vcc_lo
    s_andn2_b32 s40, s68, s66
    s_cbranch_scc0 nd_go_121
    s_sleep 4
    s_sub_u32 s41, s41, 1
    s_cmp_lg_u32 s41, 0
    s_cbranch_scc1 nd_poll_120
nd_go_121:
    s_mov_b64 exec, -1
nd_ok_119:
    s_add_u32 m0, s65, 32768
    s_nop 0
    buffer_load_dwordx4 v10, s[32:35], s54 offen offset:0 lds
    buffer_load_dwordx4 v10, s[32:35], s54 offen offset:1024 lds
    buffer_load_dwordx4 v10, s[32:35], s54 offen offset:2048 lds
    buffer_load_dwordx4 v10, s[32:35], s54 offen offset:3072 lds
    s_add_u32 s67, s67, 1
    s_cmp_eq_u32 s67, 28
    s_cselect_b32 s58, 0xfffe5000, s59
    s_cselect_b32 s67, 0, s67
    s_add_u32 s54, s54, s58
    s_waitcnt vmcnt(8)
    s_barrier
    s_lshr_b32 s68, s67, 1
    s_lshl_b32 s68, 1, s68
    s_andn2_b32 s40, s68, s66
    s_cbranch_scc0 nd_ok_122
    s_mov_b64 exec, 0x3fff
    s_mov_b32 s41, 200000
nd_poll_123:
    buffer_load_dword v2, v23, s[32:35], s38 offen sc1
    s_waitcnt vmcnt(0)
    v_cmp_eq_u32 vcc, 1, v2
    s_nop 1
    s_mov_b32 s66, vcc_lo
    s_andn2_b32 s40, s68, s66
    s_cbranch_scc0 nd_go_124
    s_sleep 4
    s_sub_u32 s41, s41, 1
    s_cmp_lg_u32 s41, 0
    s_cbranch_scc1 nd_poll_123
nd_go_124:
    s_mov_b64 exec, -1
nd_ok_122:
    s_add_u32 m0, s65, 49152
    s_nop 0
    buffer_load_dwordx4 v10, s[32:35], s54 offen offset:0 lds
    buffer_load_dwordx4 v10, s[32:35], s54 offen offset:1024 lds
    buffer_load_dwordx4 v10, s[32:35], s54 offen offset:2048 lds
    buffer_load_dwordx4 v10, s[32:35], s54 offen offset:3072 lds
    s_add_u32 s67, s67, 1
    s_cmp_eq_u32 s67, 28
    s_cselect_b32 s58, 0xfffe5000, s59
    s_cselect_b32 s67, 0, s67
    s_add_u32 s54, s54, s58
    s_waitcnt vmcnt(8)
    s_barrier
    s_lshr_b32 s68, s67, 1
    s_lshl_b32 s68, 1, s68
    s_andn2_b32 s40, s68, s66
    s_cbranch_scc0 nd_ok_125
    s_mov_b64 exec, 0x3fff
    s_mov_b32 s41, 200000
nd_poll_126:
    buffer_load_dword v2, v23, s[32:35], s38 offen sc1
    s_waitcnt vmcnt(0)
    v_cmp_eq_u32 vcc, 1, v2
    s_nop 1
    s_mov_b32 s66, vcc_lo
    s_andn2_b32 s40, s68, s66
    s_cbranch_scc0 nd_go_127
    s_sleep 4
    s_sub_u32 s41, s41, 1
    s_cmp_lg_u32 s41, 0
    s_cbranch_scc1 nd_poll_126
nd_go_127:
    s_mov_b64 exec, -1
nd_ok_125:
    s_add_u32 m0, s65, 65536
    s_nop 0
    buffer_load_dwordx4 v10, s[32:35], s54 offen offset:0 lds
    buffer_load_dwordx4 v10, s[32:35], s54 offen offset:1024 lds
    buffer_load_dwordx4 v10, s[32:35], s54 offen offset:2048 lds
    buffer_load_dwordx4 v10, s[32:35], s54 offen offset:3072 lds
    s_add_u32 s67, s67, 1
    s_cmp_eq_u32 s67, 28
    s_cselect_b32 s58, 0xfffe5000, s59
    s_cselect_b32 s67, 0, s67
    s_add_u32 s54, s54, s58
    s_waitcnt vmcnt(8)
    s_barrier
    s_lshr_b32 s68, s67, 1
    s_lshl_b32 s68, 1, s68
    s_andn2_b32 s40, s68, s66
    s_cbranch_scc0 nd_ok_128
    s_mov_b64 exec, 0x3fff
    s_mov_b32 s41, 200000
nd_poll_129:
    buffer_load_dword v2, v23, s[32:35], s38 offen sc1
    s_waitcnt vmcnt(0)
    v_cmp_eq_u32 vcc, 1, v2
    s_nop 1
    s_mov_b32 s66, vcc_lo
    s_andn2_b32 s40, s68, s66
    s_cbranch_scc0 nd_go_130
    s_sleep 4
    s_sub_u32 s41, s41, 1
    s_cmp_lg_u32 s41, 0
    s_cbranch_scc1 nd_poll_129
nd_go_130:
    s_mov_b64 exec, -1
nd_ok_128:
    s_add_u32 m0, s65, 0
    s_nop 0
    buffer_load_dwordx4 v10, s[32:35], s54 offen offset:0 lds
    buffer_load_dwordx4 v10, s[32:35], s54 offen offset:1024 lds
    buffer_load_dwordx4 v10, s[32:35], s54 offen offset:2048 lds
    buffer_load_dwordx4 v10, s[32:35], s54 offen offset:3072 lds
    s_add_u32 s67, s67, 1
    s_cmp_eq_u32 s67, 28
    s_cselect_b32 s58, 0xfffe5000, s59
    s_cselect_b32 s67, 0, s67
    s_add_u32 s54, s54, s58
    s_waitcnt vmcnt(8)
    s_barrier
    s_lshr_b32 s68, s67, 1
    s_lshl_b32 s68, 1, s68
    s_andn2_b32 s40, s68, s66
    s_cbranch_scc0 nd_ok_131
    s_mov_b64 exec, 0x3fff
    s_mov_b32 s41, 200000
nd_poll_132:
    buffer_load_dword v2, v23, s[32:35], s38 offen sc1
    s_waitcnt vmcnt(0)
    v_cmp_eq_u32 vcc, 1, v2
    s_nop 1
    s_mov_b32 s66, vcc_lo
    s_andn2_b32 s40, s68, s66
    s_cbranch_scc0 nd_go_133
    s_sleep 4
    s_sub_u32 s41, s41, 1
    s_cmp_lg_u32 s41, 0
    s_cbranch_scc1 nd_poll_132
nd_go_133:
    s_mov_b64 exec, -1
nd_ok_131:
    s_add_u32 m0, s65, 16384
    s_nop 0
    buffer_load_dwordx4 v10, s[32:35], s54 offen offset:0 lds
    buffer_load_dwordx4 v10, s[32:35], s54 offen offset:1024 lds
    buffer_load_dwordx4 v10, s[32:35], s54 offen offset:2048 lds
    buffer_load_dwordx4 v10, s[32:35], s54 offen offset:3072 lds
    s_add_u32 s67, s67, 1
    s_cmp_eq_u32 s67, 28
    s_cselect_b32 s58, 0xfffe5000, s59
    s_cselect_b32 s67, 0, s67
    s_add_u32 s54, s54, s58
    s_waitcnt vmcnt(8)
    s_barrier
    s_lshr_b32 s68, s67, 1
    s_lshl_b32 s68, 1, s68
    s_andn2_b32 s40, s68, s66
    s_cbranch_scc0 nd_ok_134
    s_mov_b64 exec, 0x3fff
    s_mov_b32 s41, 200000
nd_poll_135:
    buffer_load_dword v2, v23, s[32:35], s38 offen sc1
    s_waitcnt vmcnt(0)
    v_cmp_eq_u32 vcc, 1, v2
    s_nop 1
    s_mov_b32 s66, vcc_lo
    s_andn2_b32 s40, s68, s66
    s_cbranch_scc0 nd_go_136
    s_sleep 4
    s_sub_u32 s41, s41, 1
    s_cmp_lg_u32 s41, 0
    s_cbranch_scc1 nd_poll_135
nd_go_136:
    s_mov_b64 exec, -1
nd_ok_134:
    s_add_u32 m0, s65, 32768
    s_nop 0
    buffer_load_dwordx4 v10, s[32:35], s54 offen offset:0 lds
    buffer_load_dwordx4 v10, s[32:35], s54 offen offset:1024 lds
    buffer_load_dwordx4 v10, s[32:35], s54 offen offset:2048 lds
    buffer_load_dwordx4 v10, s[32:35], s54 offen offset:3072 lds
    s_add_u32 s67, s67, 1
    s_cmp_eq_u32 s67, 28
    s_cselect_b32 s58, 0xfffe5000, s59
    s_cselect_b32 s67, 0, s67
    s_add_u32 s54, s54, s58
    s_waitcnt vmcnt(8)
    s_barrier
    s_lshr_b32 s68, s67, 1
    s_lshl_b32 s68, 1, s68
    s_andn2_b32 s40, s68, s66
    s_cbranch_scc0 nd_ok_137
    s_mov_b64 exec, 0x3fff
    s_mov_b32 s41, 200000
nd_poll_138:
    buffer_load_dword v2, v23, s[32:35], s38 offen sc1
    s_waitcnt vmcnt(0)
    v_cmp_eq_u32 vcc, 1, v2
    s_nop 1
    s_mov_b32 s66, vcc_lo
    s_andn2_b32 s40, s68, s66
    s_cbranch_scc0 nd_go_139
    s_sleep 4
    s_sub_u32 s41, s41, 1
    s_cmp_lg_u32 s41, 0
    s_cbranch_scc1 nd_poll_138
nd_go_139:
    s_mov_b64 exec, -1
nd_ok_137:
    s_add_u32 m0, s65, 49152
    s_nop 0
    buffer_load_dwordx4 v10, s[32:35], s54 offen offset:0 lds
    buffer_load_dwordx4 v10, s[32:35], s54 offen offset:1024 lds
    buffer_load_dwordx4 v10, s[32:35], s54 offen offset:2048 lds
    buffer_load_dwordx4 v10, s[32:35], s54 offen offset:3072 lds
    s_add_u32 s67, s67, 1
    s_cmp_eq_u32 s67, 28
    s_cselect_b32 s58, 0xfffe5000, s59
    s_cselect_b32 s67, 0, s67
    s_add_u32 s54, s54, s58
    s_waitcnt vmcnt(8)
    s_barrier
    s_lshr_b32 s68, s67, 1
    s_lshl_b32 s68, 1, s68
    s_andn2_b32 s40, s68, s66
    s_cbranch_scc0 nd_ok_140
    s_mov_b64 exec, 0x3fff
    s_mov_b32 s41, 200000
nd_poll_141:
    buffer_load_dword v2, v23, s[32:35], s38 offen sc1
    s_waitcnt vmcnt(0)
    v_cmp_eq_u32 vcc, 1, v2
    s_nop 1
    s_mov_b32 s66, vcc_lo
    s_andn2_b32 s40, s68, s66
    s_cbranch_scc0 nd_go_142
    s_sleep 4
    s_sub_u32 s41, s41, 1
    s_cmp_lg_u32 s41, 0
    s_cbranch_scc1 nd_poll_141
nd_go_142:
    s_mov_b64 exec, -1
nd_ok_140:
    s_add_u32 m0, s65, 65536
    s_nop 0
    buffer_load_dwordx4 v10, s[32:35], s54 offen offset:0 lds
    buffer_load_dwordx4 v10, s[32:35], s54 offen offset:1024 lds
    buffer_load_dwordx4 v10, s[32:35], s54 offen offset:2048 lds
    buffer_load_dwordx4 v10, s[32:35], s54 offen offset:3072 lds
    s_add_u32 s67, s67, 1
    s_cmp_eq_u32 s67, 28
    s_cselect_b32 s58, 0xfffe5000, s59
    s_cselect_b32 s67, 0, s67
    s_add_u32 s54, s54, s58
    s_waitcnt vmcnt(8)
    s_barrier
    s_lshr_b32 s68, s67, 1
    s_lshl_b32 s68, 1, s68
    s_andn2_b32 s40, s68, s66
    s_cbranch_scc0 nd_ok_143
    s_mov_b64 exec, 0x3fff
    s_mov_b32 s41, 200000
nd_poll_144:
    buffer_load_dword v2, v23, s[32:35], s38 offen sc1
    s_waitcnt vmcnt(0)
    v_cmp_eq_u32 vcc, 1, v2
    s_nop 1
    s_mov_b32 s66, vcc_lo
    s_andn2_b32 s40, s68, s66
    s_cbranch_scc0 nd_go_145
    s_sleep 4
    s_sub_u32 s41, s41, 1
    s_cmp_lg_u32 s41, 0
    s_cbranch_scc1 nd_poll_144
nd_go_145:
    s_mov_b64 exec, -1
nd_ok_143:
    s_add_u32 m0, s65, 0
    s_nop 0
    buffer_load_dwordx4 v10, s[32:35], s54 offen offset:0 lds
    buffer_load_dwordx4 v10, s[32:35], s54 offen offset:1024 lds
    buffer_load_dwordx4 v10, s[32:35], s54 offen offset:2048 lds
    buffer_load_dwordx4 v10, s[32:35], s54 offen offset:3072 lds
    s_add_u32 s67, s67, 1
    s_cmp_eq_u32 s67, 28
    s_cselect_b32 s58, 0xfffe5000, s59
    s_cselect_b32 s67, 0, s67
    s_add_u32 s54, s54, s58
    s_waitcnt vmcnt(8)
    s_barrier
    s_lshr_b32 s68, s67, 1
    s_lshl_b32 s68, 1, s68
    s_andn2_b32 s40, s68, s66
    s_cbranch_scc0 nd_ok_146
    s_mov_b64 exec, 0x3fff
    s_mov_b32 s41, 200000
nd_poll_147:
    buffer_load_dword v2, v23, s[32:35], s38 offen sc1
    s_waitcnt vmcnt(0)
    v_cmp_eq_u32 vcc, 1, v2
    s_nop 1
    s_mov_b32 s66, vcc_lo
    s_andn2_b32 s40, s68, s66
    s_cbranch_scc0 nd_go_148
    s_sleep 4
    s_sub_u32 s41, s41, 1
    s_cmp_lg_u32 s41, 0
    s_cbranch_scc1 nd_poll_147
nd_go_148:
    s_mov_b64 exec, -1
nd_ok_146:
    s_add_u32 m0, s65, 16384
    s_nop 0
    buffer_load_dwordx4 v10, s[32:35], s54 offen offset:0 lds
    buffer_load_dwordx4 v10, s[32:35], s54 offen offset:1024 lds
    buffer_load_dwordx4 v10, s[32:35], s54 offen offset:2048 lds
    buffer_load_dwordx4 v10, s[32:35], s54 offen offset:3072 lds
    s_add_u32 s67, s67, 1
    s_cmp_eq_u32 s67, 28
    s_cselect_b32 s58, 0xfffe5000, s59
    s_cselect_b32 s67, 0, s67
    s_add_u32 s54, s54, s58
    s_waitcnt vmcnt(8)
    s_barrier
    s_lshr_b32 s68, s67, 1
    s_lshl_b32 s68, 1, s68
    s_andn2_b32 s40, s68, s66
    s_cbranch_scc0 nd_ok_149
    s_mov_b64 exec, 0x3fff
    s_mov_b32 s41, 200000
nd_poll_150:
    buffer_load_dword v2, v23, s[32:35], s38 offen sc1
    s_waitcnt vmcnt(0)
    v_cmp_eq_u32 vcc, 1, v2
    s_nop 1
    s_mov_b32 s66, vcc_lo
    s_andn2_b32 s40, s68, s66
    s_cbranch_scc0 nd_go_151
    s_sleep 4
    s_sub_u32 s41, s41, 1
    s_cmp_lg_u32 s41, 0
    s_cbranch_scc1 nd_poll_150
nd_go_151:
    s_mov_b64 exec, -1
nd_ok_149:
    s_add_u32 m0, s65, 32768
    s_nop 0
    buffer_load_dwordx4 v10, s[32:35], s54 offen offset:0 lds
    buffer_load_dwordx4 v10, s[32:35], s54 offen offset:1024 lds
    buffer_load_dwordx4 v10, s[32:35], s54 offen offset:2048 lds
    buffer_load_dwordx4 v10, s[32:35], s54 offen offset:3072 lds
    s_add_u32 s67, s67, 1
    s_cmp_eq_u32 s67, 28
    s_cselect_b32 s58, 0xfffe5000, s59
    s_cselect_b32 s67, 0, s67
    s_add_u32 s54, s54, s58
    s_waitcnt vmcnt(8)
    s_barrier
    s_lshr_b32 s68, s67, 1
    s_lshl_b32 s68, 1, s68
    s_andn2_b32 s40, s68, s66
    s_cbranch_scc0 nd_ok_152
    s_mov_b64 exec, 0x3fff
    s_mov_b32 s41, 200000
nd_poll_153:
    buffer_load_dword v2, v23, s[32:35], s38 offen sc1
    s_waitcnt vmcnt(0)
    v_cmp_eq_u32 vcc, 1, v2
    s_nop 1
    s_mov_b32 s66, vcc_lo
    s_andn2_b32 s40, s68, s66
    s_cbranch_scc0 nd_go_154
    s_sleep 4
    s_sub_u32 s41, s41, 1
    s_cmp_lg_u32 s41, 0
    s_cbranch_scc1 nd_poll_153
nd_go_154:
    s_mov_b64 exec, -1
nd_ok_152:
    s_add_u32 m0, s65, 49152
    s_nop 0
    buffer_load_dwordx4 v10, s[32:35], s54 offen offset:0 lds
    buffer_load_dwordx4 v10, s[32:35], s54 offen offset:1024 lds
    buffer_load_dwordx4 v10, s[32:35], s54 offen offset:2048 lds
    buffer_load_dwordx4 v10, s[32:35], s54 offen offset:3072 lds
    s_add_u32 s67, s67, 1
    s_cmp_eq_u32 s67, 28
    s_cselect_b32 s58, 0xfffe5000, s59
    s_cselect_b32 s67, 0, s67
    s_add_u32 s54, s54, s58
    s_waitcnt vmcnt(8)
    s_barrier
    s_lshr_b32 s68, s67, 1
    s_lshl_b32 s68, 1, s68
    s_andn2_b32 s40, s68, s66
    s_cbranch_scc0 nd_ok_155
    s_mov_b64 exec, 0x3fff
    s_mov_b32 s41, 200000
nd_poll_156:
    buffer_load_dword v2, v23, s[32:35], s38 offen sc1
    s_waitcnt vmcnt(0)
    v_cmp_eq_u32 vcc, 1, v2
    s_nop 1
    s_mov_b32 s66, vcc_lo
    s_andn2_b32 s40, s68, s66
    s_cbranch_scc0 nd_go_157
    s_sleep 4
    s_sub_u32 s41, s41, 1
    s_cmp_lg_u32 s41, 0
    s_cbranch_scc1 nd_poll_156
nd_go_157:
    s_mov_b64 exec, -1
nd_ok_155:
    s_add_u32 m0, s65, 65536
    s_nop 0
    buffer_load_dwordx4 v10, s[32:35], s54 offen offset:0 lds
    buffer_load_dwordx4 v10, s[32:35], s54 offen offset:1024 lds
    buffer_load_dwordx4 v10, s[32:35], s54 offen offset:2048 lds
    buffer_load_dwordx4 v10, s[32:35], s54 offen offset:3072 lds
    s_add_u32 s67, s67, 1
    s_cmp_eq_u32 s67, 28
    s_cselect_b32 s58, 0xfffe5000, s59
    s_cselect_b32 s67, 0, s67
    s_add_u32 s54, s54, s58
    s_waitcnt vmcnt(8)
    s_barrier
    s_lshr_b32 s68, s67, 1
    s_lshl_b32 s68, 1, s68
    s_andn2_b32 s40, s68, s66
    s_cbranch_scc0 nd_ok_158
    s_mov_b64 exec, 0x3fff
    s_mov_b32 s41, 200000
nd_poll_159:
    buffer_load_dword v2, v23, s[32:35], s38 offen sc1
    s_waitcnt vmcnt(0)
    v_cmp_eq_u32 vcc, 1, v2
    s_nop 1
    s_mov_b32 s66, vcc_lo
    s_andn2_b32 s40, s68, s66
    s_cbranch_scc0 nd_go_160
    s_sleep 4
    s_sub_u32 s41, s41, 1
    s_cmp_lg_u32 s41, 0
    s_cbranch_scc1 nd_poll_159
nd_go_160:
    s_mov_b64 exec, -1
nd_ok_158:
    s_add_u32 m0, s65, 0
    s_nop 0
    buffer_load_dwordx4 v10, s[32:35], s54 offen offset:0 lds
    buffer_load_dwordx4 v10, s[32:35], s54 offen offset:1024 lds
    buffer_load_dwordx4 v10, s[32:35], s54 offen offset:2048 lds
    buffer_load_dwordx4 v10, s[32:35], s54 offen offset:3072 lds
    s_add_u32 s67, s67, 1
    s_cmp_eq_u32 s67, 28
    s_cselect_b32 s58, 0xfffe5000, s59
    s_cselect_b32 s67, 0, s67
    s_add_u32 s54, s54, s58
    s_waitcnt vmcnt(8)
    s_barrier
    s_lshr_b32 s68, s67, 1
    s_lshl_b32 s68, 1, s68
    s_andn2_b32 s40, s68, s66
    s_cbranch_scc0 nd_ok_161
    s_mov_b64 exec, 0x3fff
    s_mov_b32 s41, 200000
nd_poll_162:
    buffer_load_dword v2, v23, s[32:35], s38 offen sc1
    s_waitcnt vmcnt(0)
    v_cmp_eq_u32 vcc, 1, v2
    s_nop 1
    s_mov_b32 s66, vcc_lo
    s_andn2_b32 s40, s68, s66
    s_cbranch_scc0 nd_go_163
    s_sleep 4
    s_sub_u32 s41, s41, 1
    s_cmp_lg_u32 s41, 0
    s_cbranch_scc1 nd_poll_162
nd_go_163:
    s_mov_b64 exec, -1
nd_ok_161:
    s_add_u32 m0, s65, 16384
    s_nop 0
    buffer_load_dwordx4 v10, s[32:35], s54 offen offset:0 lds
    buffer_load_dwordx4 v10, s[32:35], s54 offen offset:1024 lds
    buffer_load_dwordx4 v10, s[32:35], s54 offen offset:2048 lds
    buffer_load_dwordx4 v10, s[32:35], s54 offen offset:3072 lds
    s_add_u32 s67, s67, 1
    s_cmp_eq_u32 s67, 28
    s_cselect_b32 s58, 0xfffe5000, s59
    s_cselect_b32 s67, 0, s67
    s_add_u32 s54, s54, s58
    s_waitcnt vmcnt(8)
    s_barrier
    s_lshr_b32 s68, s67, 1
    s_lshl_b32 s68, 1, s68
    s_andn2_b32 s40, s68, s66
    s_cbranch_scc0 nd_ok_164
    s_mov_b64 exec, 0x3fff
    s_mov_b32 s41, 200000
nd_poll_165:
    buffer_load_dword v2, v23, s[32:35], s38 offen sc1
    s_waitcnt vmcnt(0)
    v_cmp_eq_u32 vcc, 1, v2
    s_nop 1
    s_mov_b32 s66, vcc_lo
    s_andn2_b32 s40, s68, s66
    s_cbranch_scc0 nd_go_166
    s_sleep 4
    s_sub_u32 s41, s41, 1
    s_cmp_lg_u32 s41, 0
    s_cbranch_scc1 nd_poll_165
nd_go_166:
    s_mov_b64 exec, -1
nd_ok_164:
    s_add_u32 m0, s65, 32768
    s_nop 0
    buffer_load_dwordx4 v10, s[32:35], s54 offen offset:0 lds
    buffer_load_dwordx4 v10, s[32:35], s54 offen offset:1024 lds
    buffer_load_dwordx4 v10, s[32:35], s54 offen offset:2048 lds
    buffer_load_dwordx4 v10, s[32:35], s54 offen offset:3072 lds
    s_waitcnt vmcnt(8)
    s_barrier
    s_waitcnt vmcnt(4)
    s_barrier
    s_waitcnt vmcnt(0)
    s_barrier
    s_barrier
    s_lshl_b32 s67, s50, 1
    s_add_u32 s67, s67, s49
    s_and_b32 s67, s67, 7
    s_mul_i32 s40, s43, 32
    s_lshl_b32 s41, s67, 2
    s_add_u32 s40, s40, s41
    s_lshl_b32 s40, s40, 10
    s_add_u32 s54, s40, 10485760
    s_lshr_b32 s38, s48, 2
    s_lshl_b32 s38, s38, 7
    s_add_u32 s38, s38, 25174016
    s_mov_b32 s66, 0
    s_lshl_b32 s68, s67, 2
    s_lshl_b32 s68, 15, s68
    s_andn2_b32 s40, s68, s66
    s_cbranch_scc0 nd_ok_167
    s_mov_b64 exec, 0xffffffff
    s_mov_b32 s41, 200000
nd_poll_168:
    buffer_load_dword v2, v23, s[32:35], s38 offen sc1
    s_waitcnt vmcnt(0)
    v_cmp_eq_u32 vcc, 1, v2
    s_nop 1
    s_mov_b32 s66, vcc_lo
    s_andn2_b32 s40, s68, s66
    s_cbranch_scc0 nd_go_169
    s_sleep 4
    s_sub_u32 s41, s41, 1
    s_cmp_lg_u32 s41, 0
    s_cbranch_scc1 nd_poll_168
nd_go_169:
    s_mov_b64 exec, -1
nd_ok_167:
    s_add_u32 m0, s65, 0
    s_nop 0
    buffer_load_dwordx4 v10, s[32:35], s54 offen offset:0 lds
    buffer_load_dwordx4 v10, s[32:35], s54 offen offset:1024 lds
    buffer_load_dwordx4 v10, s[32:35], s54 offen offset:2048 lds
    buffer_load_dwordx4 v10, s[32:35], s54 offen offset:3072 lds
    s_add_u32 s67, s67, 1
    s_cmp_eq_u32 s67, 8
    s_cselect_b32 s58, 0xffff9000, s59
    s_cselect_b32 s67, 0, s67
    s_add_u32 s54, s54, s58
    s_lshl_b32 s68, s67, 2
    s_lshl_b32 s68, 15, s68
    s_andn2_b32 s40, s68, s66
    s_cbranch_scc0 nd_ok_170
    s_mov_b64 exec, 0xffffffff
    s_mov_b32 s41, 200000
nd_poll_171:
    buffer_load_dword v2, v23, s[32:35], s38 offen sc1
    s_waitcnt vmcnt(0)
    v_cmp_eq_u32 vcc, 1, v2
    s_nop 1
    s_mov_b32 s66, vcc_lo
    s_andn2_b32 s40, s68, s66
    s_cbranch_scc0 nd_go_172
    s_sleep 4
    s_sub_u32 s41, s41, 1
    s_cmp_lg_u32 s41, 0
    s_cbranch_scc1 nd_poll_171
nd_go_172:
    s_mov_b64 exec, -1
nd_ok_170:
    s_add_u32 m0, s65, 16384
    s_nop 0
    buffer_load_dwordx4 v10, s[32:35], s54 offen offset:0 lds
    buffer_load_dwordx4 v10, s[32:35], s54 offen offset:1024 lds
    buffer_load_dwordx4 v10, s[32:35], s54 offen offset:2048 lds
    buffer_load_dwordx4 v10, s[32:35], s54 offen offset:3072 lds
    s_add_u32 s67, s67, 1
    s_cmp_eq_u32 s67, 8
    s_cselect_b32 s58, 0xffff9000, s59
    s_cselect_b32 s67, 0, s67
    s_add_u32 s54, s54, s58
    s_lshl_b32 s68, s67, 2
    s_lshl_b32 s68, 15, s68
    s_andn2_b32 s40, s68, s66
    s_cbranch_scc0 nd_ok_173
    s_mov_b64 exec, 0xffffffff
    s_mov_b32 s41, 200000
nd_poll_174:
    buffer_load_dword v2, v23, s[32:35], s38 offen sc1
    s_waitcnt vmcnt(0)
    v_cmp_eq_u32 vcc, 1, v2
    s_nop 1
    s_mov_b32 s66, vcc_lo
    s_andn2_b32 s40, s68, s66
    s_cbranch_scc0 nd_go_175
    s_sleep 4
    s_sub_u32 s41, s41, 1
    s_cmp_lg_u32 s41, 0
    s_cbranch_scc1 nd_poll_174
nd_go_175:
    s_mov_b64 exec, -1
nd_ok_173:
    s_add_u32 m0, s65, 32768
    s_nop 0
    buffer_load_dwordx4 v10, s[32:35], s54 offen offset:0 lds
    buffer_load_dwordx4 v10, s[32:35], s54 offen offset:1024 lds
    buffer_load_dwordx4 v10, s[32:35], s54 offen offset:2048 lds
    buffer_load_dwordx4 v10, s[32:35], s54 offen offset:3072 lds
    s_add_u32 s67, s67, 1
    s_cmp_eq_u32 s67, 8
    s_cselect_b32 s58, 0xffff9000, s59
    s_cselect_b32 s67, 0, s67
    s_add_u32 s54, s54, s58
    s_lshl_b32 s68, s67, 2
    s_lshl_b32 s68, 15, s68
    s_andn2_b32 s40, s68, s66
    s_cbranch_scc0 nd_ok_176
    s_mov_b64 exec, 0xffffffff
    s_mov_b32 s41, 200000
nd_poll_177:
    buffer_load_dword v2, v23, s[32:35], s38 offen sc1
    s_waitcnt vmcnt(0)
    v_cmp_eq_u32 vcc, 1, v2
    s_nop 1
    s_mov_b32 s66, vcc_lo
    s_andn2_b32 s40, s68, s66
    s_cbranch_scc0 nd_go_178
    s_sleep 4
    s_sub_u32 s41, s41, 1
    s_cmp_lg_u32 s41, 0
    s_cbranch_scc1 nd_poll_177
nd_go_178:
    s_mov_b64 exec, -1
nd_ok_176:
    s_add_u32 m0, s65, 49152
    s_nop 0
    buffer_load_dwordx4 v10, s[32:35], s54 offen offset:0 lds
    buffer_load_dwordx4 v10, s[32:35], s54 offen offset:1024 lds
    buffer_load_dwordx4 v10, s[32:35], s54 offen offset:2048 lds
    buffer_load_dwordx4 v10, s[32:35], s54 offen offset:3072 lds
    s_add_u32 s67, s67, 1
    s_cmp_eq_u32 s67, 8
    s_cselect_b32 s58, 0xffff9000, s59
    s_cselect_b32 s67, 0, s67
    s_add_u32 s54, s54, s58
    s_lshl_b32 s68, s67, 2
    s_lshl_b32 s68, 15, s68
    s_andn2_b32 s40, s68, s66
    s_cbranch_scc0 nd_ok_179
    s_mov_b64 exec, 0xffffffff
    s_mov_b32 s41, 200000
nd_poll_180:
    buffer_load_dword v2, v23, s[32:35], s38 offen sc1
    s_waitcnt vmcnt(0)
    v_cmp_eq_u32 vcc, 1, v2
    s_nop 1
    s_mov_b32 s66, vcc_lo
    s_andn2_b32 s40, s68, s66
    s_cbranch_scc0 nd_go_181
    s_sleep 4
    s_sub_u32 s41, s41, 1
    s_cmp_lg_u32 s41, 0
    s_cbranch_scc1 nd_poll_180
nd_go_181:
    s_mov_b64 exec, -1
nd_ok_179:
    s_add_u32 m0, s65, 65536
    s_nop 0
    buffer_load_dwordx4 v10, s[32:35], s54 offen offset:0 lds
    buffer_load_dwordx4 v10, s[32:35], s54 offen offset:1024 lds
    buffer_load_dwordx4 v10, s[32:35], s54 offen offset:2048 lds
    buffer_load_dwordx4 v10, s[32:35], s54 offen offset:3072 lds
    s_add_u32 s67, s67, 1
    s_cmp_eq_u32 s67, 8
    s_cselect_b32 s58, 0xffff9000, s59
    s_cselect_b32 s67, 0, s67
    s_add_u32 s54, s54, s58
    s_waitcnt vmcnt(16)
    s_barrier
    s_waitcnt vmcnt(12)
    s_barrier
    s_waitcnt vmcnt(8)
    s_barrier
    s_lshl_b32 s68, s67, 2
    s_lshl_b32 s68, 15, s68
    s_andn2_b32 s40, s68, s66
    s_cbranch_scc0 nd_ok_182
    s_mov_b64 exec, 0xffffffff
    s_mov_b32 s41, 200000
nd_poll_183:
    buffer_load_dword v2, v23, s[32:35], s38 offen sc1
    s_waitcnt vmcnt(0)
    v_cmp_eq_u32 vcc, 1, v2
    s_nop 1
    s_mov_b32 s66, vcc_lo
    s_andn2_b32 s40, s68, s66
    s_cbranch_scc0 nd_go_184
    s_sleep 4
    s_sub_u32 s41, s41, 1
    s_cmp_lg_u32 s41, 0
    s_cbranch_scc1 nd_poll_183
nd_go_184:
    s_mov_b64 exec, -1
nd_ok_182:
    s_add_u32 m0, s65, 0
    s_nop 0
    buffer_load_dwordx4 v10, s[32:35], s54 offen offset:0 lds
    buffer_load_dwordx4 v10, s[32:35], s54 offen offset:1024 lds
    buffer_load_dwordx4 v10, s[32:35], s54 offen offset:2048 lds
    buffer_load_dwordx4 v10, s[32:35], s54 offen offset:3072 lds
    s_add_u32 s67, s67, 1
    s_cmp_eq_u32 s67, 8
    s_cselect_b32 s58, 0xffff9000, s59
    s_cselect_b32 s67, 0, s67
    s_add_u32 s54, s54, s58
    s_waitcnt vmcnt(8)
    s_barrier
    s_lshl_b32 s68, s67, 2
    s_lshl_b32 s68, 15, s68
    s_andn2_b32 s40, s68, s66
    s_cbranch_scc0 nd_ok_185
    s_mov_b64 exec, 0xffffffff
    s_mov_b32 s41, 200000
nd_poll_186:
    buffer_load_dword v2, v23, s[32:35], s38 offen sc1
    s_waitcnt vmcnt(0)
    v_cmp_eq_u32 vcc, 1, v2
    s_nop 1
    s_mov_b32 s66, vcc_lo
    s_andn2_b32 s40, s68, s66
    s_cbranch_scc0 nd_go_187
    s_sleep 4
    s_sub_u32 s41, s41, 1
    s_cmp_lg_u32 s41, 0
    s_cbranch_scc1 nd_poll_186
nd_go_187:
    s_mov_b64 exec, -1
nd_ok_185:
    s_add_u32 m0, s65, 16384
    s_nop 0
    buffer_load_dwordx4 v10, s[32:35], s54 offen offset:0 lds
    buffer_load_dwordx4 v10, s[32:35], s54 offen offset:1024 lds
    buffer_load_dwordx4 v10, s[32:35], s54 offen offset:2048 lds
    buffer_load_dwordx4 v10, s[32:35], s54 offen offset:3072 lds
    s_add_u32 s67, s67, 1
    s_cmp_eq_u32 s67, 8
    s_cselect_b32 s58, 0xffff9000, s59
    s_cselect_b32 s67, 0, s67
    s_add_u32 s54, s54, s58
    s_waitcnt vmcnt(8)
    s_barrier
    s_lshl_b32 s68, s67, 2
    s_lshl_b32 s68, 15, s68
    s_andn2_b32 s40, s68, s66
    s_cbranch_scc0 nd_ok_188
    s_mov_b64 exec, 0xffffffff
    s_mov_b32 s41, 200000
nd_poll_189:
    buffer_load_dword v2, v23, s[32:35], s38 offen sc1
    s_waitcnt vmcnt(0)
    v_cmp_eq_u32 vcc, 1, v2
    s_nop 1
    s_mov_b32 s66, vcc_lo
    s_andn2_b32 s40, s68, s66
    s_cbranch_scc0 nd_go_190
    s_sleep 4
    s_sub_u32 s41, s41, 1
    s_cmp_lg_u32 s41, 0
    s_cbranch_scc1 nd_poll_189
nd_go_190:
    s_mov_b64 exec, -1
nd_ok_188:
    s_add_u32 m0, s65, 32768
    s_nop 0
    buffer_load_dwordx4 v10, s[32:35], s54 offen offset:0 lds
    buffer_load_dwordx4 v10, s[32:35], s54 offen offset:1024 lds
    buffer_load_dwordx4 v10, s[32:35], s54 offen offset:2048 lds
    buffer_load_dwordx4 v10, s[32:35], s54 offen offset:3072 lds
    s_waitcnt vmcnt(8)
    s_barrier
    s_waitcnt vmcnt(4)
    s_barrier
    s_waitcnt vmcnt(0)
    s_barrier
    s_branch k2_kernel_end_20
k2_wp_31:
    s_add_u32 s65, s65, 8192
    v_add_u32 v29, 0, v13
    v_add_u32 v30, 7168, v13
    v_add_u32 v31, 14336, v13
    v_add_u32 v32, 21504, v13
    s_lshl_b32 s55, s47, 15
    s_lshl_b32 s40, s49, 7
    s_add_u32 s55, s55, s40
    s_add_u32 m0, s65, 0
    s_nop 0
    buffer_load_dwordx4 v29, s[12:15], s55 offen offset:0 lds
    buffer_load_dwordx4 v30, s[12:15], s55 offen offset:1024 lds
    buffer_load_dwordx4 v31, s[12:15], s55 offen offset:2048 lds
    buffer_load_dwordx4 v32, s[12:15], s55 offen offset:3072 lds
    s_add_u32 s55, s55, 65536
    s_add_u32 m0, s65, 16384
    s_nop 0
    buffer_load_dwordx4 v29, s[12:15], s55 offen offset:0 lds
    buffer_load_dwordx4 v30, s[12:15], s55 offen offset:1024 lds
    buffer_load_dwordx4 v31, s[12:15], s55 offen offset:2048 lds
    buffer_load_dwordx4 v32, s[12:15], s55 offen offset:3072 lds
    s_add_u32 s55, s55, 65536
    s_add_u32 m0, s65, 32768
    s_nop 0
    buffer_load_dwordx4 v29, s[12:15], s55 offen offset:0 lds
    buffer_load_dwordx4 v30, s[12:15], s55 offen offset:1024 lds
    buffer_load_dwordx4 v31, s[12:15], s55 offen offset:2048 lds
    buffer_load_dwordx4 v32, s[12:15], s55 offen offset:3072 lds
    s_add_u32 s55, s55, 65536
    s_add_u32 m0, s65, 49152
    s_nop 0
    buffer_load_dwordx4 v29, s[12:15], s55 offen offset:0 lds
    buffer_load_dwordx4 v30, s[12:15], s55 offen offset:1024 lds
    buffer_load_dwordx4 v31, s[12:15], s55 offen offset:2048 lds
    buffer_load_dwordx4 v32, s[12:15], s55 offen offset:3072 lds
    s_add_u32 s55, s55, 65536
    s_add_u32 m0, s65, 65536
    s_nop 0
    buffer_load_dwordx4 v29, s[12:15], s55 offen offset:0 lds
    buffer_load_dwordx4 v30, s[12:15], s55 offen offset:1024 lds
    buffer_load_dwordx4 v31, s[12:15], s55 offen offset:2048 lds
    buffer_load_dwordx4 v32, s[12:15], s55 offen offset:3072 lds
    s_add_u32 s55, s55, 65536
    s_waitcnt vmcnt(16)
    s_barrier
    s_waitcnt vmcnt(12)
    s_barrier
    s_waitcnt vmcnt(8)
    s_barrier
    s_add_u32 m0, s65, 0
    s_nop 0
    buffer_load_dwordx4 v29, s[12:15], s55 offen offset:0 lds
    buffer_load_dwordx4 v30, s[12:15], s55 offen offset:1024 lds
    buffer_load_dwordx4 v31, s[12:15], s55 offen offset:2048 lds
    buffer_load_dwordx4 v32, s[12:15], s55 offen offset:3072 lds
    s_add_u32 s55, s55, 65536
    s_waitcnt vmcnt(8)
    s_barrier
    s_add_u32 m0, s65, 16384
    s_nop 0
    buffer_load_dwordx4 v29, s[12:15], s55 offen offset:0 lds
    buffer_load_dwordx4 v30, s[12:15], s55 offen offset:1024 lds
    buffer_load_dwordx4 v31, s[12:15], s55 offen offset:2048 lds
    buffer_load_dwordx4 v32, s[12:15], s55 offen offset:3072 lds
    s_add_u32 s55, s55, 65536
    s_waitcnt vmcnt(8)
    s_barrier
    s_add_u32 m0, s65, 32768
    s_nop 0
    buffer_load_dwordx4 v29, s[12:15], s55 offen offset:0 lds
    buffer_load_dwordx4 v30, s[12:15], s55 offen offset:1024 lds
    buffer_load_dwordx4 v31, s[12:15], s55 offen offset:2048 lds
    buffer_load_dwordx4 v32, s[12:15], s55 offen offset:3072 lds
    s_add_u32 s55, s55, 65536
    s_waitcnt vmcnt(8)
    s_barrier
    v_lshrrev_b32 v2, 4, v1
    v_lshlrev_b32 v3, 2, v2
    v_and_b32 v4, 15, v1
    v_xor_b32 v3, v3, v4
    v_mul_u32_u24 v2, 3584, v2
    v_lshl_add_u32 v24, v3, 4, v2
    v_add_u32 v25, 13312, v24
    v_add_u32 v26, 26624, v24
    v_add_u32 v27, 39936, v24
    s_waitcnt vmcnt(4)
    s_barrier
    s_waitcnt vmcnt(0)
    s_barrier
    s_barrier
    s_cmp_lt_u32 s63, 28
    s_cbranch_scc1 k2_w4_192
    s_branch k2_w5_191
k2_w4_192:
    s_and_b32 s42, s63, 1
    s_lshl_b32 s42, s42, 3
    s_add_u32 s42, s42, s62
    s_and_b32 s67, s42, 15
    s_mov_b32 s60, 114688
    s_mul_i32 s55, s47, 57344
    s_lshl_b32 s40, s62, 8
    s_add_u32 s55, s55, s40
    s_mul_i32 s40, s67, 114688
    s_add_u32 s55, s55, s40
    s_add_u32 m0, s65, 0
    s_nop 0
    buffer_load_dwordx4 v24, s[16:19], s55 offen offset:0 lds
    buffer_load_dwordx4 v25, s[16:19], s55 offen offset:1024 lds
    buffer_load_dwordx4 v26, s[16:19], s55 offen offset:2048 lds
    buffer_load_dwordx4 v27, s[16:19], s55 offen offset:3072 lds
    s_add_u32 s67, s67, 1
    s_cmp_eq_u32 s67, 16
    s_cselect_b32 s58, 0xffe5c000, s60
    s_cselect_b32 s67, 0, s67
    s_add_u32 s55, s55, s58
    s_add_u32 m0, s65, 16384
    s_nop 0
    buffer_load_dwordx4 v24, s[16:19], s55 offen offset:0 lds
    buffer_load_dwordx4 v25, s[16:19], s55 offen offset:1024 lds
    buffer_load_dwordx4 v26, s[16:19], s55 offen offset:2048 lds
    buffer_load_dwordx4 v27, s[16:19], s55 offen offset:3072 lds
    s_add_u32 s67, s67, 1
    s_cmp_eq_u32 s67, 16
    s_cselect_b32 s58, 0xffe5c000, s60
    s_cselect_b32 s67, 0, s67
    s_add_u32 s55, s55, s58
    s_add_u32 m0, s65, 32768
    s_nop 0
    buffer_load_dwordx4 v24, s[16:19], s55 offen offset:0 lds
    buffer_load_dwordx4 v25, s[16:19], s55 offen offset:1024 lds
    buffer_load_dwordx4 v26, s[16:19], s55 offen offset:2048 lds
    buffer_load_dwordx4 v27, s[16:19], s55 offen offset:3072 lds
    s_add_u32 s67, s67, 1
    s_cmp_eq_u32 s67, 16
    s_cselect_b32 s58, 0xffe5c000, s60
    s_cselect_b32 s67, 0, s67
    s_add_u32 s55, s55, s58
    s_add_u32 m0, s65, 49152
    s_nop 0
    buffer_load_dwordx4 v24, s[16:19], s55 offen offset:0 lds
    buffer_load_dwordx4 v25, s[16:19], s55 offen offset:1024 lds
    buffer_load_dwordx4 v26, s[16:19], s55 offen offset:2048 lds
    buffer_load_dwordx4 v27, s[16:19], s55 offen offset:3072 lds
    s_add_u32 s67, s67, 1
    s_cmp_eq_u32 s67, 16
    s_cselect_b32 s58, 0xffe5c000, s60
    s_cselect_b32 s67, 0, s67
    s_add_u32 s55, s55, s58
    s_add_u32 m0, s65, 65536
    s_nop 0
    buffer_load_dwordx4 v24, s[16:19], s55 offen offset:0 lds
    buffer_load_dwordx4 v25, s[16:19], s55 offen offset:1024 lds
    buffer_load_dwordx4 v26, s[16:19], s55 offen offset:2048 lds
    buffer_load_dwordx4 v27, s[16:19], s55 offen offset:3072 lds
    s_add_u32 s67, s67, 1
    s_cmp_eq_u32 s67, 16
    s_cselect_b32 s58, 0xffe5c000, s60
    s_cselect_b32 s67, 0, s67
    s_add_u32 s55, s55, s58
    s_lshl_b32 s40, s62, 9
    s_lshl_b32 s41, s47, 8
    s_add_u32 s40, s40, s41
    s_add_u32 s40, s40, 23134208
    buffer_load_dword v68, v23, s[32:35], s40 offen
    s_add_u32 s40, s40, 7168
    buffer_load_dword v69, v23, s[32:35], s40 offen
    s_add_u32 s40, s40, 7168
    buffer_load_dword v70, v23, s[32:35], s40 offen
    s_add_u32 s40, s40, 7168
    buffer_load_dword v71, v23, s[32:35], s40 offen
    s_add_u32 s40, s40, 7168
    buffer_load_dword v72, v23, s[32:35], s40 offen
    s_add_u32 s40, s40, 7168
    buffer_load_dword v73, v23, s[32:35], s40 offen
    s_add_u32 s40, s40, 7168
    buffer_load_dword v74, v23, s[32:35], s40 offen
    s_add_u32 s40, s40, 7168
    buffer_load_dword v75, v23, s[32:35], s40 offen
    s_barrier
    s_waitcnt vmcnt(24)
    s_barrier
    s_waitcnt vmcnt(20)
    s_barrier
    s_waitcnt vmcnt(16)
    s_barrier
    s_add_u32 m0, s65, 0
    s_nop 0
    buffer_load_dwordx4 v24, s[16:19], s55 offen offset:0 lds
    buffer_load_dwordx4 v25, s[16:19], s55 offen offset:1024 lds
    buffer_load_dwordx4 v26, s[16:19], s55 offen offset:2048 lds
    buffer_load_dwordx4 v27, s[16:19], s55 offen offset:3072 lds
    s_add_u32 s67, s67, 1
    s_cmp_eq_u32 s67, 16
    s_cselect_b32 s58, 0xffe5c000, s60
    s_cselect_b32 s67, 0, s67
    s_add_u32 s55, s55, s58
    s_waitcnt vmcnt(16)
    s_barrier
    s_add_u32 m0, s65, 16384
    s_nop 0
    buffer_load_dwordx4 v24, s[16:19], s55 offen offset:0 lds
    buffer_load_dwordx4 v25, s[16:19], s55 offen offset:1024 lds
    buffer_load_dwordx4 v26, s[16:19], s55 offen offset:2048 lds
    buffer_load_dwordx4 v27, s[16:19], s55 offen offset:3072 lds
    s_add_u32 s67, s67, 1
    s_cmp_eq_u32 s67, 16
    s_cselect_b32 s58, 0xffe5c000, s60
    s_cselect_b32 s67, 0, s67
    s_add_u32 s55, s55, s58
    s_waitcnt vmcnt(16)
    s_barrier
    s_add_u32 m0, s65, 32768
    s_nop 0
    buffer_load_dwordx4 v24, s[16:19], s55 offen offset:0 lds
    buffer_load_dwordx4 v25, s[16:19], s55 offen offset:1024 lds
    buffer_load_dwordx4 v26, s[16:19], s55 offen offset:2048 lds
    buffer_load_dwordx4 v27, s[16:19], s55 offen offset:3072 lds
    s_add_u32 s67, s67, 1
    s_cmp_eq_u32 s67, 16
    s_cselect_b32 s58, 0xffe5c000, s60
    s_cselect_b32 s67, 0, s67
    s_add_u32 s55, s55, s58
    s_waitcnt vmcnt(8)
    s_barrier
    s_add_u32 m0, s65, 49152
    s_nop 0
    buffer_load_dwordx4 v24, s[16:19], s55 offen offset:0 lds
    buffer_load_dwordx4 v25, s[16:19], s55 offen offset:1024 lds
    buffer_load_dwordx4 v26, s[16:19], s55 offen offset:2048 lds
    buffer_load_dwordx4 v27, s[16:19], s55 offen offset:3072 lds
    s_add_u32 s67, s67, 1
    s_cmp_eq_u32 s67, 16
    s_cselect_b32 s58, 0xffe5c000, s60
    s_cselect_b32 s67, 0, s67
    s_add_u32 s55, s55, s58
    s_waitcnt vmcnt(8)
    s_barrier
    s_add_u32 m0, s65, 65536
    s_nop 0
    buffer_load_dwordx4 v24, s[16:19], s55 offen offset:0 lds
    buffer_load_dwordx4 v25, s[16:19], s55 offen offset:1024 lds
    buffer_load_dwordx4 v26, s[16:19], s55 offen offset:2048 lds
    buffer_load_dwordx4 v27, s[16:19], s55 offen offset:3072 lds
    s_add_u32 s67, s67, 1
    s_cmp_eq_u32 s67, 16
    s_cselect_b32 s58, 0xffe5c000, s60
    s_cselect_b32 s67, 0, s67
    s_add_u32 s55, s55, s58
    s_waitcnt vmcnt(8)
    s_barrier
    s_add_u32 m0, s65, 0
    s_nop 0
    buffer_load_dwordx4 v24, s[16:19], s55 offen offset:0 lds
    buffer_load_dwordx4 v25, s[16:19], s55 offen offset:1024 lds
    buffer_load_dwordx4 v26, s[16:19], s55 offen offset:2048 lds
    buffer_load_dwordx4 v27, s[16:19], s55 offen offset:3072 lds
    s_add_u32 s67, s67, 1
    s_cmp_eq_u32 s67, 16
    s_cselect_b32 s58, 0xffe5c000, s60
    s_cselect_b32 s67, 0, s67
    s_add_u32 s55, s55, s58
    s_waitcnt vmcnt(8)
    s_barrier
    s_add_u32 m0, s65, 16384
    s_nop 0
    buffer_load_dwordx4 v24, s[16:19], s55 offen offset:0 lds
    buffer_load_dwordx4 v25, s[16:19], s55 offen offset:1024 lds
    buffer_load_dwordx4 v26, s[16:19], s55 offen offset:2048 lds
    buffer_load_dwordx4 v27, s[16:19], s55 offen offset:3072 lds
    s_add_u32 s67, s67, 1
    s_cmp_eq_u32 s67, 16
    s_cselect_b32 s58, 0xffe5c000, s60
    s_cselect_b32 s67, 0, s67
    s_add_u32 s55, s55, s58
    s_waitcnt vmcnt(8)
    s_barrier
    s_add_u32 m0, s65, 32768
    s_nop 0
    buffer_load_dwordx4 v24, s[16:19], s55 offen offset:0 lds
    buffer_load_dwordx4 v25, s[16:19], s55 offen offset:1024 lds
    buffer_load_dwordx4 v26, s[16:19], s55 offen offset:2048 lds
    buffer_load_dwordx4 v27, s[16:19], s55 offen offset:3072 lds
    s_add_u32 s67, s67, 1
    s_cmp_eq_u32 s67, 16
    s_cselect_b32 s58, 0xffe5c000, s60
    s_cselect_b32 s67, 0, s67
    s_add_u32 s55, s55, s58
    s_waitcnt vmcnt(8)
    s_barrier
    s_add_u32 m0, s65, 49152
    s_nop 0
    buffer_load_dwordx4 v24, s[16:19], s55 offen offset:0 lds
    buffer_load_dwordx4 v25, s[16:19], s55 offen offset:1024 lds
    buffer_load_dwordx4 v26, s[16:19], s55 offen offset:2048 lds
    buffer_load_dwordx4 v27, s[16:19], s55 offen offset:3072 lds
    s_add_u32 s67, s67, 1
    s_cmp_eq_u32 s67, 16
    s_cselect_b32 s58, 0xffe5c000, s60
    s_cselect_b32 s67, 0, s67
    s_add_u32 s55, s55, s58
    s_waitcnt vmcnt(8)
    s_barrier
    s_add_u32 m0, s65, 65536
    s_nop 0
    buffer_load_dwordx4 v24, s[16:19], s55 offen offset:0 lds
    buffer_load_dwordx4 v25, s[16:19], s55 offen offset:1024 lds
    buffer_load_dwordx4 v26, s[16:19], s55 offen offset:2048 lds
    buffer_load_dwordx4 v27, s[16:19], s55 offen offset:3072 lds
    s_add_u32 s67, s67, 1
    s_cmp_eq_u32 s67, 16
    s_cselect_b32 s58, 0xffe5c000, s60
    s_cselect_b32 s67, 0, s67
    s_add_u32 s55, s55, s58
    s_waitcnt vmcnt(8)
    s_barrier
    s_add_u32 m0, s65, 0
    s_nop 0
    buffer_load_dwordx4 v24, s[16:19], s55 offen offset:0 lds
    buffer_load_dwordx4 v25, s[16:19], s55 offen offset:1024 lds
    buffer_load_dwordx4 v26, s[16:19], s55 offen offset:2048 lds
    buffer_load_dwordx4 v27, s[16:19], s55 offen offset:3072 lds
    s_waitcnt vmcnt(8)
    s_barrier
    s_lshl_b32 s44, s61, 2
    s_add_u32 s44, s44, s39
    s_lshl_b32 s40, s44, 13
    s_add_u32 s40, s40, 24117248
    v_lshlrev_b32 v2, 7, v11
    v_lshl_add_u32 v2, v12, 8, v2
    buffer_load_dwordx4 v[36:39], v2, s[32:35], s40 offen offset:0
    buffer_load_dwordx4 v[40:43], v2, s[32:35], s40 offen offset:16
    buffer_load_dwordx4 v[44:47], v2, s[32:35], s40 offen offset:32
    buffer_load_dwordx4 v[48:51], v2, s[32:35], s40 offen offset:48
    buffer_load_dwordx4 v[52:55], v2, s[32:35], s40 offen offset:64
    buffer_load_dwordx4 v[56:59], v2, s[32:35], s40 offen offset:80
    buffer_load_dwordx4 v[60:63], v2, s[32:35], s40 offen offset:96
    buffer_load_dwordx4 v[64:67], v2, s[32:35], s40 offen offset:112
    s_waitcnt vmcnt(12)
    s_barrier
    s_waitcnt vmcnt(8)
    s_barrier
    s_waitcnt vmcnt(0)
    v_pk_add_f32 v[36:37], v[36:37], v[40:41]
    v_pk_add_f32 v[44:45], v[44:45], v[48:49]
    v_pk_add_f32 v[52:53], v[52:53], v[56:57]
    v_pk_add_f32 v[60:61], v[60:61], v[64:65]
    v_pk_add_f32 v[36:37], v[36:37], v[44:45]
    v_pk_add_f32 v[52:53], v[52:53], v[60:61]
    v_pk_add_f32 v[36:37], v[36:37], v[52:53]
    v_mov_b32 v4, v36
    v_mov_b32 v5, v37
    s_nop 1
    v_permlane32_swap_b32 v4, v36
    v_permlane32_swap_b32 v5, v37
    v_add_f32 v36, v36, v4
    v_add_f32 v37, v37, v5
    v_mul_f32 v79, 0xbb000000, v36
    v_mul_f32 v37, 0x3b000000, v37
    v_fma_f32 v37, -v79, v79, v37
    v_max_f32 v37, 0, v37
    v_add_f32 v37, 0x3727c5ac, v37
    v_rsq_f32 v38, v37
    v_sqrt_f32 v78, v37
    v_mul_f32 v76, 0xc0135761, v38
    v_mul_f32 v39, v38, v38
    v_mul_f32 v39, v39, v38
    v_mul_f32 v77, 0xbdd2d3e8, v39
    s_lshl_b32 s40, s39, 9
    v_lshlrev_b32 v7, 4, v12
    v_add_u32 v7, s40, v7
    v_pk_add_f32 v[68:69], v[68:69], v[70:71]
    v_pk_add_f32 v[72:73], v[72:73], v[74:75]
    v_pk_add_f32 v[68:69], v[68:69], v[72:73]
    v_add_f32 v68, v68, v69
    s_lshl_b32 s40, s47, 8
    v_add_u32 v6, s40, v23
    s_barrier
    ds_write_b32 v6, v68
    ds_write_b128 v7, v[76:79] offset:1024
    v_mov_b32 v2, 0
    v_mov_b32 v3, 4096
    ds_write_b32 v3, v2
    s_waitcnt lgkmcnt(0)
    s_barrier
    s_barrier
k2_w5_191:
    s_waitcnt vmcnt(0)
    s_mov_b32 s60, 65536
    s_mul_i32 s67, s49, 3
    s_mul_i32 s40, s50, 7
    s_add_u32 s67, s67, s40
    s_sub_u32 s40, s67, 28
    s_min_u32 s67, s67, s40
    s_lshl_b32 s55, s47, 15
    s_lshl_b32 s40, s49, 7
    s_add_u32 s55, s55, s40
    s_lshl_b32 s40, s67, 16
    s_add_u32 s55, s55, s40
    s_add_u32 m0, s65, 0
    s_nop 0
    buffer_load_dwordx4 v29, s[20:23], s55 offen offset:0 lds
    buffer_load_dwordx4 v30, s[20:23], s55 offen offset:1024 lds
    buffer_load_dwordx4 v31, s[20:23], s55 offen offset:2048 lds
    buffer_load_dwordx4 v32, s[20:23], s55 offen offset:3072 lds
    s_add_u32 s67, s67, 1
    s_cmp_eq_u32 s67, 28
    s_cselect_b32 s58, 0xffe50000, s60
    s_cselect_b32 s67, 0, s67
    s_add_u32 s55, s55, s58
    s_add_u32 m0, s65, 16384
    s_nop 0
    buffer_load_dwordx4 v29, s[20:23], s55 offen offset:0 lds
    buffer_load_dwordx4 v30, s[20:23], s55 offen offset:1024 lds
    buffer_load_dwordx4 v31, s[20:23], s55 offen offset:2048 lds
    buffer_load_dwordx4 v32, s[20:23], s55 offen offset:3072 lds
    s_add_u32 s67, s67, 1
    s_cmp_eq_u32 s67, 28
    s_cselect_b32 s58, 0xffe50000, s60
    s_cselect_b32 s67, 0, s67
    s_add_u32 s55, s55, s58
    s_add_u32 m0, s65, 32768
    s_nop 0
    buffer_load_dwordx4 v29, s[20:23], s55 offen offset:0 lds
    buffer_load_dwordx4 v30, s[20:23], s55 offen offset:1024 lds
    buffer_load_dwordx4 v31, s[20:23], s55 offen offset:2048 lds
    buffer_load_dwordx4 v32, s[20:23], s55 offen offset:3072 lds
    s_add_u32 s67, s67, 1
    s_cmp_eq_u32 s67, 28
    s_cselect_b32 s58, 0xffe50000, s60
    s_cselect_b32 s67, 0, s67
    s_add_u32 s55, s55, s58
    s_add_u32 m0, s65, 49152
    s_nop 0
    buffer_load_dwordx4 v29, s[20:23], s55 offen offset:0 lds
    buffer_load_dwordx4 v30, s[20:23], s55 offen offset:1024 lds
    buffer_load_dwordx4 v31, s[20:23], s55 offen offset:2048 lds
    buffer_load_dwordx4 v32, s[20:23], s55 offen offset:3072 lds
    s_add_u32 s67, s67, 1
    s_cmp_eq_u32 s67, 28
    s_cselect_b32 s58, 0xffe50000, s60
    s_cselect_b32 s67, 0, s67
    s_add_u32 s55, s55, s58
    s_add_u32 m0, s65, 65536
    s_nop 0
    buffer_load_dwordx4 v29, s[20:23], s55 offen offset:0 lds
    buffer_load_dwordx4 v30, s[20:23], s55 offen offset:1024 lds
    buffer_load_dwordx4 v31, s[20:23], s55 offen offset:2048 lds
    buffer_load_dwordx4 v32, s[20:23], s55 offen offset:3072 lds
    s_add_u32 s67, s67, 1
    s_cmp_eq_u32 s67, 28
    s_cselect_b32 s58, 0xffe50000, s60
    s_cselect_b32 s67, 0, s67
    s_add_u32 s55, s55, s58
    s_barrier
    s_waitcnt vmcnt(16)
    s_barrier
    s_waitcnt vmcnt(12)
    s_barrier
    s_waitcnt vmcnt(8)
    s_barrier
    s_add_u32 m0, s65, 0
    s_nop 0
    buffer_load_dwordx4 v29, s[20:23], s55 offen offset:0 lds
    buffer_load_dwordx4 v30, s[20:23], s55 offen offset:1024 lds
    buffer_load_dwordx4 v31, s[20:23], s55 offen offset:2048 lds
    buffer_load_dwordx4 v32, s[20:23], s55 offen offset:3072 lds
    s_add_u32 s67, s67, 1
    s_cmp_eq_u32 s67, 28
    s_cselect_b32 s58, 0xffe50000, s60
    s_cselect_b32 s67, 0, s67
    s_add_u32 s55, s55, s58
    s_waitcnt vmcnt(8)
    s_barrier
    s_add_u32 m0, s65, 16384
    s_nop 0
    buffer_load_dwordx4 v29, s[20:23], s55 offen offset:0 lds
    buffer_load_dwordx4 v30, s[20:23], s55 offen offset:1024 lds
    buffer_load_dwordx4 v31, s[20:23], s55 offen offset:2048 lds
    buffer_load_dwordx4 v32, s[20:23], s55 offen offset:3072 lds
    s_add_u32 s67, s67, 1
    s_cmp_eq_u32 s67, 28
    s_cselect_b32 s58, 0xffe50000, s60
    s_cselect_b32 s67, 0, s67
    s_add_u32 s55, s55, s58
    s_waitcnt vmcnt(8)
    s_barrier
    s_add_u32 m0, s65, 32768
    s_nop 0
    buffer_load_dwordx4 v29, s[20:23], s55 offen offset:0 lds
    buffer_load_dwordx4 v30, s[20:23], s55 offen offset:1024 lds
    buffer_load_dwordx4 v31, s[20:23], s55 offen offset:2048 lds
    buffer_load_dwordx4 v32, s[20:23], s55 offen offset:3072 lds
    s_add_u32 s67, s67, 1
    s_cmp_eq_u32 s67, 28
    s_cselect_b32 s58, 0xffe50000, s60
    s_cselect_b32 s67, 0, s67
    s_add_u32 s55, s55, s58
    s_waitcnt vmcnt(8)
    s_barrier
    s_add_u32 m0, s65, 49152
    s_nop 0
    buffer_load_dwordx4 v29, s[20:23], s55 offen offset:0 lds
    buffer_load_dwordx4 v30, s[20:23], s55 offen offset:1024 lds
    buffer_load_dwordx4 v31, s[20:23], s55 offen offset:2048 lds
    buffer_load_dwordx4 v32, s[20:23], s55 offen offset:3072 lds
    s_add_u32 s67, s67, 1
    s_cmp_eq_u32 s67, 28
    s_cselect_b32 s58, 0xffe50000, s60
    s_cselect_b32 s67, 0, s67
    s_add_u32 s55, s55, s58
    s_waitcnt vmcnt(8)
    s_barrier
    s_add_u32 m0, s65, 65536
    s_nop 0
    buffer_load_dwordx4 v29, s[20:23], s55 offen offset:0 lds
    buffer_load_dwordx4 v30, s[20:23], s55 offen offset:1024 lds
    buffer_load_dwordx4 v31, s[20:23], s55 offen offset:2048 lds
    buffer_load_dwordx4 v32, s[20:23], s55 offen offset:3072 lds
    s_add_u32 s67, s67, 1
    s_cmp_eq_u32 s67, 28
    s_cselect_b32 s58, 0xffe50000, s60
    s_cselect_b32 s67, 0, s67
    s_add_u32 s55, s55, s58
    s_waitcnt vmcnt(8)
    s_barrier
    s_add_u32 m0, s65, 0
    s_nop 0
    buffer_load_dwordx4 v29, s[20:23], s55 offen offset:0 lds
    buffer_load_dwordx4 v30, s[20:23], s55 offen offset:1024 lds
    buffer_load_dwordx4 v31, s[20:23], s55 offen offset:2048 lds
    buffer_load_dwordx4 v32, s[20:23], s55 offen offset:3072 lds
    s_add_u32 s67, s67, 1
    s_cmp_eq_u32 s67, 28
    s_cselect_b32 s58, 0xffe50000, s60
    s_cselect_b32 s67, 0, s67
    s_add_u32 s55, s55, s58
    s_waitcnt vmcnt(8)
    s_barrier
    s_add_u32 m0, s65, 16384
    s_nop 0
    buffer_load_dwordx4 v29, s[20:23], s55 offen offset:0 lds
    buffer_load_dwordx4 v30, s[20:23], s55 offen offset:1024 lds
    buffer_load_dwordx4 v31, s[20:23], s55 offen offset:2048 lds
    buffer_load_dwordx4 v32, s[20:23], s55 offen offset:3072 lds
    s_add_u32 s67, s67, 1
    s_cmp_eq_u32 s67, 28
    s_cselect_b32 s58, 0xffe50000, s60
    s_cselect_b32 s67, 0, s67
    s_add_u32 s55, s55, s58
    s_waitcnt vmcnt(8)
    s_barrier
    s_add_u32 m0, s65, 32768
    s_nop 0
    buffer_load_dwordx4 v29, s[20:23], s55 offen offset:0 lds
    buffer_load_dwordx4 v30, s[20:23], s55 offen offset:1024 lds
    buffer_load_dwordx4 v31, s[20:23], s55 offen offset:2048 lds
    buffer_load_dwordx4 v32, s[20:23], s55 offen offset:3072 lds
    s_add_u32 s67, s67, 1
    s_cmp_eq_u32 s67, 28
    s_cselect_b32 s58, 0xffe50000, s60
    s_cselect_b32 s67, 0, s67
    s_add_u32 s55, s55, s58
    s_waitcnt vmcnt(8)
    s_barrier
    s_add_u32 m0, s65, 49152
    s_nop 0
    buffer_load_dwordx4 v29, s[20:23], s55 offen offset:0 lds
    buffer_load_dwordx4 v30, s[20:23], s55 offen offset:1024 lds
    buffer_load_dwordx4 v31, s[20:23], s55 offen offset:2048 lds
    buffer_load_dwordx4 v32, s[20:23], s55 offen offset:3072 lds
    s_add_u32 s67, s67, 1
    s_cmp_eq_u32 s67, 28
    s_cselect_b32 s58, 0xffe50000, s60
    s_cselect_b32 s67, 0, s67
    s_add_u32 s55, s55, s58
    s_waitcnt vmcnt(8)
    s_barrier
    s_add_u32 m0, s65, 65536
    s_nop 0
    buffer_load_dwordx4 v29, s[20:23], s55 offen offset:0 lds
    buffer_load_dwordx4 v30, s[20:23], s55 offen offset:1024 lds
    buffer_load_dwordx4 v31, s[20:23], s55 offen offset:2048 lds
    buffer_load_dwordx4 v32, s[20:23], s55 offen offset:3072 lds
    s_add_u32 s67, s67, 1
    s_cmp_eq_u32 s67, 28
    s_cselect_b32 s58, 0xffe50000, s60
    s_cselect_b32 s67, 0, s67
    s_add_u32 s55, s55, s58
    s_waitcnt vmcnt(8)
    s_barrier
    s_add_u32 m0, s65, 0
    s_nop 0
    buffer_load_dwordx4 v29, s[20:23], s55 offen offset:0 lds
    buffer_load_dwordx4 v30, s[20:23], s55 offen offset:1024 lds
    buffer_load_dwordx4 v31, s[20:23], s55 offen offset:2048 lds
    buffer_load_dwordx4 v32, s[20:23], s55 offen offset:3072 lds
    s_add_u32 s67, s67, 1
    s_cmp_eq_u32 s67, 28
    s_cselect_b32 s58, 0xffe50000, s60
    s_cselect_b32 s67, 0, s67
    s_add_u32 s55, s55, s58
    s_waitcnt vmcnt(8)
    s_barrier
    s_add_u32 m0, s65, 16384
    s_nop 0
    buffer_load_dwordx4 v29, s[20:23], s55 offen offset:0 lds
    buffer_load_dwordx4 v30, s[20:23], s55 offen offset:1024 lds
    buffer_load_dwordx4 v31, s[20:23], s55 offen offset:2048 lds
    buffer_load_dwordx4 v32, s[20:23], s55 offen offset:3072 lds
    s_add_u32 s67, s67, 1
    s_cmp_eq_u32 s67, 28
    s_cselect_b32 s58, 0xffe50000, s60
    s_cselect_b32 s67, 0, s67
    s_add_u32 s55, s55, s58
    s_waitcnt vmcnt(8)
    s_barrier
    s_add_u32 m0, s65, 32768
    s_nop 0
    buffer_load_dwordx4 v29, s[20:23], s55 offen offset:0 lds
    buffer_load_dwordx4 v30, s[20:23], s55 offen offset:1024 lds
    buffer_load_dwordx4 v31, s[20:23], s55 offen offset:2048 lds
    buffer_load_dwordx4 v32, s[20:23], s55 offen offset:3072 lds
    s_add_u32 s67, s67, 1
    s_cmp_eq_u32 s67, 28
    s_cselect_b32 s58, 0xffe50000, s60
    s_cselect_b32 s67, 0, s67
    s_add_u32 s55, s55, s58
    s_waitcnt vmcnt(8)
    s_barrier
    s_add_u32 m0, s65, 49152
    s_nop 0
    buffer_load_dwordx4 v29, s[20:23], s55 offen offset:0 lds
    buffer_load_dwordx4 v30, s[20:23], s55 offen offset:1024 lds
    buffer_load_dwordx4 v31, s[20:23], s55 offen offset:2048 lds
    buffer_load_dwordx4 v32, s[20:23], s55 offen offset:3072 lds
    s_add_u32 s67, s67, 1
    s_cmp_eq_u32 s67, 28
    s_cselect_b32 s58, 0xffe50000, s60
    s_cselect_b32 s67, 0, s67
    s_add_u32 s55, s55, s58
    s_waitcnt vmcnt(8)
    s_barrier
    s_add_u32 m0, s65, 65536
    s_nop 0
    buffer_load_dwordx4 v29, s[20:23], s55 offen offset:0 lds
    buffer_load_dwordx4 v30, s[20:23], s55 offen offset:1024 lds
    buffer_load_dwordx4 v31, s[20:23], s55 offen offset:2048 lds
    buffer_load_dwordx4 v32, s[20:23], s55 offen offset:3072 lds
    s_add_u32 s67, s67, 1
    s_cmp_eq_u32 s67, 28
    s_cselect_b32 s58, 0xffe50000, s60
    s_cselect_b32 s67, 0, s67
    s_add_u32 s55, s55, s58
    s_waitcnt vmcnt(8)
    s_barrier
    s_add_u32 m0, s65, 0
    s_nop 0
    buffer_load_dwordx4 v29, s[20:23], s55 offen offset:0 lds
    buffer_load_dwordx4 v30, s[20:23], s55 offen offset:1024 lds
    buffer_load_dwordx4 v31, s[20:23], s55 offen offset:2048 lds
    buffer_load_dwordx4 v32, s[20:23], s55 offen offset:3072 lds
    s_add_u32 s67, s67, 1
    s_cmp_eq_u32 s67, 28
    s_cselect_b32 s58, 0xffe50000, s60
    s_cselect_b32 s67, 0, s67
    s_add_u32 s55, s55, s58
    s_waitcnt vmcnt(8)
    s_barrier
    s_add_u32 m0, s65, 16384
    s_nop 0
    buffer_load_dwordx4 v29, s[20:23], s55 offen offset:0 lds
    buffer_load_dwordx4 v30, s[20:23], s55 offen offset:1024 lds
    buffer_load_dwordx4 v31, s[20:23], s55 offen offset:2048 lds
    buffer_load_dwordx4 v32, s[20:23], s55 offen offset:3072 lds
    s_add_u32 s67, s67, 1
    s_cmp_eq_u32 s67, 28
    s_cselect_b32 s58, 0xffe50000, s60
    s_cselect_b32 s67, 0, s67
    s_add_u32 s55, s55, s58
    s_waitcnt vmcnt(8)
    s_barrier
    s_add_u32 m0, s65, 32768
    s_nop 0
    buffer_load_dwordx4 v29, s[20:23], s55 offen offset:0 lds
    buffer_load_dwordx4 v30, s[20:23], s55 offen offset:1024 lds
    buffer_load_dwordx4 v31, s[20:23], s55 offen offset:2048 lds
    buffer_load_dwordx4 v32, s[20:23], s55 offen offset:3072 lds
    s_add_u32 s67, s67, 1
    s_cmp_eq_u32 s67, 28
    s_cselect_b32 s58, 0xffe50000, s60
    s_cselect_b32 s67, 0, s67
    s_add_u32 s55, s55, s58
    s_waitcnt vmcnt(8)
    s_barrier
    s_add_u32 m0, s65, 49152
    s_nop 0
    buffer_load_dwordx4 v29, s[20:23], s55 offen offset:0 lds
    buffer_load_dwordx4 v30, s[20:23], s55 offen offset:1024 lds
    buffer_load_dwordx4 v31, s[20:23], s55 offen offset:2048 lds
    buffer_load_dwordx4 v32, s[20:23], s55 offen offset:3072 lds
    s_add_u32 s67, s67, 1
    s_cmp_eq_u32 s67, 28
    s_cselect_b32 s58, 0xffe50000, s60
    s_cselect_b32 s67, 0, s67
    s_add_u32 s55, s55, s58
    s_waitcnt vmcnt(8)
    s_barrier
    s_add_u32 m0, s65, 65536
    s_nop 0
    buffer_load_dwordx4 v29, s[20:23], s55 offen offset:0 lds
    buffer_load_dwordx4 v30, s[20:23], s55 offen offset:1024 lds
    buffer_load_dwordx4 v31, s[20:23], s55 offen offset:2048 lds
    buffer_load_dwordx4 v32, s[20:23], s55 offen offset:3072 lds
    s_add_u32 s67, s67, 1
    s_cmp_eq_u32 s67, 28
    s_cselect_b32 s58, 0xffe50000, s60
    s_cselect_b32 s67, 0, s67
    s_add_u32 s55, s55, s58
    s_waitcnt vmcnt(8)
    s_barrier
    s_add_u32 m0, s65, 0
    s_nop 0
    buffer_load_dwordx4 v29, s[20:23], s55 offen offset:0 lds
    buffer_load_dwordx4 v30, s[20:23], s55 offen offset:1024 lds
    buffer_load_dwordx4 v31, s[20:23], s55 offen offset:2048 lds
    buffer_load_dwordx4 v32, s[20:23], s55 offen offset:3072 lds
    s_add_u32 s67, s67, 1
    s_cmp_eq_u32 s67, 28
    s_cselect_b32 s58, 0xffe50000, s60
    s_cselect_b32 s67, 0, s67
    s_add_u32 s55, s55, s58
    s_waitcnt vmcnt(8)
    s_barrier
    s_add_u32 m0, s65, 16384
    s_nop 0
    buffer_load_dwordx4 v29, s[20:23], s55 offen offset:0 lds
    buffer_load_dwordx4 v30, s[20:23], s55 offen offset:1024 lds
    buffer_load_dwordx4 v31, s[20:23], s55 offen offset:2048 lds
    buffer_load_dwordx4 v32, s[20:23], s55 offen offset:3072 lds
    s_add_u32 s67, s67, 1
    s_cmp_eq_u32 s67, 28
    s_cselect_b32 s58, 0xffe50000, s60
    s_cselect_b32 s67, 0, s67
    s_add_u32 s55, s55, s58
    s_waitcnt vmcnt(8)
    s_barrier
    s_add_u32 m0, s65, 32768
    s_nop 0
    buffer_load_dwordx4 v29, s[20:23], s55 offen offset:0 lds
    buffer_load_dwordx4 v30, s[20:23], s55 offen offset:1024 lds
    buffer_load_dwordx4 v31, s[20:23], s55 offen offset:2048 lds
    buffer_load_dwordx4 v32, s[20:23], s55 offen offset:3072 lds
    s_waitcnt vmcnt(8)
    s_barrier
    s_waitcnt vmcnt(4)
    s_barrier
    s_waitcnt vmcnt(0)
    s_barrier
    s_barrier
    s_lshl_b32 s67, s50, 1
    s_add_u32 s67, s67, s49
    s_and_b32 s67, s67, 7
    s_lshl_b32 s55, s47, 15
    s_lshl_b32 s40, s49, 7
    s_add_u32 s55, s55, s40
    s_lshl_b32 s40, s67, 16
    s_add_u32 s55, s55, s40
    s_add_u32 m0, s65, 0
    s_nop 0
    buffer_load_dwordx4 v29, s[8:11], s55 offen offset:0 lds
    buffer_load_dwordx4 v30, s[8:11], s55 offen offset:1024 lds
    buffer_load_dwordx4 v31, s[8:11], s55 offen offset:2048 lds
    buffer_load_dwordx4 v32, s[8:11], s55 offen offset:3072 lds
    s_add_u32 s67, s67, 1
    s_cmp_eq_u32 s67, 8
    s_cselect_b32 s58, 0xfff90000, s60
    s_cselect_b32 s67, 0, s67
    s_add_u32 s55, s55, s58
    s_add_u32 m0, s65, 16384
    s_nop 0
    buffer_load_dwordx4 v29, s[8:11], s55 offen offset:0 lds
    buffer_load_dwordx4 v30, s[8:11], s55 offen offset:1024 lds
    buffer_load_dwordx4 v31, s[8:11], s55 offen offset:2048 lds
    buffer_load_dwordx4 v32, s[8:11], s55 offen offset:3072 lds
    s_add_u32 s67, s67, 1
    s_cmp_eq_u32 s67, 8
    s_cselect_b32 s58, 0xfff90000, s60
    s_cselect_b32 s67, 0, s67
    s_add_u32 s55, s55, s58
    s_add_u32 m0, s65, 32768
    s_nop 0
    buffer_load_dwordx4 v29, s[8:11], s55 offen offset:0 lds
    buffer_load_dwordx4 v30, s[8:11], s55 offen offset:1024 lds
    buffer_load_dwordx4 v31, s[8:11], s55 offen offset:2048 lds
    buffer_load_dwordx4 v32, s[8:11], s55 offen offset:3072 lds
    s_add_u32 s67, s67, 1
    s_cmp_eq_u32 s67, 8
    s_cselect_b32 s58, 0xfff90000, s60
    s_cselect_b32 s67, 0, s67
    s_add_u32 s55, s55, s58
    s_add_u32 m0, s65, 49152
    s_nop 0
    buffer_load_dwordx4 v29, s[8:11], s55 offen offset:0 lds
    buffer_load_dwordx4 v30, s[8:11], s55 offen offset:1024 lds
    buffer_load_dwordx4 v31, s[8:11], s55 offen offset:2048 lds
    buffer_load_dwordx4 v32, s[8:11], s55 offen offset:3072 lds
    s_add_u32 s67, s67, 1
    s_cmp_eq_u32 s67, 8
    s_cselect_b32 s58, 0xfff90000, s60
    s_cselect_b32 s67, 0, s67
    s_add_u32 s55, s55, s58
    s_add_u32 m0, s65, 65536
    s_nop 0
    buffer_load_dwordx4 v29, s[8:11], s55 offen offset:0 lds
    buffer_load_dwordx4 v30, s[8:11], s55 offen offset:1024 lds
    buffer_load_dwordx4 v31, s[8:11], s55 offen offset:2048 lds
    buffer_load_dwordx4 v32, s[8:11], s55 offen offset:3072 lds
    s_add_u32 s67, s67, 1
    s_cmp_eq_u32 s67, 8
    s_cselect_b32 s58, 0xfff90000, s60
    s_cselect_b32 s67, 0, s67
    s_add_u32 s55, s55, s58
    s_waitcnt vmcnt(16)
    s_barrier
    s_waitcnt vmcnt(12)
    s_barrier
    s_waitcnt vmcnt(8)
    s_barrier
    s_add_u32 m0, s65, 0
    s_nop 0
    buffer_load_dwordx4 v29, s[8:11], s55 offen offset:0 lds
    buffer_load_dwordx4 v30, s[8:11], s55 offen offset:1024 lds
    buffer_load_dwordx4 v31, s[8:11], s55 offen offset:2048 lds
    buffer_load_dwordx4 v32, s[8:11], s55 offen offset:3072 lds
    s_add_u32 s67, s67, 1
    s_cmp_eq_u32 s67, 8
    s_cselect_b32 s58, 0xfff90000, s60
    s_cselect_b32 s67, 0, s67
    s_add_u32 s55, s55, s58
    s_waitcnt vmcnt(8)
    s_barrier
    s_add_u32 m0, s65, 16384
    s_nop 0
    buffer_load_dwordx4 v29, s[8:11], s55 offen offset:0 lds
    buffer_load_dwordx4 v30, s[8:11], s55 offen offset:1024 lds
    buffer_load_dwordx4 v31, s[8:11], s55 offen offset:2048 lds
    buffer_load_dwordx4 v32, s[8:11], s55 offen offset:3072 lds
    s_add_u32 s67, s67, 1
    s_cmp_eq_u32 s67, 8
    s_cselect_b32 s58, 0xfff90000, s60
    s_cselect_b32 s67, 0, s67
    s_add_u32 s55, s55, s58
    s_waitcnt vmcnt(8)
    s_barrier
    s_add_u32 m0, s65, 32768
    s_nop 0
    buffer_load_dwordx4 v29, s[8:11], s55 offen offset:0 lds
    buffer_load_dwordx4 v30, s[8:11], s55 offen offset:1024 lds
    buffer_load_dwordx4 v31, s[8:11], s55 offen offset:2048 lds
    buffer_load_dwordx4 v32, s[8:11], s55 offen offset:3072 lds
    s_waitcnt vmcnt(8)
    s_barrier
    s_waitcnt vmcnt(4)
    s_barrier
    s_waitcnt vmcnt(0)
    s_barrier
k2_kernel_end_20:
    s_endpgm
.p2align 10
code_end:
.section .rodata,"a"
.p2align 6
.amdhsa_kernel k1_kernel
  .amdhsa_next_free_vgpr 128
  .amdhsa_next_free_sgpr 100
  .amdhsa_accum_offset 128
  .amdhsa_group_segment_fixed_size 0
  .amdhsa_kernarg_size 96
  .amdhsa_user_sgpr_count 2
  .amdhsa_user_sgpr_kernarg_segment_ptr 1
  .amdhsa_system_sgpr_workgroup_id_x 1
.end_amdhsa_kernel
.p2align 6
.amdhsa_kernel k2_kernel
  .amdhsa_next_free_vgpr 128
  .amdhsa_next_free_sgpr 100
  .amdhsa_accum_offset 128
  .amdhsa_group_segment_fixed_size 0
  .amdhsa_kernarg_size 96
  .amdhsa_user_sgpr_count 2
  .amdhsa_user_sgpr_kernarg_segment_ptr 1
  .amdhsa_system_sgpr_workgroup_id_x 1
.end_amdhsa_kernel
```
